```python
import torch

def _softmax(x, axis=-1):
    return torch.softmax(x, dim=axis)
def _gelu(x):
    return torch.nn.functional.gelu(x, approximate="tanh")
def _silu(x):
    return torch.nn.functional.silu(x)
def _sigmoid(x):
    return torch.sigmoid(x)
def _layernorm(x, axis=-1, eps=1e-5):
    m = x.mean(dim=axis, keepdim=True)
    v = x.var(dim=axis, keepdim=True, unbiased=False)
    return (x - m) / torch.sqrt(v + eps)
def _scatter_add(tgt, idx, src, axis=0):
    return tgt.clone().index_add_(axis, idx, src)
def _segment_sum(src, seg, n):
    out = torch.zeros((n,) + src.shape[1:], dtype=src.dtype)
    return out.index_add_(0, seg, src)
def _pad(x, pw):
    flat = tuple(v for pair in reversed(pw) for v in pair)
    return torch.nn.functional.pad(x, flat)

kernel_name = 'standalone__glu_gated_geglu__prompt'

def setup_inputs():

    _w = (lambda a: (lambda t: t.to(torch.bfloat16) if t.is_floating_point() else t)(torch.as_tensor(a)))
    B, S, Dm, Df = 1, 2048, 576, 4608
    return {
        "x": _w((lambda *s: torch.randn(*s, dtype=torch.bfloat16) * 0.05)(B, S, Dm)),
        "w_gate": _w((lambda *s: torch.randn(*s, dtype=torch.bfloat16) * 0.05)(Dm, Df) * (Dm ** -0.5)),
        "w_up": _w((lambda *s: torch.randn(*s, dtype=torch.bfloat16) * 0.05)(Dm, Df) * (Dm ** -0.5)),
        "w_down": _w((lambda *s: torch.randn(*s, dtype=torch.bfloat16) * 0.05)(Df, Dm) * (Df ** -0.5)),
    }

def reference(x, w_gate, w_up, w_down):
    g = torch.einsum("bsd,df->bsf", x, w_gate)
    u = torch.einsum("bsd,df->bsf", x, w_up)
    h = _gelu(g) * u
    return torch.einsum("bsf,fd->bsd", h, w_down)
```

```asm
; @launch grid=(256,1,1) block=(256,1,1) lds=163840
.amdgcn_target "amdgcn-amd-amdhsa--gfx950"
.text
.globl standalone__glu_gated_geglu__prompt_kernel
.p2align 8
.type standalone__glu_gated_geglu__prompt_kernel,@function
standalone__glu_gated_geglu__prompt_kernel:
  s_cmp_ge_u32 s2, 256
  s_cbranch_scc1 L_end
  s_load_dwordx4 s[4:7], s[0:1], 0
  s_load_dwordx4 s[8:11], s[0:1], 16
  s_load_dwordx4 s[12:15], s[0:1], 32
  s_load_dwordx2 s[52:53], s[0:1], 48
  s_getpc_b64 s[100:101]
L_pc:
  s_lshr_b32 s3, s2, 3
  v_lshrrev_b32 v50, 6, v0
  s_lshl_b32 s3, s3, 2
  v_add_u32 v50, s3, v50
  v_mul_u32_u24 v50, 3, v50
  v_and_b32 v51, 3, v0
  v_min_u32 v51, 2, v51
  v_add_u32 v50, v50, v51
  s_sub_u32 s100, s100, L_pc-standalone__glu_gated_geglu__prompt_kernel
  s_subb_u32 s101, s101, 0
  v_lshlrev_b32 v50, 7, v50
  v_min_u32 v50, L_end-standalone__glu_gated_geglu__prompt_kernel, v50
  v_mov_b32 v53, s101
  v_add_co_u32 v52, vcc, s100, v50
  s_nop 1
  v_addc_co_u32 v53, vcc, 0, v53, vcc
  global_load_dword v252, v[52:53], off
  v_lshrrev_b32 v1, 6, v0
  v_and_b32 v0, 63, v0
  s_and_b32 s40, s2, 7
  v_readfirstlane_b32 s28, v1
  s_lshr_b32 s54, s2, 3
  s_and_b32 s31, s54, 7
  s_lshr_b32 s41, s54, 3
  s_and_b32 s32, s40, 3
  s_lshl_b32 s55, s40, 2
  s_add_u32 s55, s55, s41
  s_lshr_b32 s40, s40, 2
  s_lshl_b32 s42, s40, 2
  s_add_u32 s33, s42, s41
  s_lshl_b32 s34, s32, 3
  s_add_u32 s34, s34, s31
  s_and_b32 s35, s31, 1
  s_lshr_b32 s29, s28, 1
  s_and_b32 s30, s28, 1
  v_lshrrev_b32 v50, 3, v0
  v_mul_u32_u24 v50, 1152, v50
  v_and_b32 v51, 7, v0
  v_lshrrev_b32 v52, 4, v0
  v_xor_b32 v51, v51, v52
  v_lshl_add_u32 v52, v51, 4, v50
  v_xor_b32 v51, 4, v51
  v_lshl_add_u32 v53, v51, 4, v50
  v_add_u32 v10, 0, v52
  v_add_u32 v11, 8192, v53
  v_add_u32 v12, 16384, v52
  v_add_u32 v13, 24576, v53
  v_add_u32 v14, 36864, v52
  v_add_u32 v15, 45056, v53
  v_add_u32 v16, 53248, v52
  v_add_u32 v17, 61440, v53
  s_lshl_b32 s36, s33, 2
  s_add_u32 s36, s36, s28
  s_mul_i32 s36, s36, 73728
  s_mul_i32 s37, s29, 294912
  s_mul_i32 s42, s34, 288
  s_add_u32 s37, s37, s42
  s_lshl_b32 s38, s28, 13
  s_mul_i32 s39, s30, 9216
  s_add_u32 s39, s39, 65536
  s_lshl_b32 s42, s35, 1
  s_movk_i32 s43, -18
  s_lshl_b32 s61, s54, 2
  s_add_u32 s61, s61, s28
  s_mov_b32 s3, s61
  s_lshr_b32 s62, s61, 1
  s_mul_i32 s62, s62, 9216
  s_mul_i32 s63, s32, 2304
  s_add_u32 s62, s62, s63
  v_lshlrev_b32 v50, 7, v0
  v_add_u32 v50, s62, v50
  v_mov_b32 v51, 2130706432
  v_cmp_gt_u32 vcc, 18, v0
  s_lshl_b32 s62, s40, 10
  s_lshl_b32 s63, s61, 3
  v_cndmask_b32 v248, v51, v50, vcc
  s_add_u32 s62, s62, s63
  v_add_u32 v50, s62, v0
  v_mul_u32_u24 v50, 1152, v50
  v_cmp_gt_u32 vcc, 8, v0
  s_nop 1
  v_cndmask_b32 v249, v51, v50, vcc
  s_mul_i32 s62, s61, 81
  v_add_u32 v50, s62, v0
  v_lshlrev_b32 v50, 7, v50
  s_mul_i32 s62, s32, 1327104
  v_add_u32 v50, s62, v50
  v_cmp_gt_u32 vcc, 17, v0
  s_nop 1
  v_cndmask_b32 v55, v51, v50, vcc
  v_add_u32 v50, 0, v0
  v_mul_u32_u24 v51, 3641, v50
  v_lshrrev_b32 v51, 16, v51
  v_mad_i32_i24 v50, v51, s43, v50
  v_add_u32 v50, s42, v50
  v_subrev_u32 v52, 18, v50
  v_min_u32 v50, v50, v52
  v_lshrrev_b32 v52, 1, v51
  v_and_b32 v52, 4, v52
  v_xor_b32 v51, v51, v52
  v_mul_u32_u24 v51, 9216, v51
  v_lshl_add_u32 v1, v50, 4, v51
  v_add_u32 v50, 64, v0
  v_mul_u32_u24 v51, 3641, v50
  v_lshrrev_b32 v51, 16, v51
  v_mad_i32_i24 v50, v51, s43, v50
  v_add_u32 v50, s42, v50
  v_subrev_u32 v52, 18, v50
  v_min_u32 v50, v50, v52
  v_lshrrev_b32 v52, 1, v51
  v_and_b32 v52, 4, v52
  v_xor_b32 v51, v51, v52
  v_mul_u32_u24 v51, 9216, v51
  v_lshl_add_u32 v2, v50, 4, v51
  v_subrev_u32 v2, 1024, v2
  v_add_u32 v50, 128, v0
  v_mul_u32_u24 v51, 3641, v50
  v_lshrrev_b32 v51, 16, v51
  v_mad_i32_i24 v50, v51, s43, v50
  v_add_u32 v50, s42, v50
  v_subrev_u32 v52, 18, v50
  v_min_u32 v50, v50, v52
  v_lshrrev_b32 v52, 1, v51
  v_and_b32 v52, 4, v52
  v_xor_b32 v51, v51, v52
  v_mul_u32_u24 v51, 9216, v51
  v_lshl_add_u32 v3, v50, 4, v51
  v_subrev_u32 v3, 2048, v3
  v_add_u32 v50, 192, v0
  v_mul_u32_u24 v51, 3641, v50
  v_lshrrev_b32 v51, 16, v51
  v_mad_i32_i24 v50, v51, s43, v50
  v_add_u32 v50, s42, v50
  v_subrev_u32 v52, 18, v50
  v_min_u32 v50, v50, v52
  v_lshrrev_b32 v52, 1, v51
  v_and_b32 v52, 4, v52
  v_xor_b32 v51, v51, v52
  v_mul_u32_u24 v51, 9216, v51
  v_lshl_add_u32 v4, v50, 4, v51
  v_subrev_u32 v4, 3072, v4
  s_waitcnt lgkmcnt(0)
  s_mov_b32 s16, s4
  s_mov_b32 s17, s5
  s_mov_b32 s18, 2359296
  s_mov_b32 s19, 0x00020000
  s_cmp_eq_u32 s30, 1
  s_cselect_b32 s20, s8, s6
  s_cselect_b32 s21, s9, s7
  s_mov_b32 s22, 5308416
  s_mov_b32 s23, 0x00020000
  s_mov_b32 s63, 0
  buffer_load_dword v252, v249, s[16:19], s63 offen
  s_mov_b32 s63, 0
  buffer_load_dword v252, v248, s[20:23], s63 offen
  s_mov_b32 s63, 128
  buffer_load_dword v252, v249, s[16:19], s63 offen
  s_mov_b32 s63, 589824
  buffer_load_dword v252, v248, s[20:23], s63 offen
  s_movk_i32 s88, -18
  s_add_u32 s43, s36, 0
  s_add_u32 m0, s38, 0
  s_nop 0
  buffer_load_dwordx4 v10, s[16:19], s43 offen offset:0 lds
  v_add_u32 v50, 256, v0
  v_mul_u32_u24 v51, 3641, v50
  v_lshrrev_b32 v51, 16, v51
  v_mad_i32_i24 v50, v51, s88, v50
  v_add_u32 v50, s42, v50
  v_subrev_u32 v52, 18, v50
  v_min_u32 v50, v50, v52
  v_lshrrev_b32 v52, 1, v51
  v_and_b32 v52, 4, v52
  v_xor_b32 v51, v51, v52
  v_mul_u32_u24 v51, 9216, v51
  v_lshl_add_u32 v5, v50, 4, v51
  buffer_load_dwordx4 v11, s[16:19], s43 offen offset:1024 lds
  v_add_u32 v50, 320, v0
  v_mul_u32_u24 v51, 3641, v50
  v_lshrrev_b32 v51, 16, v51
  v_mad_i32_i24 v50, v51, s88, v50
  v_add_u32 v50, s42, v50
  v_subrev_u32 v52, 18, v50
  v_min_u32 v50, v50, v52
  v_lshrrev_b32 v52, 1, v51
  v_and_b32 v52, 4, v52
  v_xor_b32 v51, v51, v52
  v_mul_u32_u24 v51, 9216, v51
  v_lshl_add_u32 v6, v50, 4, v51
  v_subrev_u32 v6, 1024, v6
  buffer_load_dwordx4 v12, s[16:19], s43 offen offset:2048 lds
  v_add_u32 v50, 384, v0
  v_mul_u32_u24 v51, 3641, v50
  v_lshrrev_b32 v51, 16, v51
  v_mad_i32_i24 v50, v51, s88, v50
  v_add_u32 v50, s42, v50
  v_subrev_u32 v52, 18, v50
  v_min_u32 v50, v50, v52
  v_lshrrev_b32 v52, 1, v51
  v_and_b32 v52, 4, v52
  v_xor_b32 v51, v51, v52
  v_mul_u32_u24 v51, 9216, v51
  v_lshl_add_u32 v7, v50, 4, v51
  v_subrev_u32 v7, 2048, v7
  buffer_load_dwordx4 v13, s[16:19], s43 offen offset:3072 lds
  v_add_u32 v50, 448, v0
  v_mul_u32_u24 v51, 3641, v50
  v_lshrrev_b32 v51, 16, v51
  v_mad_i32_i24 v50, v51, s88, v50
  v_add_u32 v50, s42, v50
  v_subrev_u32 v52, 18, v50
  v_min_u32 v50, v50, v52
  v_lshrrev_b32 v52, 1, v51
  v_and_b32 v52, 4, v52
  v_xor_b32 v51, v51, v52
  v_mul_u32_u24 v51, 9216, v51
  v_lshl_add_u32 v8, v50, 4, v51
  v_subrev_u32 v8, 3072, v8
  s_add_u32 m0, s38, 4096
  s_nop 0
  buffer_load_dwordx4 v14, s[16:19], s43 offen offset:0 lds
  v_add_u32 v50, 512, v0
  v_mul_u32_u24 v51, 3641, v50
  v_lshrrev_b32 v51, 16, v51
  v_mad_i32_i24 v50, v51, s88, v50
  v_add_u32 v50, s42, v50
  v_subrev_u32 v52, 18, v50
  v_min_u32 v50, v50, v52
  v_lshrrev_b32 v52, 1, v51
  v_and_b32 v52, 4, v52
  v_xor_b32 v51, v51, v52
  v_mul_u32_u24 v51, 9216, v51
  v_lshl_add_u32 v9, v50, 4, v51
  buffer_load_dwordx4 v15, s[16:19], s43 offen offset:1024 lds
  buffer_load_dwordx4 v16, s[16:19], s43 offen offset:2048 lds
  buffer_load_dwordx4 v17, s[16:19], s43 offen offset:3072 lds
  s_mul_i32 s45, s29, 0
  s_add_u32 s45, s45, s37
  s_mul_i32 s44, s29, 18432
  s_add_u32 s44, s44, s39
  s_add_u32 m0, s44, 0
  s_nop 0
  buffer_load_dwordx4 v1, s[20:23], s45 offen offset:0 lds
  v_lshrrev_b32 v50, 4, v0
  v_and_b32 v51, 15, v0
  v_lshrrev_b32 v52, 2, v51
  buffer_load_dwordx4 v2, s[20:23], s45 offen offset:1024 lds
  v_lshlrev_b32 v53, 3, v50
  v_add_u32 v52, v52, v53
  v_and_b32 v54, 1, v50
  buffer_load_dwordx4 v3, s[20:23], s45 offen offset:2048 lds
  v_lshlrev_b32 v54, 2, v54
  v_xor_b32 v49, v52, v54
  v_add_u32 v52, 4, v52
  buffer_load_dwordx4 v4, s[20:23], s45 offen offset:3072 lds
  v_xor_b32 v52, v52, v54
  v_and_b32 v53, 3, v51
  v_lshlrev_b32 v53, 3, v53
  s_add_u32 m0, s44, 4096
  s_nop 0
  buffer_load_dwordx4 v5, s[20:23], s45 offen offset:0 lds
  v_mul_u32_u24 v49, 288, v49
  v_add_u32 v18, v49, v53
  v_mul_u32_u24 v52, 288, v52
  buffer_load_dwordx4 v6, s[20:23], s45 offen offset:1024 lds
  v_add_u32 v19, v52, v53
  v_lshrrev_b32 v52, 1, v51
  v_and_b32 v52, 7, v52
  buffer_load_dwordx4 v7, s[20:23], s45 offen offset:2048 lds
  v_xor_b32 v52, v52, v50
  v_lshlrev_b32 v52, 4, v52
  v_lshlrev_b32 v53, 7, v51
  buffer_load_dwordx4 v8, s[20:23], s45 offen offset:3072 lds
  v_add_u32 v52, v52, v53
  v_add_u32 v24, s38, v52
  v_xor_b32 v25, 64, v24
  s_add_u32 m0, s44, 8192
  s_nop 0
  buffer_load_dwordx4 v9, s[20:23], s45 offen offset:0 lds
  v_lshlrev_b32 v26, 4, v0
  v_cmp_eq_u32 vcc, 0, v0
  v_mov_b32 v254, 2130706432
  v_mov_b32 v50, 0
  v_cndmask_b32 v254, v254, v50, vcc
  s_mov_b32 s24, s52
  s_mov_b32 s25, s53
  s_mov_b32 s26, 268435456
  s_mov_b32 s27, 0x00020000
  s_mov_b32 s56, s14
  s_mov_b32 s57, s15
  s_mov_b32 s58, 256
  s_mov_b32 s59, 0x00020000
  s_mov_b32 s68, s10
  s_mov_b32 s69, s11
  s_mov_b32 s70, 5308416
  s_mov_b32 s71, 0x00020000
  s_mov_b32 s96, s12
  s_mov_b32 s97, s13
  s_mov_b32 s98, 2359296
  s_mov_b32 s99, 0x00020000
  s_or_b32 s42, s2, s28
  s_cmp_lg_u32 s42, 0
  s_cbranch_scc1 L_nonce_skip
  s_memrealtime s[44:45]
  s_waitcnt lgkmcnt(0)
  s_lshl_b32 s44, s44, 5
  s_or_b32 s44, s44, 16
  v_mov_b32 v50, s44
  buffer_store_dword v50, v254, s[56:59], 0 offen sc1
L_nonce_skip:
  s_waitcnt vmcnt(0)
  s_barrier
  v_add_u32 v20, 65536, v18
  v_add_u32 v21, 65536, v19
  v_add_u32 v22, 83968, v18
  v_add_u32 v23, 83968, v19
  ds_read_b64_tr_b16 a[160:161], v20 offset:0
  ds_read_b64_tr_b16 a[162:163], v21 offset:0
  ds_read_b64_tr_b16 a[164:165], v22 offset:0
  ds_read_b64_tr_b16 a[166:167], v23 offset:0
  ds_read_b128 a[96:99], v24 offset:0
  ds_read_b128 a[100:103], v25 offset:0
  ds_read_b128 a[104:107], v24 offset:2048
  ds_read_b128 a[108:111], v25 offset:2048
  ds_read_b128 a[112:115], v24 offset:4096
  ds_read_b128 a[116:119], v25 offset:4096
  ds_read_b128 a[120:123], v24 offset:6144
  ds_read_b128 a[124:127], v25 offset:6144
  ds_read_b64_tr_b16 a[168:169], v20 offset:9216
  ds_read_b64_tr_b16 a[170:171], v21 offset:9216
  ds_read_b64_tr_b16 a[172:173], v22 offset:9216
  ds_read_b64_tr_b16 a[174:175], v23 offset:9216
L_slab0:
  s_waitcnt lgkmcnt(4)
  v_mfma_f32_16x16x32_bf16 v[56:59], a[160:163], a[96:99], 0
  ds_read_b64_tr_b16 a[176:177], v20 offset:32
  v_mfma_f32_16x16x32_bf16 v[56:59], a[164:167], a[100:103], v[56:59]
  ds_read_b64_tr_b16 a[178:179], v21 offset:32
  v_mfma_f32_16x16x32_bf16 v[60:63], a[164:167], a[108:111], 0
  ds_read_b64_tr_b16 a[180:181], v22 offset:32
  v_mfma_f32_16x16x32_bf16 v[60:63], a[160:163], a[104:107], v[60:63]
  ds_read_b64_tr_b16 a[182:183], v23 offset:32
  v_mfma_f32_16x16x32_bf16 v[64:67], a[160:163], a[112:115], 0
  s_add_u32 s43, s36, 128
  s_add_u32 m0, s38, 32768
  v_mfma_f32_16x16x32_bf16 v[64:67], a[164:167], a[116:119], v[64:67]
  buffer_load_dwordx4 v10, s[16:19], s43 offen offset:0 lds
  v_mfma_f32_16x16x32_bf16 v[68:71], a[164:167], a[124:127], 0
  v_mfma_f32_16x16x32_bf16 v[68:71], a[160:163], a[120:123], v[68:71]
  s_waitcnt lgkmcnt(4)
  v_mfma_f32_16x16x32_bf16 v[72:75], a[168:171], a[96:99], 0
  ds_read_b64_tr_b16 a[160:161], v20 offset:9248
  v_mfma_f32_16x16x32_bf16 v[72:75], a[172:175], a[100:103], v[72:75]
  ds_read_b64_tr_b16 a[162:163], v21 offset:9248
  buffer_load_dwordx4 v11, s[16:19], s43 offen offset:1024 lds
  v_mfma_f32_16x16x32_bf16 v[76:79], a[172:175], a[108:111], 0
  ds_read_b64_tr_b16 a[164:165], v22 offset:9248
  v_mfma_f32_16x16x32_bf16 v[76:79], a[168:171], a[104:107], v[76:79]
  ds_read_b64_tr_b16 a[166:167], v23 offset:9248
  s_mov_b32 s63, 1179648
  v_mfma_f32_16x16x32_bf16 v[80:83], a[168:171], a[112:115], 0
  buffer_load_dword v252, v248, s[20:23], s63 offen
  v_mfma_f32_16x16x32_bf16 v[80:83], a[172:175], a[116:119], v[80:83]
  buffer_load_dwordx4 v12, s[16:19], s43 offen offset:2048 lds
  s_mov_b32 s63, 256
  v_mfma_f32_16x16x32_bf16 v[84:87], a[172:175], a[124:127], 0
  buffer_load_dword v252, v249, s[16:19], s63 offen
  v_mfma_f32_16x16x32_bf16 v[84:87], a[168:171], a[120:123], v[84:87]
  s_waitcnt lgkmcnt(4)
  v_mfma_f32_16x16x32_bf16 v[88:91], a[176:179], a[96:99], 0
  ds_read_b64_tr_b16 a[168:169], v20 offset:64
  v_mfma_f32_16x16x32_bf16 v[88:91], a[180:183], a[100:103], v[88:91]
  ds_read_b64_tr_b16 a[170:171], v21 offset:64
  v_mfma_f32_16x16x32_bf16 v[92:95], a[180:183], a[108:111], 0
  ds_read_b64_tr_b16 a[172:173], v22 offset:64
  v_mfma_f32_16x16x32_bf16 v[92:95], a[176:179], a[104:107], v[92:95]
  ds_read_b64_tr_b16 a[174:175], v23 offset:64
  buffer_load_dwordx4 v13, s[16:19], s43 offen offset:3072 lds
  v_mfma_f32_16x16x32_bf16 v[96:99], a[176:179], a[112:115], 0
  v_mfma_f32_16x16x32_bf16 v[96:99], a[180:183], a[116:119], v[96:99]
  v_mfma_f32_16x16x32_bf16 v[100:103], a[180:183], a[124:127], 0
  s_add_u32 m0, s38, 36864
  v_mfma_f32_16x16x32_bf16 v[100:103], a[176:179], a[120:123], v[100:103]
  s_waitcnt lgkmcnt(4)
  buffer_load_dwordx4 v14, s[16:19], s43 offen offset:0 lds
  v_mfma_f32_16x16x32_bf16 v[104:107], a[160:163], a[96:99], 0
  ds_read_b64_tr_b16 a[176:177], v20 offset:9280
  v_mfma_f32_16x16x32_bf16 v[104:107], a[164:167], a[100:103], v[104:107]
  ds_read_b64_tr_b16 a[178:179], v21 offset:9280
  v_mfma_f32_16x16x32_bf16 v[108:111], a[164:167], a[108:111], 0
  ds_read_b64_tr_b16 a[180:181], v22 offset:9280
  v_mfma_f32_16x16x32_bf16 v[108:111], a[160:163], a[104:107], v[108:111]
  ds_read_b64_tr_b16 a[182:183], v23 offset:9280
  v_mfma_f32_16x16x32_bf16 v[112:115], a[160:163], a[112:115], 0
  v_mfma_f32_16x16x32_bf16 v[112:115], a[164:167], a[116:119], v[112:115]
  buffer_load_dwordx4 v15, s[16:19], s43 offen offset:1024 lds
  v_mfma_f32_16x16x32_bf16 v[116:119], a[164:167], a[124:127], 0
  v_mfma_f32_16x16x32_bf16 v[116:119], a[160:163], a[120:123], v[116:119]
  s_waitcnt lgkmcnt(4)
  v_mfma_f32_16x16x32_bf16 v[120:123], a[168:171], a[96:99], 0
  ds_read_b64_tr_b16 a[160:161], v20 offset:96
  v_mfma_f32_16x16x32_bf16 v[120:123], a[172:175], a[100:103], v[120:123]
  ds_read_b64_tr_b16 a[162:163], v21 offset:96
  buffer_load_dwordx4 v16, s[16:19], s43 offen offset:2048 lds
  v_mfma_f32_16x16x32_bf16 v[124:127], a[172:175], a[108:111], 0
  ds_read_b64_tr_b16 a[164:165], v22 offset:96
  v_mfma_f32_16x16x32_bf16 v[124:127], a[168:171], a[104:107], v[124:127]
  ds_read_b64_tr_b16 a[166:167], v23 offset:96
  v_mfma_f32_16x16x32_bf16 v[128:131], a[168:171], a[112:115], 0
  v_mfma_f32_16x16x32_bf16 v[128:131], a[172:175], a[116:119], v[128:131]
  v_mfma_f32_16x16x32_bf16 v[132:135], a[172:175], a[124:127], 0
  v_mfma_f32_16x16x32_bf16 v[132:135], a[168:171], a[120:123], v[132:135]
  s_waitcnt lgkmcnt(4)
  buffer_load_dwordx4 v17, s[16:19], s43 offen offset:3072 lds
  v_mfma_f32_16x16x32_bf16 v[136:139], a[176:179], a[96:99], 0
  ds_read_b64_tr_b16 a[168:169], v20 offset:9312
  v_mfma_f32_16x16x32_bf16 v[136:139], a[180:183], a[100:103], v[136:139]
  ds_read_b64_tr_b16 a[170:171], v21 offset:9312
  v_mfma_f32_16x16x32_bf16 v[140:143], a[180:183], a[108:111], 0
  ds_read_b64_tr_b16 a[172:173], v22 offset:9312
  s_mul_i32 s45, s29, 0
  s_add_u32 s45, s45, s37
  s_add_u32 s45, s45, 589824
  s_mul_i32 s44, s29, 18432
  s_add_u32 s44, s44, s39
  s_add_u32 m0, s44, 36864
  v_mfma_f32_16x16x32_bf16 v[140:143], a[176:179], a[104:107], v[140:143]
  ds_read_b64_tr_b16 a[174:175], v23 offset:9312
  buffer_load_dwordx4 v1, s[20:23], s45 offen offset:0 lds
  v_mfma_f32_16x16x32_bf16 v[144:147], a[176:179], a[112:115], 0
  v_mfma_f32_16x16x32_bf16 v[144:147], a[180:183], a[116:119], v[144:147]
  v_mfma_f32_16x16x32_bf16 v[148:151], a[180:183], a[124:127], 0
  v_mfma_f32_16x16x32_bf16 v[148:151], a[176:179], a[120:123], v[148:151]
  s_waitcnt lgkmcnt(4)
  v_mfma_f32_16x16x32_bf16 v[152:155], a[160:163], a[96:99], 0
  ds_read_b64_tr_b16 a[176:177], v20 offset:128
  v_mfma_f32_16x16x32_bf16 v[152:155], a[164:167], a[100:103], v[152:155]
  ds_read_b64_tr_b16 a[178:179], v21 offset:128
  buffer_load_dwordx4 v2, s[20:23], s45 offen offset:1024 lds
  v_mfma_f32_16x16x32_bf16 v[156:159], a[164:167], a[108:111], 0
  ds_read_b64_tr_b16 a[180:181], v22 offset:128
  v_mfma_f32_16x16x32_bf16 v[156:159], a[160:163], a[104:107], v[156:159]
  ds_read_b64_tr_b16 a[182:183], v23 offset:128
  v_mfma_f32_16x16x32_bf16 v[160:163], a[160:163], a[112:115], 0
  v_mfma_f32_16x16x32_bf16 v[160:163], a[164:167], a[116:119], v[160:163]
  buffer_load_dwordx4 v3, s[20:23], s45 offen offset:2048 lds
  v_mfma_f32_16x16x32_bf16 v[164:167], a[164:167], a[124:127], 0
  v_mfma_f32_16x16x32_bf16 v[164:167], a[160:163], a[120:123], v[164:167]
  s_waitcnt lgkmcnt(4)
  v_mfma_f32_16x16x32_bf16 v[168:171], a[168:171], a[96:99], 0
  ds_read_b64_tr_b16 a[160:161], v20 offset:9344
  v_mfma_f32_16x16x32_bf16 v[168:171], a[172:175], a[100:103], v[168:171]
  ds_read_b64_tr_b16 a[162:163], v21 offset:9344
  v_mfma_f32_16x16x32_bf16 v[172:175], a[172:175], a[108:111], 0
  ds_read_b64_tr_b16 a[164:165], v22 offset:9344
  v_mfma_f32_16x16x32_bf16 v[172:175], a[168:171], a[104:107], v[172:175]
  ds_read_b64_tr_b16 a[166:167], v23 offset:9344
  buffer_load_dwordx4 v4, s[20:23], s45 offen offset:3072 lds
  v_mfma_f32_16x16x32_bf16 v[176:179], a[168:171], a[112:115], 0
  v_mfma_f32_16x16x32_bf16 v[176:179], a[172:175], a[116:119], v[176:179]
  v_mfma_f32_16x16x32_bf16 v[180:183], a[172:175], a[124:127], 0
  s_add_u32 m0, s44, 40960
  v_mfma_f32_16x16x32_bf16 v[180:183], a[168:171], a[120:123], v[180:183]
  s_waitcnt lgkmcnt(4)
  buffer_load_dwordx4 v5, s[20:23], s45 offen offset:0 lds
  v_mfma_f32_16x16x32_bf16 v[184:187], a[176:179], a[96:99], 0
  ds_read_b64_tr_b16 a[168:169], v20 offset:160
  v_mfma_f32_16x16x32_bf16 v[184:187], a[180:183], a[100:103], v[184:187]
  ds_read_b64_tr_b16 a[170:171], v21 offset:160
  v_mfma_f32_16x16x32_bf16 v[188:191], a[180:183], a[108:111], 0
  ds_read_b64_tr_b16 a[172:173], v22 offset:160
  v_mfma_f32_16x16x32_bf16 v[188:191], a[176:179], a[104:107], v[188:191]
  ds_read_b64_tr_b16 a[174:175], v23 offset:160
  v_mfma_f32_16x16x32_bf16 v[192:195], a[176:179], a[112:115], 0
  v_mfma_f32_16x16x32_bf16 v[192:195], a[180:183], a[116:119], v[192:195]
  buffer_load_dwordx4 v6, s[20:23], s45 offen offset:1024 lds
  v_mfma_f32_16x16x32_bf16 v[196:199], a[180:183], a[124:127], 0
  v_mfma_f32_16x16x32_bf16 v[196:199], a[176:179], a[120:123], v[196:199]
  s_waitcnt lgkmcnt(4)
  v_mfma_f32_16x16x32_bf16 v[200:203], a[160:163], a[96:99], 0
  ds_read_b64_tr_b16 a[176:177], v20 offset:9376
  v_mfma_f32_16x16x32_bf16 v[200:203], a[164:167], a[100:103], v[200:203]
  ds_read_b64_tr_b16 a[178:179], v21 offset:9376
  buffer_load_dwordx4 v7, s[20:23], s45 offen offset:2048 lds
  v_mfma_f32_16x16x32_bf16 v[204:207], a[164:167], a[108:111], 0
  ds_read_b64_tr_b16 a[180:181], v22 offset:9376
  v_mfma_f32_16x16x32_bf16 v[204:207], a[160:163], a[104:107], v[204:207]
  ds_read_b64_tr_b16 a[182:183], v23 offset:9376
  v_mfma_f32_16x16x32_bf16 v[208:211], a[160:163], a[112:115], 0
  v_mfma_f32_16x16x32_bf16 v[208:211], a[164:167], a[116:119], v[208:211]
  v_mfma_f32_16x16x32_bf16 v[212:215], a[164:167], a[124:127], 0
  v_mfma_f32_16x16x32_bf16 v[212:215], a[160:163], a[120:123], v[212:215]
  s_waitcnt lgkmcnt(4)
  buffer_load_dwordx4 v8, s[20:23], s45 offen offset:3072 lds
  v_mfma_f32_16x16x32_bf16 v[216:219], a[168:171], a[96:99], 0
  ds_read_b64_tr_b16 a[160:161], v20 offset:192
  v_mfma_f32_16x16x32_bf16 v[216:219], a[172:175], a[100:103], v[216:219]
  ds_read_b64_tr_b16 a[162:163], v21 offset:192
  v_mfma_f32_16x16x32_bf16 v[220:223], a[172:175], a[108:111], 0
  ds_read_b64_tr_b16 a[164:165], v22 offset:192
  s_add_u32 m0, s44, 45056
  v_mfma_f32_16x16x32_bf16 v[220:223], a[168:171], a[104:107], v[220:223]
  ds_read_b64_tr_b16 a[166:167], v23 offset:192
  buffer_load_dwordx4 v9, s[20:23], s45 offen offset:0 lds
  v_mfma_f32_16x16x32_bf16 v[224:227], a[168:171], a[112:115], 0
  v_mfma_f32_16x16x32_bf16 v[224:227], a[172:175], a[116:119], v[224:227]
  v_mfma_f32_16x16x32_bf16 v[228:231], a[172:175], a[124:127], 0
  v_mfma_f32_16x16x32_bf16 v[228:231], a[168:171], a[120:123], v[228:231]
  s_waitcnt lgkmcnt(4)
  v_mfma_f32_16x16x32_bf16 v[232:235], a[176:179], a[96:99], 0
  ds_read_b64_tr_b16 a[168:169], v20 offset:9408
  v_mfma_f32_16x16x32_bf16 v[232:235], a[180:183], a[100:103], v[232:235]
  ds_read_b64_tr_b16 a[170:171], v21 offset:9408
  v_mfma_f32_16x16x32_bf16 v[236:239], a[180:183], a[108:111], 0
  ds_read_b64_tr_b16 a[172:173], v22 offset:9408
  v_mfma_f32_16x16x32_bf16 v[236:239], a[176:179], a[104:107], v[236:239]
  ds_read_b64_tr_b16 a[174:175], v23 offset:9408
  v_mfma_f32_16x16x32_bf16 v[240:243], a[176:179], a[112:115], 0
  v_mfma_f32_16x16x32_bf16 v[240:243], a[180:183], a[116:119], v[240:243]
  v_mfma_f32_16x16x32_bf16 v[244:247], a[180:183], a[124:127], 0
  v_mfma_f32_16x16x32_bf16 v[244:247], a[176:179], a[120:123], v[244:247]
  s_waitcnt lgkmcnt(4)
  v_mfma_f32_16x16x32_bf16 a[0:3], a[160:163], a[96:99], 0
  ds_read_b64_tr_b16 a[176:177], v20 offset:224
  v_mfma_f32_16x16x32_bf16 a[0:3], a[164:167], a[100:103], a[0:3]
  ds_read_b64_tr_b16 a[178:179], v21 offset:224
  v_mfma_f32_16x16x32_bf16 a[4:7], a[164:167], a[108:111], 0
  ds_read_b64_tr_b16 a[180:181], v22 offset:224
  v_mfma_f32_16x16x32_bf16 a[4:7], a[160:163], a[104:107], a[4:7]
  ds_read_b64_tr_b16 a[182:183], v23 offset:224
  v_mfma_f32_16x16x32_bf16 a[8:11], a[160:163], a[112:115], 0
  v_mfma_f32_16x16x32_bf16 a[8:11], a[164:167], a[116:119], a[8:11]
  v_mfma_f32_16x16x32_bf16 a[12:15], a[164:167], a[124:127], 0
  v_mfma_f32_16x16x32_bf16 a[12:15], a[160:163], a[120:123], a[12:15]
  s_waitcnt lgkmcnt(4)
  s_mov_b32 s63, 1769472
  v_mfma_f32_16x16x32_bf16 a[16:19], a[168:171], a[96:99], 0
  ds_read_b64_tr_b16 a[160:161], v20 offset:9440
  buffer_load_dword v252, v248, s[20:23], s63 offen
  v_mfma_f32_16x16x32_bf16 a[16:19], a[172:175], a[100:103], a[16:19]
  ds_read_b64_tr_b16 a[162:163], v21 offset:9440
  v_mfma_f32_16x16x32_bf16 a[20:23], a[172:175], a[108:111], 0
  ds_read_b64_tr_b16 a[164:165], v22 offset:9440
  v_mfma_f32_16x16x32_bf16 a[20:23], a[168:171], a[104:107], a[20:23]
  ds_read_b64_tr_b16 a[166:167], v23 offset:9440
  s_mov_b32 s63, 384
  v_mfma_f32_16x16x32_bf16 a[24:27], a[168:171], a[112:115], 0
  buffer_load_dword v252, v249, s[16:19], s63 offen
  v_mfma_f32_16x16x32_bf16 a[24:27], a[172:175], a[116:119], a[24:27]
  v_mfma_f32_16x16x32_bf16 a[28:31], a[172:175], a[124:127], 0
  v_mfma_f32_16x16x32_bf16 a[28:31], a[168:171], a[120:123], a[28:31]
  s_waitcnt lgkmcnt(4)
  s_mov_b32 s63, 512
  v_mfma_f32_16x16x32_bf16 a[32:35], a[176:179], a[96:99], 0
  ds_read_b64_tr_b16 a[168:169], v20 offset:256
  buffer_load_dword v252, v249, s[16:19], s63 offen
  v_mfma_f32_16x16x32_bf16 a[32:35], a[180:183], a[100:103], a[32:35]
  ds_read_b64_tr_b16 a[170:171], v21 offset:256
  v_mfma_f32_16x16x32_bf16 a[36:39], a[180:183], a[108:111], 0
  ds_read_b64_tr_b16 a[172:173], v22 offset:256
  v_mfma_f32_16x16x32_bf16 a[36:39], a[176:179], a[104:107], a[36:39]
  ds_read_b64_tr_b16 a[174:175], v23 offset:256
  v_mfma_f32_16x16x32_bf16 a[40:43], a[176:179], a[112:115], 0
  v_mfma_f32_16x16x32_bf16 a[40:43], a[180:183], a[116:119], a[40:43]
  s_lshl_b32 s62, s33, 3
  s_add_u32 s62, s62, s31
  s_mul_i32 s62, s62, 196608
  s_add_u32 s62, s62, 20971520
  v_mov_b32 v50, s62
  s_mov_b32 s62, 42467328
  v_writelane_b32 v50, s62, 1
  v_mov_b32 v51, 2130706432
  v_cmp_gt_u32 vcc, 2, v0
  s_nop 1
  v_cndmask_b32 v50, v51, v50, vcc
  v_mfma_f32_16x16x32_bf16 a[44:47], a[180:183], a[124:127], 0
  buffer_load_dword v252, v50, s[24:27], 0 offen
  v_mfma_f32_16x16x32_bf16 a[44:47], a[176:179], a[120:123], a[44:47]
  s_waitcnt lgkmcnt(4)
  v_mfma_f32_16x16x32_bf16 a[48:51], a[160:163], a[96:99], 0
  ds_read_b64_tr_b16 a[176:177], v20 offset:9472
  v_mfma_f32_16x16x32_bf16 a[48:51], a[164:167], a[100:103], a[48:51]
  ds_read_b64_tr_b16 a[178:179], v21 offset:9472
  s_mul_i32 s62, s33, 294912
  v_mov_b32 v50, s62
  v_cmp_gt_u32 vcc, 1, v0
  s_nop 1
  v_cndmask_b32 v50, v51, v50, vcc
  v_mfma_f32_16x16x32_bf16 a[52:55], a[164:167], a[108:111], 0
  ds_read_b64_tr_b16 a[180:181], v22 offset:9472
  buffer_load_dword v252, v50, s[96:99], 0 offen
  v_mfma_f32_16x16x32_bf16 a[52:55], a[160:163], a[104:107], a[52:55]
  ds_read_b64_tr_b16 a[182:183], v23 offset:9472
  v_mfma_f32_16x16x32_bf16 a[56:59], a[160:163], a[112:115], 0
  v_mfma_f32_16x16x32_bf16 a[56:59], a[164:167], a[116:119], a[56:59]
  v_mfma_f32_16x16x32_bf16 a[60:63], a[164:167], a[124:127], 0
  v_mfma_f32_16x16x32_bf16 a[60:63], a[160:163], a[120:123], a[60:63]
  s_waitcnt vmcnt(5) lgkmcnt(0)
  s_barrier
  v_add_u32 v20, 102400, v18
  v_add_u32 v21, 102400, v19
  v_add_u32 v22, 120832, v18
  v_add_u32 v23, 120832, v19
  v_mfma_f32_16x16x32_bf16 a[64:67], a[168:171], a[96:99], 0
  ds_read_b64_tr_b16 a[160:161], v20 offset:0
  v_mfma_f32_16x16x32_bf16 a[64:67], a[172:175], a[100:103], a[64:67]
  ds_read_b64_tr_b16 a[162:163], v21 offset:0
  v_mfma_f32_16x16x32_bf16 a[68:71], a[172:175], a[108:111], 0
  ds_read_b64_tr_b16 a[164:165], v22 offset:0
  v_mfma_f32_16x16x32_bf16 a[68:71], a[168:171], a[104:107], a[68:71]
  ds_read_b64_tr_b16 a[166:167], v23 offset:0
  v_mfma_f32_16x16x32_bf16 a[72:75], a[168:171], a[112:115], 0
  ds_read_b128 a[128:131], v24 offset:32768
  v_mfma_f32_16x16x32_bf16 a[72:75], a[172:175], a[116:119], a[72:75]
  ds_read_b128 a[132:135], v25 offset:32768
  v_mfma_f32_16x16x32_bf16 a[76:79], a[172:175], a[124:127], 0
  ds_read_b128 a[136:139], v24 offset:34816
  v_mfma_f32_16x16x32_bf16 a[76:79], a[168:171], a[120:123], a[76:79]
  ds_read_b128 a[140:143], v25 offset:34816
  v_mfma_f32_16x16x32_bf16 a[80:83], a[176:179], a[96:99], 0
  ds_read_b128 a[144:147], v24 offset:36864
  v_mfma_f32_16x16x32_bf16 a[80:83], a[180:183], a[100:103], a[80:83]
  ds_read_b128 a[148:151], v25 offset:36864
  v_mfma_f32_16x16x32_bf16 a[84:87], a[180:183], a[108:111], 0
  ds_read_b128 a[152:155], v24 offset:38912
  v_mfma_f32_16x16x32_bf16 a[84:87], a[176:179], a[104:107], a[84:87]
  ds_read_b128 a[156:159], v25 offset:38912
  v_mfma_f32_16x16x32_bf16 a[88:91], a[176:179], a[112:115], 0
  ds_read_b64_tr_b16 a[168:169], v20 offset:9216
  v_mfma_f32_16x16x32_bf16 a[88:91], a[180:183], a[116:119], a[88:91]
  ds_read_b64_tr_b16 a[170:171], v21 offset:9216
  v_mfma_f32_16x16x32_bf16 a[92:95], a[180:183], a[124:127], 0
  ds_read_b64_tr_b16 a[172:173], v22 offset:9216
  v_mfma_f32_16x16x32_bf16 a[92:95], a[176:179], a[120:123], a[92:95]
  ds_read_b64_tr_b16 a[174:175], v23 offset:9216
L_slab1:
  s_waitcnt lgkmcnt(4)
  v_mfma_f32_16x16x32_bf16 v[56:59], a[160:163], a[128:131], v[56:59]
  ds_read_b64_tr_b16 a[176:177], v20 offset:32
  v_mfma_f32_16x16x32_bf16 v[56:59], a[164:167], a[132:135], v[56:59]
  ds_read_b64_tr_b16 a[178:179], v21 offset:32
  v_mfma_f32_16x16x32_bf16 v[60:63], a[164:167], a[140:143], v[60:63]
  ds_read_b64_tr_b16 a[180:181], v22 offset:32
  v_mfma_f32_16x16x32_bf16 v[60:63], a[160:163], a[136:139], v[60:63]
  ds_read_b64_tr_b16 a[182:183], v23 offset:32
  v_mfma_f32_16x16x32_bf16 v[64:67], a[160:163], a[144:147], v[64:67]
  s_mul_i32 s45, s29, 0
  s_add_u32 s45, s45, s37
  s_add_u32 s45, s45, 1179648
  s_mul_i32 s44, s29, -73728
  s_add_u32 s44, s44, s39
  s_add_u32 m0, s44, 73728
  v_mfma_f32_16x16x32_bf16 v[64:67], a[164:167], a[148:151], v[64:67]
  buffer_load_dwordx4 v1, s[20:23], s45 offen offset:0 lds
  v_mfma_f32_16x16x32_bf16 v[68:71], a[164:167], a[156:159], v[68:71]
  v_mfma_f32_16x16x32_bf16 v[68:71], a[160:163], a[152:155], v[68:71]
  s_waitcnt lgkmcnt(4)
  buffer_load_dwordx4 v2, s[20:23], s45 offen offset:1024 lds
  v_mfma_f32_16x16x32_bf16 v[72:75], a[168:171], a[128:131], v[72:75]
  ds_read_b64_tr_b16 a[160:161], v20 offset:9248
  v_mfma_f32_16x16x32_bf16 v[72:75], a[172:175], a[132:135], v[72:75]
  ds_read_b64_tr_b16 a[162:163], v21 offset:9248
  v_mfma_f32_16x16x32_bf16 v[76:79], a[172:175], a[140:143], v[76:79]
  ds_read_b64_tr_b16 a[164:165], v22 offset:9248
  v_mfma_f32_16x16x32_bf16 v[76:79], a[168:171], a[136:139], v[76:79]
  ds_read_b64_tr_b16 a[166:167], v23 offset:9248
  v_mfma_f32_16x16x32_bf16 v[80:83], a[168:171], a[144:147], v[80:83]
  v_mfma_f32_16x16x32_bf16 v[80:83], a[172:175], a[148:151], v[80:83]
  buffer_load_dwordx4 v3, s[20:23], s45 offen offset:2048 lds
  v_mfma_f32_16x16x32_bf16 v[84:87], a[172:175], a[156:159], v[84:87]
  v_mfma_f32_16x16x32_bf16 v[84:87], a[168:171], a[152:155], v[84:87]
  s_waitcnt lgkmcnt(4)
  buffer_load_dwordx4 v4, s[20:23], s45 offen offset:3072 lds
  v_mfma_f32_16x16x32_bf16 v[88:91], a[176:179], a[128:131], v[88:91]
  ds_read_b64_tr_b16 a[168:169], v20 offset:64
  v_mfma_f32_16x16x32_bf16 v[88:91], a[180:183], a[132:135], v[88:91]
  ds_read_b64_tr_b16 a[170:171], v21 offset:64
  v_mfma_f32_16x16x32_bf16 v[92:95], a[180:183], a[140:143], v[92:95]
  ds_read_b64_tr_b16 a[172:173], v22 offset:64
  v_mfma_f32_16x16x32_bf16 v[92:95], a[176:179], a[136:139], v[92:95]
  ds_read_b64_tr_b16 a[174:175], v23 offset:64
  v_mfma_f32_16x16x32_bf16 v[96:99], a[176:179], a[144:147], v[96:99]
  s_add_u32 m0, s44, 77824
  v_mfma_f32_16x16x32_bf16 v[96:99], a[180:183], a[148:151], v[96:99]
  buffer_load_dwordx4 v5, s[20:23], s45 offen offset:0 lds
  v_mfma_f32_16x16x32_bf16 v[100:103], a[180:183], a[156:159], v[100:103]
  v_mfma_f32_16x16x32_bf16 v[100:103], a[176:179], a[152:155], v[100:103]
  s_waitcnt lgkmcnt(4)
  buffer_load_dwordx4 v6, s[20:23], s45 offen offset:1024 lds
  v_mfma_f32_16x16x32_bf16 v[104:107], a[160:163], a[128:131], v[104:107]
  ds_read_b64_tr_b16 a[176:177], v20 offset:9280
  v_mfma_f32_16x16x32_bf16 v[104:107], a[164:167], a[132:135], v[104:107]
  ds_read_b64_tr_b16 a[178:179], v21 offset:9280
  v_mfma_f32_16x16x32_bf16 v[108:111], a[164:167], a[140:143], v[108:111]
  ds_read_b64_tr_b16 a[180:181], v22 offset:9280
  v_mfma_f32_16x16x32_bf16 v[108:111], a[160:163], a[136:139], v[108:111]
  ds_read_b64_tr_b16 a[182:183], v23 offset:9280
  v_mfma_f32_16x16x32_bf16 v[112:115], a[160:163], a[144:147], v[112:115]
  v_mfma_f32_16x16x32_bf16 v[112:115], a[164:167], a[148:151], v[112:115]
  buffer_load_dwordx4 v7, s[20:23], s45 offen offset:2048 lds
  v_mfma_f32_16x16x32_bf16 v[116:119], a[164:167], a[156:159], v[116:119]
  v_mfma_f32_16x16x32_bf16 v[116:119], a[160:163], a[152:155], v[116:119]
  s_waitcnt lgkmcnt(4)
  buffer_load_dwordx4 v8, s[20:23], s45 offen offset:3072 lds
  v_mfma_f32_16x16x32_bf16 v[120:123], a[168:171], a[128:131], v[120:123]
  ds_read_b64_tr_b16 a[160:161], v20 offset:96
  v_mfma_f32_16x16x32_bf16 v[120:123], a[172:175], a[132:135], v[120:123]
  ds_read_b64_tr_b16 a[162:163], v21 offset:96
  v_mfma_f32_16x16x32_bf16 v[124:127], a[172:175], a[140:143], v[124:127]
  ds_read_b64_tr_b16 a[164:165], v22 offset:96
  v_mfma_f32_16x16x32_bf16 v[124:127], a[168:171], a[136:139], v[124:127]
  ds_read_b64_tr_b16 a[166:167], v23 offset:96
  v_mfma_f32_16x16x32_bf16 v[128:131], a[168:171], a[144:147], v[128:131]
  s_add_u32 m0, s44, 81920
  v_mfma_f32_16x16x32_bf16 v[128:131], a[172:175], a[148:151], v[128:131]
  buffer_load_dwordx4 v9, s[20:23], s45 offen offset:0 lds
  v_mfma_f32_16x16x32_bf16 v[132:135], a[172:175], a[156:159], v[132:135]
  s_add_u32 s43, s36, 256
  s_add_u32 m0, s38, 0
  v_mfma_f32_16x16x32_bf16 v[132:135], a[168:171], a[152:155], v[132:135]
  s_waitcnt lgkmcnt(4)
  buffer_load_dwordx4 v10, s[16:19], s43 offen offset:0 lds
  v_mfma_f32_16x16x32_bf16 v[136:139], a[176:179], a[128:131], v[136:139]
  ds_read_b64_tr_b16 a[168:169], v20 offset:9312
  v_mfma_f32_16x16x32_bf16 v[136:139], a[180:183], a[132:135], v[136:139]
  ds_read_b64_tr_b16 a[170:171], v21 offset:9312
  v_mfma_f32_16x16x32_bf16 v[140:143], a[180:183], a[140:143], v[140:143]
  ds_read_b64_tr_b16 a[172:173], v22 offset:9312
  v_mfma_f32_16x16x32_bf16 v[140:143], a[176:179], a[136:139], v[140:143]
  ds_read_b64_tr_b16 a[174:175], v23 offset:9312
  v_mfma_f32_16x16x32_bf16 v[144:147], a[176:179], a[144:147], v[144:147]
  v_mfma_f32_16x16x32_bf16 v[144:147], a[180:183], a[148:151], v[144:147]
  buffer_load_dwordx4 v11, s[16:19], s43 offen offset:1024 lds
  v_mfma_f32_16x16x32_bf16 v[148:151], a[180:183], a[156:159], v[148:151]
  v_mfma_f32_16x16x32_bf16 v[148:151], a[176:179], a[152:155], v[148:151]
  s_waitcnt lgkmcnt(4)
  buffer_load_dwordx4 v12, s[16:19], s43 offen offset:2048 lds
  v_mfma_f32_16x16x32_bf16 v[152:155], a[160:163], a[128:131], v[152:155]
  ds_read_b64_tr_b16 a[176:177], v20 offset:128
  v_mfma_f32_16x16x32_bf16 v[152:155], a[164:167], a[132:135], v[152:155]
  ds_read_b64_tr_b16 a[178:179], v21 offset:128
  v_mfma_f32_16x16x32_bf16 v[156:159], a[164:167], a[140:143], v[156:159]
  ds_read_b64_tr_b16 a[180:181], v22 offset:128
  v_mfma_f32_16x16x32_bf16 v[156:159], a[160:163], a[136:139], v[156:159]
  ds_read_b64_tr_b16 a[182:183], v23 offset:128
  v_mfma_f32_16x16x32_bf16 v[160:163], a[160:163], a[144:147], v[160:163]
  v_mfma_f32_16x16x32_bf16 v[160:163], a[164:167], a[148:151], v[160:163]
  buffer_load_dwordx4 v13, s[16:19], s43 offen offset:3072 lds
  v_mfma_f32_16x16x32_bf16 v[164:167], a[164:167], a[156:159], v[164:167]
  s_add_u32 m0, s38, 4096
  v_mfma_f32_16x16x32_bf16 v[164:167], a[160:163], a[152:155], v[164:167]
  s_waitcnt lgkmcnt(4)
  buffer_load_dwordx4 v14, s[16:19], s43 offen offset:0 lds
  v_mfma_f32_16x16x32_bf16 v[168:171], a[168:171], a[128:131], v[168:171]
  ds_read_b64_tr_b16 a[160:161], v20 offset:9344
  v_mfma_f32_16x16x32_bf16 v[168:171], a[172:175], a[132:135], v[168:171]
  ds_read_b64_tr_b16 a[162:163], v21 offset:9344
  v_mfma_f32_16x16x32_bf16 v[172:175], a[172:175], a[140:143], v[172:175]
  ds_read_b64_tr_b16 a[164:165], v22 offset:9344
  v_mfma_f32_16x16x32_bf16 v[172:175], a[168:171], a[136:139], v[172:175]
  ds_read_b64_tr_b16 a[166:167], v23 offset:9344
  v_mfma_f32_16x16x32_bf16 v[176:179], a[168:171], a[144:147], v[176:179]
  v_mfma_f32_16x16x32_bf16 v[176:179], a[172:175], a[148:151], v[176:179]
  buffer_load_dwordx4 v15, s[16:19], s43 offen offset:1024 lds
  v_mfma_f32_16x16x32_bf16 v[180:183], a[172:175], a[156:159], v[180:183]
  v_mfma_f32_16x16x32_bf16 v[180:183], a[168:171], a[152:155], v[180:183]
  s_waitcnt lgkmcnt(4)
  buffer_load_dwordx4 v16, s[16:19], s43 offen offset:2048 lds
  v_mfma_f32_16x16x32_bf16 v[184:187], a[176:179], a[128:131], v[184:187]
  ds_read_b64_tr_b16 a[168:169], v20 offset:160
  v_mfma_f32_16x16x32_bf16 v[184:187], a[180:183], a[132:135], v[184:187]
  ds_read_b64_tr_b16 a[170:171], v21 offset:160
  v_mfma_f32_16x16x32_bf16 v[188:191], a[180:183], a[140:143], v[188:191]
  ds_read_b64_tr_b16 a[172:173], v22 offset:160
  v_mfma_f32_16x16x32_bf16 v[188:191], a[176:179], a[136:139], v[188:191]
  ds_read_b64_tr_b16 a[174:175], v23 offset:160
  v_mfma_f32_16x16x32_bf16 v[192:195], a[176:179], a[144:147], v[192:195]
  v_mfma_f32_16x16x32_bf16 v[192:195], a[180:183], a[148:151], v[192:195]
  buffer_load_dwordx4 v17, s[16:19], s43 offen offset:3072 lds
  v_mfma_f32_16x16x32_bf16 v[196:199], a[180:183], a[156:159], v[196:199]
  s_add_u32 s43, s36, 384
  s_add_u32 m0, s38, 32768
  v_mfma_f32_16x16x32_bf16 v[196:199], a[176:179], a[152:155], v[196:199]
  s_waitcnt lgkmcnt(4)
  buffer_load_dwordx4 v10, s[16:19], s43 offen offset:0 lds
  v_mfma_f32_16x16x32_bf16 v[200:203], a[160:163], a[128:131], v[200:203]
  ds_read_b64_tr_b16 a[176:177], v20 offset:9376
  v_mfma_f32_16x16x32_bf16 v[200:203], a[164:167], a[132:135], v[200:203]
  ds_read_b64_tr_b16 a[178:179], v21 offset:9376
  v_mfma_f32_16x16x32_bf16 v[204:207], a[164:167], a[140:143], v[204:207]
  ds_read_b64_tr_b16 a[180:181], v22 offset:9376
  v_mfma_f32_16x16x32_bf16 v[204:207], a[160:163], a[136:139], v[204:207]
  ds_read_b64_tr_b16 a[182:183], v23 offset:9376
  v_mfma_f32_16x16x32_bf16 v[208:211], a[160:163], a[144:147], v[208:211]
  v_mfma_f32_16x16x32_bf16 v[208:211], a[164:167], a[148:151], v[208:211]
  buffer_load_dwordx4 v11, s[16:19], s43 offen offset:1024 lds
  v_mfma_f32_16x16x32_bf16 v[212:215], a[164:167], a[156:159], v[212:215]
  v_mfma_f32_16x16x32_bf16 v[212:215], a[160:163], a[152:155], v[212:215]
  s_waitcnt lgkmcnt(4)
  buffer_load_dwordx4 v12, s[16:19], s43 offen offset:2048 lds
  v_mfma_f32_16x16x32_bf16 v[216:219], a[168:171], a[128:131], v[216:219]
  ds_read_b64_tr_b16 a[160:161], v20 offset:192
  v_mfma_f32_16x16x32_bf16 v[216:219], a[172:175], a[132:135], v[216:219]
  ds_read_b64_tr_b16 a[162:163], v21 offset:192
  v_mfma_f32_16x16x32_bf16 v[220:223], a[172:175], a[140:143], v[220:223]
  ds_read_b64_tr_b16 a[164:165], v22 offset:192
  v_mfma_f32_16x16x32_bf16 v[220:223], a[168:171], a[136:139], v[220:223]
  ds_read_b64_tr_b16 a[166:167], v23 offset:192
  v_mfma_f32_16x16x32_bf16 v[224:227], a[168:171], a[144:147], v[224:227]
  v_mfma_f32_16x16x32_bf16 v[224:227], a[172:175], a[148:151], v[224:227]
  buffer_load_dwordx4 v13, s[16:19], s43 offen offset:3072 lds
  v_mfma_f32_16x16x32_bf16 v[228:231], a[172:175], a[156:159], v[228:231]
  s_add_u32 m0, s38, 36864
  v_mfma_f32_16x16x32_bf16 v[228:231], a[168:171], a[152:155], v[228:231]
  s_waitcnt lgkmcnt(4)
  buffer_load_dwordx4 v14, s[16:19], s43 offen offset:0 lds
  v_mfma_f32_16x16x32_bf16 v[232:235], a[176:179], a[128:131], v[232:235]
  ds_read_b64_tr_b16 a[168:169], v20 offset:9408
  v_mfma_f32_16x16x32_bf16 v[232:235], a[180:183], a[132:135], v[232:235]
  ds_read_b64_tr_b16 a[170:171], v21 offset:9408
  v_mfma_f32_16x16x32_bf16 v[236:239], a[180:183], a[140:143], v[236:239]
  ds_read_b64_tr_b16 a[172:173], v22 offset:9408
  v_mfma_f32_16x16x32_bf16 v[236:239], a[176:179], a[136:139], v[236:239]
  ds_read_b64_tr_b16 a[174:175], v23 offset:9408
  v_mfma_f32_16x16x32_bf16 v[240:243], a[176:179], a[144:147], v[240:243]
  v_mfma_f32_16x16x32_bf16 v[240:243], a[180:183], a[148:151], v[240:243]
  buffer_load_dwordx4 v15, s[16:19], s43 offen offset:1024 lds
  v_mfma_f32_16x16x32_bf16 v[244:247], a[180:183], a[156:159], v[244:247]
  v_mfma_f32_16x16x32_bf16 v[244:247], a[176:179], a[152:155], v[244:247]
  s_waitcnt lgkmcnt(4)
  buffer_load_dwordx4 v16, s[16:19], s43 offen offset:2048 lds
  v_mfma_f32_16x16x32_bf16 a[0:3], a[160:163], a[128:131], a[0:3]
  ds_read_b64_tr_b16 a[176:177], v20 offset:224
  v_mfma_f32_16x16x32_bf16 a[0:3], a[164:167], a[132:135], a[0:3]
  ds_read_b64_tr_b16 a[178:179], v21 offset:224
  v_mfma_f32_16x16x32_bf16 a[4:7], a[164:167], a[140:143], a[4:7]
  ds_read_b64_tr_b16 a[180:181], v22 offset:224
  v_mfma_f32_16x16x32_bf16 a[4:7], a[160:163], a[136:139], a[4:7]
  ds_read_b64_tr_b16 a[182:183], v23 offset:224
  v_mfma_f32_16x16x32_bf16 a[8:11], a[160:163], a[144:147], a[8:11]
  v_mfma_f32_16x16x32_bf16 a[8:11], a[164:167], a[148:151], a[8:11]
  buffer_load_dwordx4 v17, s[16:19], s43 offen offset:3072 lds
  v_mfma_f32_16x16x32_bf16 a[12:15], a[164:167], a[156:159], a[12:15]
  v_mfma_f32_16x16x32_bf16 a[12:15], a[160:163], a[152:155], a[12:15]
  s_waitcnt lgkmcnt(4)
  v_mfma_f32_16x16x32_bf16 a[16:19], a[168:171], a[128:131], a[16:19]
  ds_read_b64_tr_b16 a[160:161], v20 offset:9440
  v_mfma_f32_16x16x32_bf16 a[16:19], a[172:175], a[132:135], a[16:19]
  ds_read_b64_tr_b16 a[162:163], v21 offset:9440
  v_mfma_f32_16x16x32_bf16 a[20:23], a[172:175], a[140:143], a[20:23]
  ds_read_b64_tr_b16 a[164:165], v22 offset:9440
  v_mfma_f32_16x16x32_bf16 a[20:23], a[168:171], a[136:139], a[20:23]
  ds_read_b64_tr_b16 a[166:167], v23 offset:9440
  v_mfma_f32_16x16x32_bf16 a[24:27], a[168:171], a[144:147], a[24:27]
  s_mov_b32 s63, 2359296
  v_mfma_f32_16x16x32_bf16 a[24:27], a[172:175], a[148:151], a[24:27]
  buffer_load_dword v252, v248, s[20:23], s63 offen
  v_mfma_f32_16x16x32_bf16 a[28:31], a[172:175], a[156:159], a[28:31]
  s_mov_b32 s63, 640
  v_mfma_f32_16x16x32_bf16 a[28:31], a[168:171], a[152:155], a[28:31]
  s_waitcnt lgkmcnt(4)
  buffer_load_dword v252, v249, s[16:19], s63 offen
  v_mfma_f32_16x16x32_bf16 a[32:35], a[176:179], a[128:131], a[32:35]
  ds_read_b64_tr_b16 a[168:169], v20 offset:256
  v_mfma_f32_16x16x32_bf16 a[32:35], a[180:183], a[132:135], a[32:35]
  ds_read_b64_tr_b16 a[170:171], v21 offset:256
  v_mfma_f32_16x16x32_bf16 a[36:39], a[180:183], a[140:143], a[36:39]
  ds_read_b64_tr_b16 a[172:173], v22 offset:256
  v_mfma_f32_16x16x32_bf16 a[36:39], a[176:179], a[136:139], a[36:39]
  ds_read_b64_tr_b16 a[174:175], v23 offset:256
  v_mfma_f32_16x16x32_bf16 a[40:43], a[176:179], a[144:147], a[40:43]
  v_mfma_f32_16x16x32_bf16 a[40:43], a[180:183], a[148:151], a[40:43]
  buffer_load_dword v252, v55, s[68:71], 0 offen
  v_mfma_f32_16x16x32_bf16 a[44:47], a[180:183], a[156:159], a[44:47]
  v_mfma_f32_16x16x32_bf16 a[44:47], a[176:179], a[152:155], a[44:47]
  s_waitcnt lgkmcnt(4)
  v_mfma_f32_16x16x32_bf16 a[48:51], a[160:163], a[128:131], a[48:51]
  ds_read_b64_tr_b16 a[176:177], v20 offset:9472
  v_mfma_f32_16x16x32_bf16 a[48:51], a[164:167], a[132:135], a[48:51]
  ds_read_b64_tr_b16 a[178:179], v21 offset:9472
  v_mfma_f32_16x16x32_bf16 a[52:55], a[164:167], a[140:143], a[52:55]
  ds_read_b64_tr_b16 a[180:181], v22 offset:9472
  s_cmp_lg_u32 s28, 0
  s_cbranch_scc1 L_n1
  buffer_load_dword v253, v254, s[56:59], 0 offen
L_n1:
  v_mfma_f32_16x16x32_bf16 a[52:55], a[160:163], a[136:139], a[52:55]
  ds_read_b64_tr_b16 a[182:183], v23 offset:9472
  v_mfma_f32_16x16x32_bf16 a[56:59], a[160:163], a[144:147], a[56:59]
  v_mfma_f32_16x16x32_bf16 a[56:59], a[164:167], a[148:151], a[56:59]
  v_mfma_f32_16x16x32_bf16 a[60:63], a[164:167], a[156:159], a[60:63]
  v_mfma_f32_16x16x32_bf16 a[60:63], a[160:163], a[152:155], a[60:63]
  s_waitcnt vmcnt(11) lgkmcnt(0)
  s_barrier
  v_add_u32 v20, 139264, v18
  v_add_u32 v21, 139264, v19
  v_add_u32 v22, 65536, v18
  v_add_u32 v23, 65536, v19
  v_mfma_f32_16x16x32_bf16 a[64:67], a[168:171], a[128:131], a[64:67]
  ds_read_b64_tr_b16 a[160:161], v20 offset:0
  v_mfma_f32_16x16x32_bf16 a[64:67], a[172:175], a[132:135], a[64:67]
  ds_read_b64_tr_b16 a[162:163], v21 offset:0
  v_mfma_f32_16x16x32_bf16 a[68:71], a[172:175], a[140:143], a[68:71]
  ds_read_b64_tr_b16 a[164:165], v22 offset:0
  v_mfma_f32_16x16x32_bf16 a[68:71], a[168:171], a[136:139], a[68:71]
  ds_read_b64_tr_b16 a[166:167], v23 offset:0
  v_mfma_f32_16x16x32_bf16 a[72:75], a[168:171], a[144:147], a[72:75]
  ds_read_b128 a[96:99], v24 offset:0
  v_mfma_f32_16x16x32_bf16 a[72:75], a[172:175], a[148:151], a[72:75]
  ds_read_b128 a[100:103], v25 offset:0
  v_mfma_f32_16x16x32_bf16 a[76:79], a[172:175], a[156:159], a[76:79]
  ds_read_b128 a[104:107], v24 offset:2048
  v_mfma_f32_16x16x32_bf16 a[76:79], a[168:171], a[152:155], a[76:79]
  ds_read_b128 a[108:111], v25 offset:2048
  v_mfma_f32_16x16x32_bf16 a[80:83], a[176:179], a[128:131], a[80:83]
  ds_read_b128 a[112:115], v24 offset:4096
  v_mfma_f32_16x16x32_bf16 a[80:83], a[180:183], a[132:135], a[80:83]
  ds_read_b128 a[116:119], v25 offset:4096
  v_mfma_f32_16x16x32_bf16 a[84:87], a[180:183], a[140:143], a[84:87]
  ds_read_b128 a[120:123], v24 offset:6144
  v_mfma_f32_16x16x32_bf16 a[84:87], a[176:179], a[136:139], a[84:87]
  ds_read_b128 a[124:127], v25 offset:6144
  v_mfma_f32_16x16x32_bf16 a[88:91], a[176:179], a[144:147], a[88:91]
  ds_read_b64_tr_b16 a[168:169], v20 offset:9216
  v_mfma_f32_16x16x32_bf16 a[88:91], a[180:183], a[148:151], a[88:91]
  ds_read_b64_tr_b16 a[170:171], v21 offset:9216
  v_mfma_f32_16x16x32_bf16 a[92:95], a[180:183], a[156:159], a[92:95]
  ds_read_b64_tr_b16 a[172:173], v22 offset:9216
  v_mfma_f32_16x16x32_bf16 a[92:95], a[176:179], a[152:155], a[92:95]
  ds_read_b64_tr_b16 a[174:175], v23 offset:9216
L_slab2:
  s_waitcnt lgkmcnt(4)
  v_mfma_f32_16x16x32_bf16 v[56:59], a[160:163], a[96:99], v[56:59]
  ds_read_b64_tr_b16 a[176:177], v20 offset:32
  v_mfma_f32_16x16x32_bf16 v[56:59], a[164:167], a[100:103], v[56:59]
  ds_read_b64_tr_b16 a[178:179], v21 offset:32
  v_mfma_f32_16x16x32_bf16 v[60:63], a[164:167], a[108:111], v[60:63]
  ds_read_b64_tr_b16 a[180:181], v22 offset:32
  v_mfma_f32_16x16x32_bf16 v[60:63], a[160:163], a[104:107], v[60:63]
  ds_read_b64_tr_b16 a[182:183], v23 offset:32
  v_mfma_f32_16x16x32_bf16 v[64:67], a[160:163], a[112:115], v[64:67]
  s_mul_i32 s45, s29, 0
  s_add_u32 s45, s45, s37
  s_add_u32 s45, s45, 1769472
  s_mul_i32 s44, s29, 18432
  s_add_u32 s44, s44, s39
  s_add_u32 m0, s44, 18432
  s_mul_i32 s65, s55, 16
  v_mfma_f32_16x16x32_bf16 v[64:67], a[164:167], a[116:119], v[64:67]
  buffer_load_dwordx4 v1, s[20:23], s45 offen offset:0 lds
  v_mfma_f32_16x16x32_bf16 v[68:71], a[164:167], a[124:127], v[68:71]
  s_add_u32 s65, s65, s28
  v_mfma_f32_16x16x32_bf16 v[68:71], a[160:163], a[120:123], v[68:71]
  s_waitcnt lgkmcnt(4)
  buffer_load_dwordx4 v2, s[20:23], s45 offen offset:1024 lds
  v_mfma_f32_16x16x32_bf16 v[72:75], a[168:171], a[96:99], v[72:75]
  ds_read_b64_tr_b16 a[160:161], v20 offset:9248
  v_mfma_f32_16x16x32_bf16 v[72:75], a[172:175], a[100:103], v[72:75]
  ds_read_b64_tr_b16 a[162:163], v21 offset:9248
  v_mfma_f32_16x16x32_bf16 v[76:79], a[172:175], a[108:111], v[76:79]
  ds_read_b64_tr_b16 a[164:165], v22 offset:9248
  v_mfma_f32_16x16x32_bf16 v[76:79], a[168:171], a[104:107], v[76:79]
  ds_read_b64_tr_b16 a[166:167], v23 offset:9248
  v_mfma_f32_16x16x32_bf16 v[80:83], a[168:171], a[112:115], v[80:83]
  s_lshl_b32 s65, s65, 3
  v_mfma_f32_16x16x32_bf16 v[80:83], a[172:175], a[116:119], v[80:83]
  buffer_load_dwordx4 v3, s[20:23], s45 offen offset:2048 lds
  v_mfma_f32_16x16x32_bf16 v[84:87], a[172:175], a[124:127], v[84:87]
  s_add_u32 s65, s65, s31
  v_mfma_f32_16x16x32_bf16 v[84:87], a[168:171], a[120:123], v[84:87]
  s_waitcnt lgkmcnt(4)
  buffer_load_dwordx4 v4, s[20:23], s45 offen offset:3072 lds
  v_mfma_f32_16x16x32_bf16 v[88:91], a[176:179], a[96:99], v[88:91]
  ds_read_b64_tr_b16 a[168:169], v20 offset:64
  v_mfma_f32_16x16x32_bf16 v[88:91], a[180:183], a[100:103], v[88:91]
  ds_read_b64_tr_b16 a[170:171], v21 offset:64
  v_mfma_f32_16x16x32_bf16 v[92:95], a[180:183], a[108:111], v[92:95]
  ds_read_b64_tr_b16 a[172:173], v22 offset:64
  v_mfma_f32_16x16x32_bf16 v[92:95], a[176:179], a[104:107], v[92:95]
  ds_read_b64_tr_b16 a[174:175], v23 offset:64
  v_mfma_f32_16x16x32_bf16 v[96:99], a[176:179], a[112:115], v[96:99]
  s_add_u32 m0, s44, 22528
  s_lshl_b32 s65, s65, 7
  v_mfma_f32_16x16x32_bf16 v[96:99], a[180:183], a[116:119], v[96:99]
  buffer_load_dwordx4 v5, s[20:23], s45 offen offset:0 lds
  v_mfma_f32_16x16x32_bf16 v[100:103], a[180:183], a[124:127], v[100:103]
  s_add_u32 s65, s65, 41943040
  v_mfma_f32_16x16x32_bf16 v[100:103], a[176:179], a[120:123], v[100:103]
  s_waitcnt lgkmcnt(4)
  buffer_load_dwordx4 v6, s[20:23], s45 offen offset:1024 lds
  v_mfma_f32_16x16x32_bf16 v[104:107], a[160:163], a[96:99], v[104:107]
  ds_read_b64_tr_b16 a[176:177], v20 offset:9280
  v_mfma_f32_16x16x32_bf16 v[104:107], a[164:167], a[100:103], v[104:107]
  ds_read_b64_tr_b16 a[178:179], v21 offset:9280
  v_mfma_f32_16x16x32_bf16 v[108:111], a[164:167], a[108:111], v[108:111]
  ds_read_b64_tr_b16 a[180:181], v22 offset:9280
  v_mfma_f32_16x16x32_bf16 v[108:111], a[160:163], a[104:107], v[108:111]
  ds_read_b64_tr_b16 a[182:183], v23 offset:9280
  v_mfma_f32_16x16x32_bf16 v[112:115], a[160:163], a[112:115], v[112:115]
  s_mul_i32 s66, s55, 16
  v_mfma_f32_16x16x32_bf16 v[112:115], a[164:167], a[116:119], v[112:115]
  buffer_load_dwordx4 v7, s[20:23], s45 offen offset:2048 lds
  v_mfma_f32_16x16x32_bf16 v[116:119], a[164:167], a[124:127], v[116:119]
  s_lshr_b32 s67, s31, 2
  v_mfma_f32_16x16x32_bf16 v[116:119], a[160:163], a[120:123], v[116:119]
  s_waitcnt lgkmcnt(4)
  buffer_load_dwordx4 v8, s[20:23], s45 offen offset:3072 lds
  v_mfma_f32_16x16x32_bf16 v[120:123], a[168:171], a[96:99], v[120:123]
  ds_read_b64_tr_b16 a[160:161], v20 offset:96
  v_mfma_f32_16x16x32_bf16 v[120:123], a[172:175], a[100:103], v[120:123]
  ds_read_b64_tr_b16 a[162:163], v21 offset:96
  v_mfma_f32_16x16x32_bf16 v[124:127], a[172:175], a[108:111], v[124:127]
  ds_read_b64_tr_b16 a[164:165], v22 offset:96
  v_mfma_f32_16x16x32_bf16 v[124:127], a[168:171], a[104:107], v[124:127]
  ds_read_b64_tr_b16 a[166:167], v23 offset:96
  v_mfma_f32_16x16x32_bf16 v[128:131], a[168:171], a[112:115], v[128:131]
  s_add_u32 m0, s44, 26624
  s_lshl_b32 s67, s67, 1
  v_mfma_f32_16x16x32_bf16 v[128:131], a[172:175], a[116:119], v[128:131]
  buffer_load_dwordx4 v9, s[20:23], s45 offen offset:0 lds
  v_mfma_f32_16x16x32_bf16 v[132:135], a[172:175], a[124:127], v[132:135]
  s_add_u32 s43, s36, 512
  s_add_u32 m0, s38, 0
  s_add_u32 s67, s67, s29
  v_mfma_f32_16x16x32_bf16 v[132:135], a[168:171], a[120:123], v[132:135]
  s_waitcnt lgkmcnt(4)
  buffer_load_dwordx4 v10, s[16:19], s43 offen offset:0 lds
  v_mfma_f32_16x16x32_bf16 v[136:139], a[176:179], a[96:99], v[136:139]
  ds_read_b64_tr_b16 a[168:169], v20 offset:9312
  v_mfma_f32_16x16x32_bf16 v[136:139], a[180:183], a[100:103], v[136:139]
  ds_read_b64_tr_b16 a[170:171], v21 offset:9312
  v_mfma_f32_16x16x32_bf16 v[140:143], a[180:183], a[108:111], v[140:143]
  ds_read_b64_tr_b16 a[172:173], v22 offset:9312
  v_mfma_f32_16x16x32_bf16 v[140:143], a[176:179], a[104:107], v[140:143]
  ds_read_b64_tr_b16 a[174:175], v23 offset:9312
  v_mfma_f32_16x16x32_bf16 v[144:147], a[176:179], a[112:115], v[144:147]
  s_add_u32 s66, s66, s67
  v_mfma_f32_16x16x32_bf16 v[144:147], a[180:183], a[116:119], v[144:147]
  buffer_load_dwordx4 v11, s[16:19], s43 offen offset:1024 lds
  v_mfma_f32_16x16x32_bf16 v[148:151], a[180:183], a[124:127], v[148:151]
  s_lshl_b32 s66, s66, 10
  v_mfma_f32_16x16x32_bf16 v[148:151], a[176:179], a[120:123], v[148:151]
  s_waitcnt lgkmcnt(4)
  buffer_load_dwordx4 v12, s[16:19], s43 offen offset:2048 lds
  v_mfma_f32_16x16x32_bf16 v[152:155], a[160:163], a[96:99], v[152:155]
  ds_read_b64_tr_b16 a[176:177], v20 offset:128
  v_mfma_f32_16x16x32_bf16 v[152:155], a[164:167], a[100:103], v[152:155]
  ds_read_b64_tr_b16 a[178:179], v21 offset:128
  v_mfma_f32_16x16x32_bf16 v[156:159], a[164:167], a[108:111], v[156:159]
  ds_read_b64_tr_b16 a[180:181], v22 offset:128
  v_mfma_f32_16x16x32_bf16 v[156:159], a[160:163], a[104:107], v[156:159]
  ds_read_b64_tr_b16 a[182:183], v23 offset:128
  v_mfma_f32_16x16x32_bf16 v[160:163], a[160:163], a[112:115], v[160:163]
  s_add_u32 s66, s66, 41943040
  v_mfma_f32_16x16x32_bf16 v[160:163], a[164:167], a[116:119], v[160:163]
  buffer_load_dwordx4 v13, s[16:19], s43 offen offset:3072 lds
  v_mfma_f32_16x16x32_bf16 v[164:167], a[164:167], a[124:127], v[164:167]
  s_add_u32 m0, s38, 4096
  s_lshl_b32 s75, s33, 3
  v_mfma_f32_16x16x32_bf16 v[164:167], a[160:163], a[120:123], v[164:167]
  s_waitcnt lgkmcnt(4)
  buffer_load_dwordx4 v14, s[16:19], s43 offen offset:0 lds
  v_mfma_f32_16x16x32_bf16 v[168:171], a[168:171], a[96:99], v[168:171]
  ds_read_b64_tr_b16 a[160:161], v20 offset:9344
  v_mfma_f32_16x16x32_bf16 v[168:171], a[172:175], a[100:103], v[168:171]
  ds_read_b64_tr_b16 a[162:163], v21 offset:9344
  v_mfma_f32_16x16x32_bf16 v[172:175], a[172:175], a[108:111], v[172:175]
  ds_read_b64_tr_b16 a[164:165], v22 offset:9344
  v_mfma_f32_16x16x32_bf16 v[172:175], a[168:171], a[104:107], v[172:175]
  ds_read_b64_tr_b16 a[166:167], v23 offset:9344
  v_mfma_f32_16x16x32_bf16 v[176:179], a[168:171], a[112:115], v[176:179]
  s_add_u32 s75, s75, s31
  v_mfma_f32_16x16x32_bf16 v[176:179], a[172:175], a[116:119], v[176:179]
  buffer_load_dwordx4 v15, s[16:19], s43 offen offset:1024 lds
  v_mfma_f32_16x16x32_bf16 v[180:183], a[172:175], a[124:127], v[180:183]
  s_lshl_b32 s75, s75, 2
  v_mfma_f32_16x16x32_bf16 v[180:183], a[168:171], a[120:123], v[180:183]
  s_waitcnt lgkmcnt(4)
  buffer_load_dwordx4 v16, s[16:19], s43 offen offset:2048 lds
  v_mfma_f32_16x16x32_bf16 v[184:187], a[176:179], a[96:99], v[184:187]
  ds_read_b64_tr_b16 a[168:169], v20 offset:160
  v_mfma_f32_16x16x32_bf16 v[184:187], a[180:183], a[100:103], v[184:187]
  ds_read_b64_tr_b16 a[170:171], v21 offset:160
  v_mfma_f32_16x16x32_bf16 v[188:191], a[180:183], a[108:111], v[188:191]
  ds_read_b64_tr_b16 a[172:173], v22 offset:160
  v_mfma_f32_16x16x32_bf16 v[188:191], a[176:179], a[104:107], v[188:191]
  ds_read_b64_tr_b16 a[174:175], v23 offset:160
  v_mfma_f32_16x16x32_bf16 v[192:195], a[176:179], a[112:115], v[192:195]
  s_add_u32 s75, s75, s28
  v_mfma_f32_16x16x32_bf16 v[192:195], a[180:183], a[116:119], v[192:195]
  buffer_load_dwordx4 v17, s[16:19], s43 offen offset:3072 lds
  v_mfma_f32_16x16x32_bf16 v[196:199], a[180:183], a[124:127], v[196:199]
  s_lshl_b32 s75, s75, 2
  v_mfma_f32_16x16x32_bf16 v[196:199], a[176:179], a[120:123], v[196:199]
  s_waitcnt lgkmcnt(4)
  v_mfma_f32_16x16x32_bf16 v[200:203], a[160:163], a[96:99], v[200:203]
  ds_read_b64_tr_b16 a[176:177], v20 offset:9376
  v_mfma_f32_16x16x32_bf16 v[200:203], a[164:167], a[100:103], v[200:203]
  ds_read_b64_tr_b16 a[178:179], v21 offset:9376
  v_mfma_f32_16x16x32_bf16 v[204:207], a[164:167], a[108:111], v[204:207]
  ds_read_b64_tr_b16 a[180:181], v22 offset:9376
  v_mfma_f32_16x16x32_bf16 v[204:207], a[160:163], a[104:107], v[204:207]
  ds_read_b64_tr_b16 a[182:183], v23 offset:9376
  v_mfma_f32_16x16x32_bf16 v[208:211], a[160:163], a[112:115], v[208:211]
  s_add_u32 s75, s75, s32
  v_mfma_f32_16x16x32_bf16 v[208:211], a[164:167], a[116:119], v[208:211]
  v_mfma_f32_16x16x32_bf16 v[212:215], a[164:167], a[124:127], v[212:215]
  s_lshl_b32 s75, s75, 7
  v_mfma_f32_16x16x32_bf16 v[212:215], a[160:163], a[120:123], v[212:215]
  s_waitcnt lgkmcnt(4)
  v_mfma_f32_16x16x32_bf16 v[216:219], a[168:171], a[96:99], v[216:219]
  ds_read_b64_tr_b16 a[160:161], v20 offset:192
  v_mfma_f32_16x16x32_bf16 v[216:219], a[172:175], a[100:103], v[216:219]
  ds_read_b64_tr_b16 a[162:163], v21 offset:192
  v_mfma_f32_16x16x32_bf16 v[220:223], a[172:175], a[108:111], v[220:223]
  ds_read_b64_tr_b16 a[164:165], v22 offset:192
  v_mfma_f32_16x16x32_bf16 v[220:223], a[168:171], a[104:107], v[220:223]
  ds_read_b64_tr_b16 a[166:167], v23 offset:192
  v_mfma_f32_16x16x32_bf16 v[224:227], a[168:171], a[112:115], v[224:227]
  s_add_u32 s75, s75, 42991616
  v_mfma_f32_16x16x32_bf16 v[224:227], a[172:175], a[116:119], v[224:227]
  v_mfma_f32_16x16x32_bf16 v[228:231], a[172:175], a[124:127], v[228:231]
  v_mov_b32 v49, 0
  v_mfma_f32_16x16x32_bf16 v[228:231], a[168:171], a[120:123], v[228:231]
  s_waitcnt lgkmcnt(4)
  v_mfma_f32_16x16x32_bf16 v[232:235], a[176:179], a[96:99], v[232:235]
  ds_read_b64_tr_b16 a[168:169], v20 offset:9408
  v_mfma_f32_16x16x32_bf16 v[232:235], a[180:183], a[100:103], v[232:235]
  ds_read_b64_tr_b16 a[170:171], v21 offset:9408
  v_mfma_f32_16x16x32_bf16 v[236:239], a[180:183], a[108:111], v[236:239]
  ds_read_b64_tr_b16 a[172:173], v22 offset:9408
  v_mfma_f32_16x16x32_bf16 v[236:239], a[176:179], a[104:107], v[236:239]
  ds_read_b64_tr_b16 a[174:175], v23 offset:9408
  v_mfma_f32_16x16x32_bf16 v[240:243], a[176:179], a[112:115], v[240:243]
  v_mfma_f32_16x16x32_bf16 v[240:243], a[180:183], a[116:119], v[240:243]
  v_mfma_f32_16x16x32_bf16 v[244:247], a[180:183], a[124:127], v[244:247]
  v_mfma_f32_16x16x32_bf16 v[244:247], a[176:179], a[120:123], v[244:247]
  s_waitcnt lgkmcnt(4)
  v_mfma_f32_16x16x32_bf16 a[0:3], a[160:163], a[96:99], a[0:3]
  ds_read_b64_tr_b16 a[176:177], v20 offset:224
  v_mfma_f32_16x16x32_bf16 a[0:3], a[164:167], a[100:103], a[0:3]
  ds_read_b64_tr_b16 a[178:179], v21 offset:224
  v_mfma_f32_16x16x32_bf16 a[4:7], a[164:167], a[108:111], a[4:7]
  ds_read_b64_tr_b16 a[180:181], v22 offset:224
  v_mfma_f32_16x16x32_bf16 a[4:7], a[160:163], a[104:107], a[4:7]
  ds_read_b64_tr_b16 a[182:183], v23 offset:224
  v_mfma_f32_16x16x32_bf16 a[8:11], a[160:163], a[112:115], a[8:11]
  v_mfma_f32_16x16x32_bf16 a[8:11], a[164:167], a[116:119], a[8:11]
  v_mfma_f32_16x16x32_bf16 a[12:15], a[164:167], a[124:127], a[12:15]
  s_add_u32 s51, s65, 4096
  v_mfma_f32_16x16x32_bf16 a[12:15], a[160:163], a[120:123], a[12:15]
  s_waitcnt lgkmcnt(4)
  buffer_store_dword v49, v254, s[24:27], s51 offen sc1
  v_mfma_f32_16x16x32_bf16 a[16:19], a[168:171], a[96:99], a[16:19]
  ds_read_b64_tr_b16 a[160:161], v20 offset:9440
  v_mfma_f32_16x16x32_bf16 a[16:19], a[172:175], a[100:103], a[16:19]
  ds_read_b64_tr_b16 a[162:163], v21 offset:9440
  v_mfma_f32_16x16x32_bf16 a[20:23], a[172:175], a[108:111], a[20:23]
  ds_read_b64_tr_b16 a[164:165], v22 offset:9440
  v_mfma_f32_16x16x32_bf16 a[20:23], a[168:171], a[104:107], a[20:23]
  ds_read_b64_tr_b16 a[166:167], v23 offset:9440
  v_mfma_f32_16x16x32_bf16 a[24:27], a[168:171], a[112:115], a[24:27]
  s_mov_b32 s63, 2949120
  v_mfma_f32_16x16x32_bf16 a[24:27], a[172:175], a[116:119], a[24:27]
  buffer_load_dword v252, v248, s[20:23], s63 offen
  v_mfma_f32_16x16x32_bf16 a[28:31], a[172:175], a[124:127], a[28:31]
  s_mov_b32 s63, 768
  v_mfma_f32_16x16x32_bf16 a[28:31], a[168:171], a[120:123], a[28:31]
  s_waitcnt lgkmcnt(4)
  buffer_load_dword v252, v249, s[16:19], s63 offen
  v_mfma_f32_16x16x32_bf16 a[32:35], a[176:179], a[96:99], a[32:35]
  ds_read_b64_tr_b16 a[168:169], v20 offset:256
  v_mfma_f32_16x16x32_bf16 a[32:35], a[180:183], a[100:103], a[32:35]
  ds_read_b64_tr_b16 a[170:171], v21 offset:256
  v_mfma_f32_16x16x32_bf16 a[36:39], a[180:183], a[108:111], a[36:39]
  ds_read_b64_tr_b16 a[172:173], v22 offset:256
  v_mfma_f32_16x16x32_bf16 a[36:39], a[176:179], a[104:107], a[36:39]
  ds_read_b64_tr_b16 a[174:175], v23 offset:256
  v_mfma_f32_16x16x32_bf16 a[40:43], a[176:179], a[112:115], a[40:43]
  s_lshl_b32 s62, s3, 7
  s_add_u32 s62, s62, L_slab3-standalone__glu_gated_geglu__prompt_kernel
  s_min_u32 s62, s62, L_end-standalone__glu_gated_geglu__prompt_kernel
  s_add_u32 s62, s62, s100
  s_addc_u32 s63, s101, 0
  v_mov_b32 v46, s62
  v_mov_b32 v47, s63
  v_mfma_f32_16x16x32_bf16 a[40:43], a[180:183], a[116:119], a[40:43]
  global_load_dword v252, v[46:47], off
  v_mfma_f32_16x16x32_bf16 a[44:47], a[180:183], a[124:127], a[44:47]
  s_add_u32 s51, s65, 8192
  v_mfma_f32_16x16x32_bf16 a[44:47], a[176:179], a[120:123], a[44:47]
  s_waitcnt lgkmcnt(4)
  buffer_store_dword v49, v254, s[24:27], s51 offen sc1
  v_mfma_f32_16x16x32_bf16 a[48:51], a[160:163], a[96:99], a[48:51]
  ds_read_b64_tr_b16 a[176:177], v20 offset:9472
  v_mfma_f32_16x16x32_bf16 a[48:51], a[164:167], a[100:103], a[48:51]
  ds_read_b64_tr_b16 a[178:179], v21 offset:9472
  v_mfma_f32_16x16x32_bf16 a[52:55], a[164:167], a[108:111], a[52:55]
  ds_read_b64_tr_b16 a[180:181], v22 offset:9472
  v_mfma_f32_16x16x32_bf16 a[52:55], a[160:163], a[104:107], a[52:55]
  ds_read_b64_tr_b16 a[182:183], v23 offset:9472
  v_mfma_f32_16x16x32_bf16 a[56:59], a[160:163], a[112:115], a[56:59]
  s_add_u32 s51, s65, 12288
  v_mfma_f32_16x16x32_bf16 a[56:59], a[164:167], a[116:119], a[56:59]
  buffer_store_dword v49, v254, s[24:27], s51 offen sc1
  v_mfma_f32_16x16x32_bf16 a[60:63], a[164:167], a[124:127], a[60:63]
  v_mfma_f32_16x16x32_bf16 a[60:63], a[160:163], a[120:123], a[60:63]
  s_waitcnt vmcnt(14) lgkmcnt(0)
  s_barrier
  v_add_u32 v20, 83968, v18
  v_add_u32 v21, 83968, v19
  v_add_u32 v22, 102400, v18
  v_add_u32 v23, 102400, v19
  buffer_store_dword v49, v254, s[24:27], s75 offen sc1
  v_mfma_f32_16x16x32_bf16 a[64:67], a[168:171], a[96:99], a[64:67]
  ds_read_b64_tr_b16 a[160:161], v20 offset:0
  v_mfma_f32_16x16x32_bf16 a[64:67], a[172:175], a[100:103], a[64:67]
  ds_read_b64_tr_b16 a[162:163], v21 offset:0
  v_mfma_f32_16x16x32_bf16 a[68:71], a[172:175], a[108:111], a[68:71]
  ds_read_b64_tr_b16 a[164:165], v22 offset:0
  v_mfma_f32_16x16x32_bf16 a[68:71], a[168:171], a[104:107], a[68:71]
  ds_read_b64_tr_b16 a[166:167], v23 offset:0
  v_mfma_f32_16x16x32_bf16 a[72:75], a[168:171], a[112:115], a[72:75]
  ds_read_b128 a[128:131], v24 offset:32768
  v_mfma_f32_16x16x32_bf16 a[72:75], a[172:175], a[116:119], a[72:75]
  ds_read_b128 a[132:135], v25 offset:32768
  v_mfma_f32_16x16x32_bf16 a[76:79], a[172:175], a[124:127], a[76:79]
  ds_read_b128 a[136:139], v24 offset:34816
  v_mfma_f32_16x16x32_bf16 a[76:79], a[168:171], a[120:123], a[76:79]
  ds_read_b128 a[140:143], v25 offset:34816
  v_mfma_f32_16x16x32_bf16 a[80:83], a[176:179], a[96:99], a[80:83]
  ds_read_b128 a[144:147], v24 offset:36864
  v_mfma_f32_16x16x32_bf16 a[80:83], a[180:183], a[100:103], a[80:83]
  ds_read_b128 a[148:151], v25 offset:36864
  v_mfma_f32_16x16x32_bf16 a[84:87], a[180:183], a[108:111], a[84:87]
  ds_read_b128 a[152:155], v24 offset:38912
  v_mfma_f32_16x16x32_bf16 a[84:87], a[176:179], a[104:107], a[84:87]
  ds_read_b128 a[156:159], v25 offset:38912
  v_mfma_f32_16x16x32_bf16 a[88:91], a[176:179], a[112:115], a[88:91]
  ds_read_b64_tr_b16 a[168:169], v20 offset:9216
  v_mfma_f32_16x16x32_bf16 a[88:91], a[180:183], a[116:119], a[88:91]
  ds_read_b64_tr_b16 a[170:171], v21 offset:9216
  v_mfma_f32_16x16x32_bf16 a[92:95], a[180:183], a[124:127], a[92:95]
  ds_read_b64_tr_b16 a[172:173], v22 offset:9216
  v_mfma_f32_16x16x32_bf16 a[92:95], a[176:179], a[120:123], a[92:95]
  ds_read_b64_tr_b16 a[174:175], v23 offset:9216
L_slab3:
  s_waitcnt lgkmcnt(4)
  v_mfma_f32_16x16x32_bf16 v[56:59], a[160:163], a[128:131], v[56:59]
  ds_read_b64_tr_b16 a[176:177], v20 offset:32
  v_mfma_f32_16x16x32_bf16 v[56:59], a[164:167], a[132:135], v[56:59]
  ds_read_b64_tr_b16 a[178:179], v21 offset:32
  v_mfma_f32_16x16x32_bf16 v[60:63], a[164:167], a[140:143], v[60:63]
  ds_read_b64_tr_b16 a[180:181], v22 offset:32
  v_mfma_f32_16x16x32_bf16 v[60:63], a[160:163], a[136:139], v[60:63]
  ds_read_b64_tr_b16 a[182:183], v23 offset:32
  v_mfma_f32_16x16x32_bf16 v[64:67], a[160:163], a[144:147], v[64:67]
  s_mul_i32 s45, s29, 0
  s_add_u32 s45, s45, s37
  s_add_u32 s45, s45, 2359296
  s_mul_i32 s44, s29, 18432
  s_add_u32 s44, s44, s39
  s_add_u32 m0, s44, 55296
  v_mov_b32 v28, 0xc0135761
  v_mfma_f32_16x16x32_bf16 v[64:67], a[164:167], a[148:151], v[64:67]
  buffer_load_dwordx4 v1, s[20:23], s45 offen offset:0 lds
  v_mfma_f32_16x16x32_bf16 v[68:71], a[164:167], a[156:159], v[68:71]
  v_mov_b32 v29, 0xc0135761
  v_mov_b32 v30, 0xbdd2d3e8
  v_mfma_f32_16x16x32_bf16 v[68:71], a[160:163], a[152:155], v[68:71]
  s_waitcnt lgkmcnt(4)
  buffer_load_dwordx4 v2, s[20:23], s45 offen offset:1024 lds
  v_mfma_f32_16x16x32_bf16 v[72:75], a[168:171], a[128:131], v[72:75]
  ds_read_b64_tr_b16 a[160:161], v20 offset:9248
  v_mfma_f32_16x16x32_bf16 v[72:75], a[172:175], a[132:135], v[72:75]
  ds_read_b64_tr_b16 a[162:163], v21 offset:9248
  v_mfma_f32_16x16x32_bf16 v[76:79], a[172:175], a[140:143], v[76:79]
  ds_read_b64_tr_b16 a[164:165], v22 offset:9248
  v_mfma_f32_16x16x32_bf16 v[76:79], a[168:171], a[136:139], v[76:79]
  ds_read_b64_tr_b16 a[166:167], v23 offset:9248
  v_mfma_f32_16x16x32_bf16 v[80:83], a[168:171], a[144:147], v[80:83]
  v_mov_b32 v31, 0xbdd2d3e8
  v_mfma_f32_16x16x32_bf16 v[80:83], a[172:175], a[148:151], v[80:83]
  buffer_load_dwordx4 v3, s[20:23], s45 offen offset:2048 lds
  v_mfma_f32_16x16x32_bf16 v[84:87], a[172:175], a[156:159], v[84:87]
  v_mov_b32 v32, 0x3f800000
  v_mov_b32 v33, 0x3f800000
  v_mfma_f32_16x16x32_bf16 v[84:87], a[168:171], a[152:155], v[84:87]
  s_waitcnt lgkmcnt(4)
  buffer_load_dwordx4 v4, s[20:23], s45 offen offset:3072 lds
  v_mfma_f32_16x16x32_bf16 v[88:91], a[176:179], a[128:131], v[88:91]
  ds_read_b64_tr_b16 a[168:169], v20 offset:64
  v_mfma_f32_16x16x32_bf16 v[88:91], a[180:183], a[132:135], v[88:91]
  ds_read_b64_tr_b16 a[170:171], v21 offset:64
  v_mfma_f32_16x16x32_bf16 v[92:95], a[180:183], a[140:143], v[92:95]
  ds_read_b64_tr_b16 a[172:173], v22 offset:64
  v_mfma_f32_16x16x32_bf16 v[92:95], a[176:179], a[136:139], v[92:95]
  ds_read_b64_tr_b16 a[174:175], v23 offset:64
  v_mfma_f32_16x16x32_bf16 v[96:99], a[176:179], a[144:147], v[96:99]
  s_add_u32 m0, s44, 59392
  s_lshl_b32 s89, s32, 2
  v_mfma_f32_16x16x32_bf16 v[96:99], a[180:183], a[148:151], v[96:99]
  buffer_load_dwordx4 v5, s[20:23], s45 offen offset:0 lds
  v_mfma_f32_16x16x32_bf16 v[100:103], a[180:183], a[156:159], v[100:103]
  s_add_u32 s89, s89, 4
  s_cmp_eq_u32 s32, 3
  s_cselect_b32 s89, 0, s89
  v_mfma_f32_16x16x32_bf16 v[100:103], a[176:179], a[152:155], v[100:103]
  s_waitcnt lgkmcnt(4)
  buffer_load_dwordx4 v6, s[20:23], s45 offen offset:1024 lds
  v_mfma_f32_16x16x32_bf16 v[104:107], a[160:163], a[128:131], v[104:107]
  ds_read_b64_tr_b16 a[176:177], v20 offset:9280
  v_mfma_f32_16x16x32_bf16 v[104:107], a[164:167], a[132:135], v[104:107]
  ds_read_b64_tr_b16 a[178:179], v21 offset:9280
  v_mfma_f32_16x16x32_bf16 v[108:111], a[164:167], a[140:143], v[108:111]
  ds_read_b64_tr_b16 a[180:181], v22 offset:9280
  v_mfma_f32_16x16x32_bf16 v[108:111], a[160:163], a[136:139], v[108:111]
  ds_read_b64_tr_b16 a[182:183], v23 offset:9280
  v_mfma_f32_16x16x32_bf16 v[112:115], a[160:163], a[144:147], v[112:115]
  s_lshr_b32 s77, s89, 1
  v_mfma_f32_16x16x32_bf16 v[112:115], a[164:167], a[148:151], v[112:115]
  buffer_load_dwordx4 v7, s[20:23], s45 offen offset:2048 lds
  v_mfma_f32_16x16x32_bf16 v[116:119], a[164:167], a[156:159], v[116:119]
  v_add_u32 v50, 0, v0
  v_mul_u32_u24 v51, 3641, v50
  v_mfma_f32_16x16x32_bf16 v[116:119], a[160:163], a[152:155], v[116:119]
  s_waitcnt lgkmcnt(4)
  buffer_load_dwordx4 v8, s[20:23], s45 offen offset:3072 lds
  v_mfma_f32_16x16x32_bf16 v[120:123], a[168:171], a[128:131], v[120:123]
  ds_read_b64_tr_b16 a[160:161], v20 offset:96
  v_mfma_f32_16x16x32_bf16 v[120:123], a[172:175], a[132:135], v[120:123]
  ds_read_b64_tr_b16 a[162:163], v21 offset:96
  v_mfma_f32_16x16x32_bf16 v[124:127], a[172:175], a[140:143], v[124:127]
  ds_read_b64_tr_b16 a[164:165], v22 offset:96
  v_mfma_f32_16x16x32_bf16 v[124:127], a[168:171], a[136:139], v[124:127]
  ds_read_b64_tr_b16 a[166:167], v23 offset:96
  v_mfma_f32_16x16x32_bf16 v[128:131], a[168:171], a[144:147], v[128:131]
  s_add_u32 m0, s44, 63488
  v_lshrrev_b32 v51, 16, v51
  v_mfma_f32_16x16x32_bf16 v[128:131], a[172:175], a[148:151], v[128:131]
  buffer_load_dwordx4 v9, s[20:23], s45 offen offset:0 lds
  v_mfma_f32_16x16x32_bf16 v[132:135], a[172:175], a[156:159], v[132:135]
  s_add_u32 s43, s36, 640
  s_add_u32 m0, s38, 32768
  v_mad_i32_i24 v50, v51, s88, v50
  v_add_u32 v50, s89, v50
  v_mfma_f32_16x16x32_bf16 v[132:135], a[168:171], a[152:155], v[132:135]
  s_waitcnt lgkmcnt(4)
  buffer_load_dwordx4 v10, s[16:19], s43 offen offset:0 lds
  v_mfma_f32_16x16x32_bf16 v[136:139], a[176:179], a[128:131], v[136:139]
  ds_read_b64_tr_b16 a[168:169], v20 offset:9312
  v_mfma_f32_16x16x32_bf16 v[136:139], a[180:183], a[132:135], v[136:139]
  ds_read_b64_tr_b16 a[170:171], v21 offset:9312
  v_mfma_f32_16x16x32_bf16 v[140:143], a[180:183], a[140:143], v[140:143]
  ds_read_b64_tr_b16 a[172:173], v22 offset:9312
  v_mfma_f32_16x16x32_bf16 v[140:143], a[176:179], a[136:139], v[140:143]
  ds_read_b64_tr_b16 a[174:175], v23 offset:9312
  v_mfma_f32_16x16x32_bf16 v[144:147], a[176:179], a[144:147], v[144:147]
  v_subrev_u32 v52, 18, v50
  v_mfma_f32_16x16x32_bf16 v[144:147], a[180:183], a[148:151], v[144:147]
  buffer_load_dwordx4 v11, s[16:19], s43 offen offset:1024 lds
  v_mfma_f32_16x16x32_bf16 v[148:151], a[180:183], a[156:159], v[148:151]
  v_min_u32 v50, v50, v52
  v_mul_u32_u24 v51, 1152, v51
  v_mfma_f32_16x16x32_bf16 v[148:151], a[176:179], a[152:155], v[148:151]
  s_waitcnt lgkmcnt(4)
  buffer_load_dwordx4 v12, s[16:19], s43 offen offset:2048 lds
  v_mfma_f32_16x16x32_bf16 v[152:155], a[160:163], a[128:131], v[152:155]
  ds_read_b64_tr_b16 a[176:177], v20 offset:128
  v_mfma_f32_16x16x32_bf16 v[152:155], a[164:167], a[132:135], v[152:155]
  ds_read_b64_tr_b16 a[178:179], v21 offset:128
  v_mfma_f32_16x16x32_bf16 v[156:159], a[164:167], a[140:143], v[156:159]
  ds_read_b64_tr_b16 a[180:181], v22 offset:128
  v_mfma_f32_16x16x32_bf16 v[156:159], a[160:163], a[136:139], v[156:159]
  ds_read_b64_tr_b16 a[182:183], v23 offset:128
  v_mfma_f32_16x16x32_bf16 v[160:163], a[160:163], a[144:147], v[160:163]
  v_lshl_add_u32 v53, v50, 4, v51
  v_mfma_f32_16x16x32_bf16 v[160:163], a[164:167], a[148:151], v[160:163]
  buffer_load_dwordx4 v13, s[16:19], s43 offen offset:3072 lds
  v_mfma_f32_16x16x32_bf16 v[164:167], a[164:167], a[156:159], v[164:167]
  s_add_u32 m0, s38, 36864
  v_accvgpr_write_b32 a184, v53
  v_add_u32 v50, 64, v0
  v_mfma_f32_16x16x32_bf16 v[164:167], a[160:163], a[152:155], v[164:167]
  s_waitcnt lgkmcnt(4)
  buffer_load_dwordx4 v14, s[16:19], s43 offen offset:0 lds
  v_mfma_f32_16x16x32_bf16 v[168:171], a[168:171], a[128:131], v[168:171]
  ds_read_b64_tr_b16 a[160:161], v20 offset:9344
  v_mfma_f32_16x16x32_bf16 v[168:171], a[172:175], a[132:135], v[168:171]
  ds_read_b64_tr_b16 a[162:163], v21 offset:9344
  v_mfma_f32_16x16x32_bf16 v[172:175], a[172:175], a[140:143], v[172:175]
  ds_read_b64_tr_b16 a[164:165], v22 offset:9344
  v_mfma_f32_16x16x32_bf16 v[172:175], a[168:171], a[136:139], v[172:175]
  ds_read_b64_tr_b16 a[166:167], v23 offset:9344
  v_mfma_f32_16x16x32_bf16 v[176:179], a[168:171], a[144:147], v[176:179]
  v_mul_u32_u24 v51, 3641, v50
  v_mfma_f32_16x16x32_bf16 v[176:179], a[172:175], a[148:151], v[176:179]
  buffer_load_dwordx4 v15, s[16:19], s43 offen offset:1024 lds
  v_mfma_f32_16x16x32_bf16 v[180:183], a[172:175], a[156:159], v[180:183]
  v_lshrrev_b32 v51, 16, v51
  v_mad_i32_i24 v50, v51, s88, v50
  v_mfma_f32_16x16x32_bf16 v[180:183], a[168:171], a[152:155], v[180:183]
  s_waitcnt lgkmcnt(4)
  buffer_load_dwordx4 v16, s[16:19], s43 offen offset:2048 lds
  v_mfma_f32_16x16x32_bf16 v[184:187], a[176:179], a[128:131], v[184:187]
  ds_read_b64_tr_b16 a[168:169], v20 offset:160
  v_mfma_f32_16x16x32_bf16 v[184:187], a[180:183], a[132:135], v[184:187]
  ds_read_b64_tr_b16 a[170:171], v21 offset:160
  v_mfma_f32_16x16x32_bf16 v[188:191], a[180:183], a[140:143], v[188:191]
  ds_read_b64_tr_b16 a[172:173], v22 offset:160
  v_mfma_f32_16x16x32_bf16 v[188:191], a[176:179], a[136:139], v[188:191]
  ds_read_b64_tr_b16 a[174:175], v23 offset:160
  v_mfma_f32_16x16x32_bf16 v[192:195], a[176:179], a[144:147], v[192:195]
  v_add_u32 v50, s89, v50
  v_mfma_f32_16x16x32_bf16 v[192:195], a[180:183], a[148:151], v[192:195]
  buffer_load_dwordx4 v17, s[16:19], s43 offen offset:3072 lds
  v_mfma_f32_16x16x32_bf16 v[196:199], a[180:183], a[156:159], v[196:199]
  v_subrev_u32 v52, 18, v50
  v_min_u32 v50, v50, v52
  v_mfma_f32_16x16x32_bf16 v[196:199], a[176:179], a[152:155], v[196:199]
  s_waitcnt lgkmcnt(4)
  v_mfma_f32_16x16x32_bf16 v[200:203], a[160:163], a[128:131], v[200:203]
  ds_read_b64_tr_b16 a[176:177], v20 offset:9376
  v_mfma_f32_16x16x32_bf16 v[200:203], a[164:167], a[132:135], v[200:203]
  ds_read_b64_tr_b16 a[178:179], v21 offset:9376
  v_mfma_f32_16x16x32_bf16 v[204:207], a[164:167], a[140:143], v[204:207]
  ds_read_b64_tr_b16 a[180:181], v22 offset:9376
  v_mfma_f32_16x16x32_bf16 v[204:207], a[160:163], a[136:139], v[204:207]
  ds_read_b64_tr_b16 a[182:183], v23 offset:9376
  v_mfma_f32_16x16x32_bf16 v[208:211], a[160:163], a[144:147], v[208:211]
  v_mul_u32_u24 v51, 1152, v51
  v_mfma_f32_16x16x32_bf16 v[208:211], a[164:167], a[148:151], v[208:211]
  v_mfma_f32_16x16x32_bf16 v[212:215], a[164:167], a[156:159], v[212:215]
  v_lshl_add_u32 v53, v50, 4, v51
  v_subrev_u32 v53, 1024, v53
  v_mfma_f32_16x16x32_bf16 v[212:215], a[160:163], a[152:155], v[212:215]
  s_waitcnt lgkmcnt(4)
  v_mfma_f32_16x16x32_bf16 v[216:219], a[168:171], a[128:131], v[216:219]
  ds_read_b64_tr_b16 a[160:161], v20 offset:192
  v_mfma_f32_16x16x32_bf16 v[216:219], a[172:175], a[132:135], v[216:219]
  ds_read_b64_tr_b16 a[162:163], v21 offset:192
  v_mfma_f32_16x16x32_bf16 v[220:223], a[172:175], a[140:143], v[220:223]
  ds_read_b64_tr_b16 a[164:165], v22 offset:192
  v_mfma_f32_16x16x32_bf16 v[220:223], a[168:171], a[136:139], v[220:223]
  ds_read_b64_tr_b16 a[166:167], v23 offset:192
  v_mfma_f32_16x16x32_bf16 v[224:227], a[168:171], a[144:147], v[224:227]
  v_accvgpr_write_b32 a185, v53
  v_mfma_f32_16x16x32_bf16 v[224:227], a[172:175], a[148:151], v[224:227]
  v_mfma_f32_16x16x32_bf16 v[228:231], a[172:175], a[156:159], v[228:231]
  v_add_u32 v50, 128, v0
  v_mfma_f32_16x16x32_bf16 v[228:231], a[168:171], a[152:155], v[228:231]
  s_waitcnt lgkmcnt(4)
  v_mfma_f32_16x16x32_bf16 v[232:235], a[176:179], a[128:131], v[232:235]
  ds_read_b64_tr_b16 a[168:169], v20 offset:9408
  v_mfma_f32_16x16x32_bf16 v[232:235], a[180:183], a[132:135], v[232:235]
  ds_read_b64_tr_b16 a[170:171], v21 offset:9408
  v_mfma_f32_16x16x32_bf16 v[236:239], a[180:183], a[140:143], v[236:239]
  ds_read_b64_tr_b16 a[172:173], v22 offset:9408
  v_mfma_f32_16x16x32_bf16 v[236:239], a[176:179], a[136:139], v[236:239]
  ds_read_b64_tr_b16 a[174:175], v23 offset:9408
  v_mfma_f32_16x16x32_bf16 v[240:243], a[176:179], a[144:147], v[240:243]
  v_mfma_f32_16x16x32_bf16 v[240:243], a[180:183], a[148:151], v[240:243]
  v_mfma_f32_16x16x32_bf16 v[244:247], a[180:183], a[156:159], v[244:247]
  v_mfma_f32_16x16x32_bf16 v[244:247], a[176:179], a[152:155], v[244:247]
  s_waitcnt lgkmcnt(4)
  v_mfma_f32_16x16x32_bf16 a[0:3], a[160:163], a[128:131], a[0:3]
  ds_read_b64_tr_b16 a[176:177], v20 offset:224
  v_mfma_f32_16x16x32_bf16 a[0:3], a[164:167], a[132:135], a[0:3]
  ds_read_b64_tr_b16 a[178:179], v21 offset:224
  v_mfma_f32_16x16x32_bf16 a[4:7], a[164:167], a[140:143], a[4:7]
  ds_read_b64_tr_b16 a[180:181], v22 offset:224
  v_mfma_f32_16x16x32_bf16 a[4:7], a[160:163], a[136:139], a[4:7]
  ds_read_b64_tr_b16 a[182:183], v23 offset:224
  v_mfma_f32_16x16x32_bf16 a[8:11], a[160:163], a[144:147], a[8:11]
  v_mfma_f32_16x16x32_bf16 a[8:11], a[164:167], a[148:151], a[8:11]
  v_mfma_f32_16x16x32_bf16 a[12:15], a[164:167], a[156:159], a[12:15]
  v_mfma_f32_16x16x32_bf16 a[12:15], a[160:163], a[152:155], a[12:15]
  s_waitcnt lgkmcnt(4)
  v_mfma_f32_16x16x32_bf16 a[16:19], a[168:171], a[128:131], a[16:19]
  ds_read_b64_tr_b16 a[160:161], v20 offset:9440
  v_mfma_f32_16x16x32_bf16 a[16:19], a[172:175], a[132:135], a[16:19]
  ds_read_b64_tr_b16 a[162:163], v21 offset:9440
  v_mfma_f32_16x16x32_bf16 a[20:23], a[172:175], a[140:143], a[20:23]
  ds_read_b64_tr_b16 a[164:165], v22 offset:9440
  v_mfma_f32_16x16x32_bf16 a[20:23], a[168:171], a[136:139], a[20:23]
  ds_read_b64_tr_b16 a[166:167], v23 offset:9440
  v_mfma_f32_16x16x32_bf16 a[24:27], a[168:171], a[144:147], a[24:27]
  s_mov_b32 s63, 3538944
  v_mfma_f32_16x16x32_bf16 a[24:27], a[172:175], a[148:151], a[24:27]
  buffer_load_dword v252, v248, s[20:23], s63 offen
  v_mfma_f32_16x16x32_bf16 a[28:31], a[172:175], a[156:159], a[28:31]
  s_mov_b32 s63, 896
  v_mfma_f32_16x16x32_bf16 a[28:31], a[168:171], a[152:155], a[28:31]
  s_waitcnt lgkmcnt(4)
  buffer_load_dword v252, v249, s[16:19], s63 offen
  v_mfma_f32_16x16x32_bf16 a[32:35], a[176:179], a[128:131], a[32:35]
  ds_read_b64_tr_b16 a[168:169], v20 offset:256
  v_mfma_f32_16x16x32_bf16 a[32:35], a[180:183], a[132:135], a[32:35]
  ds_read_b64_tr_b16 a[170:171], v21 offset:256
  v_mfma_f32_16x16x32_bf16 a[36:39], a[180:183], a[140:143], a[36:39]
  ds_read_b64_tr_b16 a[172:173], v22 offset:256
  v_mfma_f32_16x16x32_bf16 a[36:39], a[176:179], a[136:139], a[36:39]
  ds_read_b64_tr_b16 a[174:175], v23 offset:256
  v_mfma_f32_16x16x32_bf16 a[40:43], a[176:179], a[144:147], a[40:43]
  s_movk_i32 s63, 0
  v_mfma_f32_16x16x32_bf16 a[40:43], a[180:183], a[148:151], a[40:43]
  buffer_load_dword v252, v55, s[68:71], s63 offen
  v_mfma_f32_16x16x32_bf16 a[44:47], a[180:183], a[156:159], a[44:47]
  v_mfma_f32_16x16x32_bf16 a[44:47], a[176:179], a[152:155], a[44:47]
  s_waitcnt lgkmcnt(4)
  v_mfma_f32_16x16x32_bf16 a[48:51], a[160:163], a[128:131], a[48:51]
  ds_read_b64_tr_b16 a[176:177], v20 offset:9472
  v_mfma_f32_16x16x32_bf16 a[48:51], a[164:167], a[132:135], a[48:51]
  ds_read_b64_tr_b16 a[178:179], v21 offset:9472
  v_mfma_f32_16x16x32_bf16 a[52:55], a[164:167], a[140:143], a[52:55]
  ds_read_b64_tr_b16 a[180:181], v22 offset:9472
  v_mfma_f32_16x16x32_bf16 a[52:55], a[160:163], a[136:139], a[52:55]
  ds_read_b64_tr_b16 a[182:183], v23 offset:9472
  v_mfma_f32_16x16x32_bf16 a[56:59], a[160:163], a[144:147], a[56:59]
  v_mfma_f32_16x16x32_bf16 a[56:59], a[164:167], a[148:151], a[56:59]
  v_mfma_f32_16x16x32_bf16 a[60:63], a[164:167], a[156:159], a[60:63]
  v_mfma_f32_16x16x32_bf16 a[60:63], a[160:163], a[152:155], a[60:63]
  s_waitcnt vmcnt(11) lgkmcnt(0)
  s_barrier
  v_add_u32 v20, 120832, v18
  v_add_u32 v21, 120832, v19
  v_add_u32 v22, 139264, v18
  v_add_u32 v23, 139264, v19
  v_mfma_f32_16x16x32_bf16 a[64:67], a[168:171], a[128:131], a[64:67]
  ds_read_b64_tr_b16 a[160:161], v20 offset:0
  v_mfma_f32_16x16x32_bf16 a[64:67], a[172:175], a[132:135], a[64:67]
  ds_read_b64_tr_b16 a[162:163], v21 offset:0
  v_mfma_f32_16x16x32_bf16 a[68:71], a[172:175], a[140:143], a[68:71]
  ds_read_b64_tr_b16 a[164:165], v22 offset:0
  v_mfma_f32_16x16x32_bf16 a[68:71], a[168:171], a[136:139], a[68:71]
  ds_read_b64_tr_b16 a[166:167], v23 offset:0
  v_mfma_f32_16x16x32_bf16 a[72:75], a[168:171], a[144:147], a[72:75]
  ds_read_b128 a[96:99], v24 offset:0
  v_mfma_f32_16x16x32_bf16 a[72:75], a[172:175], a[148:151], a[72:75]
  ds_read_b128 a[100:103], v25 offset:0
  v_mfma_f32_16x16x32_bf16 a[76:79], a[172:175], a[156:159], a[76:79]
  ds_read_b128 a[104:107], v24 offset:2048
  v_mfma_f32_16x16x32_bf16 a[76:79], a[168:171], a[152:155], a[76:79]
  ds_read_b128 a[108:111], v25 offset:2048
  v_mfma_f32_16x16x32_bf16 a[80:83], a[176:179], a[128:131], a[80:83]
  ds_read_b128 a[112:115], v24 offset:4096
  v_mfma_f32_16x16x32_bf16 a[80:83], a[180:183], a[132:135], a[80:83]
  ds_read_b128 a[116:119], v25 offset:4096
  v_mfma_f32_16x16x32_bf16 a[84:87], a[180:183], a[140:143], a[84:87]
  ds_read_b128 a[120:123], v24 offset:6144
  v_mfma_f32_16x16x32_bf16 a[84:87], a[176:179], a[136:139], a[84:87]
  ds_read_b128 a[124:127], v25 offset:6144
  v_mfma_f32_16x16x32_bf16 a[88:91], a[176:179], a[144:147], a[88:91]
  ds_read_b64_tr_b16 a[168:169], v20 offset:9216
  v_mfma_f32_16x16x32_bf16 a[88:91], a[180:183], a[148:151], a[88:91]
  ds_read_b64_tr_b16 a[170:171], v21 offset:9216
  v_mfma_f32_16x16x32_bf16 a[92:95], a[180:183], a[156:159], a[92:95]
  ds_read_b64_tr_b16 a[172:173], v22 offset:9216
  v_mfma_f32_16x16x32_bf16 a[92:95], a[176:179], a[152:155], a[92:95]
  ds_read_b64_tr_b16 a[174:175], v23 offset:9216
L_slab4:
  s_waitcnt lgkmcnt(4)
  v_mfma_f32_16x16x32_bf16 v[56:59], a[160:163], a[96:99], v[56:59]
  ds_read_b64_tr_b16 a[176:177], v20 offset:32
  v_mfma_f32_16x16x32_bf16 v[56:59], a[164:167], a[100:103], v[56:59]
  ds_read_b64_tr_b16 a[178:179], v21 offset:32
  v_mfma_f32_16x16x32_bf16 v[60:63], a[164:167], a[108:111], v[60:63]
  ds_read_b64_tr_b16 a[180:181], v22 offset:32
  v_mfma_f32_16x16x32_bf16 v[60:63], a[160:163], a[104:107], v[60:63]
  ds_read_b64_tr_b16 a[182:183], v23 offset:32
  v_mfma_f32_16x16x32_bf16 v[64:67], a[160:163], a[112:115], v[64:67]
  s_mul_i32 s45, s29, 0
  s_add_u32 s45, s45, s37
  s_add_u32 s45, s45, 2949120
  s_mul_i32 s44, s29, 18432
  s_add_u32 s44, s44, s39
  s_add_u32 m0, s44, 0
  v_mul_u32_u24 v51, 3641, v50
  v_mfma_f32_16x16x32_bf16 v[64:67], a[164:167], a[116:119], v[64:67]
  buffer_load_dwordx4 v1, s[20:23], s45 offen offset:0 lds
  v_mfma_f32_16x16x32_bf16 v[68:71], a[164:167], a[124:127], v[68:71]
  v_lshrrev_b32 v51, 16, v51
  v_mad_i32_i24 v50, v51, s88, v50
  v_mfma_f32_16x16x32_bf16 v[68:71], a[160:163], a[120:123], v[68:71]
  s_waitcnt lgkmcnt(4)
  buffer_load_dwordx4 v2, s[20:23], s45 offen offset:1024 lds
  v_mfma_f32_16x16x32_bf16 v[72:75], a[168:171], a[96:99], v[72:75]
  ds_read_b64_tr_b16 a[160:161], v20 offset:9248
  v_mfma_f32_16x16x32_bf16 v[72:75], a[172:175], a[100:103], v[72:75]
  ds_read_b64_tr_b16 a[162:163], v21 offset:9248
  v_mfma_f32_16x16x32_bf16 v[76:79], a[172:175], a[108:111], v[76:79]
  ds_read_b64_tr_b16 a[164:165], v22 offset:9248
  v_mfma_f32_16x16x32_bf16 v[76:79], a[168:171], a[104:107], v[76:79]
  ds_read_b64_tr_b16 a[166:167], v23 offset:9248
  v_mfma_f32_16x16x32_bf16 v[80:83], a[168:171], a[112:115], v[80:83]
  v_add_u32 v50, s89, v50
  v_mfma_f32_16x16x32_bf16 v[80:83], a[172:175], a[116:119], v[80:83]
  buffer_load_dwordx4 v3, s[20:23], s45 offen offset:2048 lds
  v_mfma_f32_16x16x32_bf16 v[84:87], a[172:175], a[124:127], v[84:87]
  v_subrev_u32 v52, 18, v50
  v_min_u32 v50, v50, v52
  v_mfma_f32_16x16x32_bf16 v[84:87], a[168:171], a[120:123], v[84:87]
  s_waitcnt lgkmcnt(4)
  buffer_load_dwordx4 v4, s[20:23], s45 offen offset:3072 lds
  v_mfma_f32_16x16x32_bf16 v[88:91], a[176:179], a[96:99], v[88:91]
  ds_read_b64_tr_b16 a[168:169], v20 offset:64
  v_mfma_f32_16x16x32_bf16 v[88:91], a[180:183], a[100:103], v[88:91]
  ds_read_b64_tr_b16 a[170:171], v21 offset:64
  v_mfma_f32_16x16x32_bf16 v[92:95], a[180:183], a[108:111], v[92:95]
  ds_read_b64_tr_b16 a[172:173], v22 offset:64
  v_mfma_f32_16x16x32_bf16 v[92:95], a[176:179], a[104:107], v[92:95]
  ds_read_b64_tr_b16 a[174:175], v23 offset:64
  v_mfma_f32_16x16x32_bf16 v[96:99], a[176:179], a[112:115], v[96:99]
  s_add_u32 m0, s44, 4096
  v_mul_u32_u24 v51, 1152, v51
  v_mfma_f32_16x16x32_bf16 v[96:99], a[180:183], a[116:119], v[96:99]
  buffer_load_dwordx4 v5, s[20:23], s45 offen offset:0 lds
  v_mfma_f32_16x16x32_bf16 v[100:103], a[180:183], a[124:127], v[100:103]
  v_lshl_add_u32 v53, v50, 4, v51
  v_subrev_u32 v53, 2048, v53
  v_mfma_f32_16x16x32_bf16 v[100:103], a[176:179], a[120:123], v[100:103]
  s_waitcnt lgkmcnt(4)
  buffer_load_dwordx4 v6, s[20:23], s45 offen offset:1024 lds
  v_mfma_f32_16x16x32_bf16 v[104:107], a[160:163], a[96:99], v[104:107]
  ds_read_b64_tr_b16 a[176:177], v20 offset:9280
  v_mfma_f32_16x16x32_bf16 v[104:107], a[164:167], a[100:103], v[104:107]
  ds_read_b64_tr_b16 a[178:179], v21 offset:9280
  v_mfma_f32_16x16x32_bf16 v[108:111], a[164:167], a[108:111], v[108:111]
  ds_read_b64_tr_b16 a[180:181], v22 offset:9280
  v_mfma_f32_16x16x32_bf16 v[108:111], a[160:163], a[104:107], v[108:111]
  ds_read_b64_tr_b16 a[182:183], v23 offset:9280
  v_mfma_f32_16x16x32_bf16 v[112:115], a[160:163], a[112:115], v[112:115]
  v_accvgpr_write_b32 a186, v53
  v_mfma_f32_16x16x32_bf16 v[112:115], a[164:167], a[116:119], v[112:115]
  buffer_load_dwordx4 v7, s[20:23], s45 offen offset:2048 lds
  v_mfma_f32_16x16x32_bf16 v[116:119], a[164:167], a[124:127], v[116:119]
  v_add_u32 v50, 192, v0
  v_mul_u32_u24 v51, 3641, v50
  v_mfma_f32_16x16x32_bf16 v[116:119], a[160:163], a[120:123], v[116:119]
  s_waitcnt lgkmcnt(4)
  buffer_load_dwordx4 v8, s[20:23], s45 offen offset:3072 lds
  v_mfma_f32_16x16x32_bf16 v[120:123], a[168:171], a[96:99], v[120:123]
  ds_read_b64_tr_b16 a[160:161], v20 offset:96
  v_mfma_f32_16x16x32_bf16 v[120:123], a[172:175], a[100:103], v[120:123]
  ds_read_b64_tr_b16 a[162:163], v21 offset:96
  v_mfma_f32_16x16x32_bf16 v[124:127], a[172:175], a[108:111], v[124:127]
  ds_read_b64_tr_b16 a[164:165], v22 offset:96
  v_mfma_f32_16x16x32_bf16 v[124:127], a[168:171], a[104:107], v[124:127]
  ds_read_b64_tr_b16 a[166:167], v23 offset:96
  v_mfma_f32_16x16x32_bf16 v[128:131], a[168:171], a[112:115], v[128:131]
  s_add_u32 m0, s44, 8192
  v_lshrrev_b32 v51, 16, v51
  v_mfma_f32_16x16x32_bf16 v[128:131], a[172:175], a[116:119], v[128:131]
  buffer_load_dwordx4 v9, s[20:23], s45 offen offset:0 lds
  v_mfma_f32_16x16x32_bf16 v[132:135], a[172:175], a[124:127], v[132:135]
  s_add_u32 s43, s36, 768
  s_add_u32 m0, s38, 0
  v_mad_i32_i24 v50, v51, s88, v50
  v_add_u32 v50, s89, v50
  v_mfma_f32_16x16x32_bf16 v[132:135], a[168:171], a[120:123], v[132:135]
  s_waitcnt lgkmcnt(4)
  buffer_load_dwordx4 v10, s[16:19], s43 offen offset:0 lds
  v_mfma_f32_16x16x32_bf16 v[136:139], a[176:179], a[96:99], v[136:139]
  ds_read_b64_tr_b16 a[168:169], v20 offset:9312
  v_mfma_f32_16x16x32_bf16 v[136:139], a[180:183], a[100:103], v[136:139]
  ds_read_b64_tr_b16 a[170:171], v21 offset:9312
  v_mfma_f32_16x16x32_bf16 v[140:143], a[180:183], a[108:111], v[140:143]
  ds_read_b64_tr_b16 a[172:173], v22 offset:9312
  v_mfma_f32_16x16x32_bf16 v[140:143], a[176:179], a[104:107], v[140:143]
  ds_read_b64_tr_b16 a[174:175], v23 offset:9312
  v_mfma_f32_16x16x32_bf16 v[144:147], a[176:179], a[112:115], v[144:147]
  v_subrev_u32 v52, 18, v50
  v_mfma_f32_16x16x32_bf16 v[144:147], a[180:183], a[116:119], v[144:147]
  buffer_load_dwordx4 v11, s[16:19], s43 offen offset:1024 lds
  v_mfma_f32_16x16x32_bf16 v[148:151], a[180:183], a[124:127], v[148:151]
  v_min_u32 v50, v50, v52
  v_mul_u32_u24 v51, 1152, v51
  v_mfma_f32_16x16x32_bf16 v[148:151], a[176:179], a[120:123], v[148:151]
  s_waitcnt lgkmcnt(4)
  buffer_load_dwordx4 v12, s[16:19], s43 offen offset:2048 lds
  v_mfma_f32_16x16x32_bf16 v[152:155], a[160:163], a[96:99], v[152:155]
  ds_read_b64_tr_b16 a[176:177], v20 offset:128
  v_mfma_f32_16x16x32_bf16 v[152:155], a[164:167], a[100:103], v[152:155]
  ds_read_b64_tr_b16 a[178:179], v21 offset:128
  v_mfma_f32_16x16x32_bf16 v[156:159], a[164:167], a[108:111], v[156:159]
  ds_read_b64_tr_b16 a[180:181], v22 offset:128
  v_mfma_f32_16x16x32_bf16 v[156:159], a[160:163], a[104:107], v[156:159]
  ds_read_b64_tr_b16 a[182:183], v23 offset:128
  v_mfma_f32_16x16x32_bf16 v[160:163], a[160:163], a[112:115], v[160:163]
  v_lshl_add_u32 v53, v50, 4, v51
  v_mfma_f32_16x16x32_bf16 v[160:163], a[164:167], a[116:119], v[160:163]
  buffer_load_dwordx4 v13, s[16:19], s43 offen offset:3072 lds
  v_mfma_f32_16x16x32_bf16 v[164:167], a[164:167], a[124:127], v[164:167]
  s_add_u32 m0, s38, 4096
  v_subrev_u32 v53, 3072, v53
  v_accvgpr_write_b32 a187, v53
  v_mfma_f32_16x16x32_bf16 v[164:167], a[160:163], a[120:123], v[164:167]
  s_waitcnt lgkmcnt(4)
  buffer_load_dwordx4 v14, s[16:19], s43 offen offset:0 lds
  v_mfma_f32_16x16x32_bf16 v[168:171], a[168:171], a[96:99], v[168:171]
  ds_read_b64_tr_b16 a[160:161], v20 offset:9344
  v_mfma_f32_16x16x32_bf16 v[168:171], a[172:175], a[100:103], v[168:171]
  ds_read_b64_tr_b16 a[162:163], v21 offset:9344
  v_mfma_f32_16x16x32_bf16 v[172:175], a[172:175], a[108:111], v[172:175]
  ds_read_b64_tr_b16 a[164:165], v22 offset:9344
  v_mfma_f32_16x16x32_bf16 v[172:175], a[168:171], a[104:107], v[172:175]
  ds_read_b64_tr_b16 a[166:167], v23 offset:9344
  v_mfma_f32_16x16x32_bf16 v[176:179], a[168:171], a[112:115], v[176:179]
  v_add_u32 v50, 256, v0
  v_mfma_f32_16x16x32_bf16 v[176:179], a[172:175], a[116:119], v[176:179]
  buffer_load_dwordx4 v15, s[16:19], s43 offen offset:1024 lds
  v_mfma_f32_16x16x32_bf16 v[180:183], a[172:175], a[124:127], v[180:183]
  v_mul_u32_u24 v51, 3641, v50
  v_lshrrev_b32 v51, 16, v51
  v_mfma_f32_16x16x32_bf16 v[180:183], a[168:171], a[120:123], v[180:183]
  s_waitcnt lgkmcnt(4)
  buffer_load_dwordx4 v16, s[16:19], s43 offen offset:2048 lds
  v_mfma_f32_16x16x32_bf16 v[184:187], a[176:179], a[96:99], v[184:187]
  ds_read_b64_tr_b16 a[168:169], v20 offset:160
  v_mfma_f32_16x16x32_bf16 v[184:187], a[180:183], a[100:103], v[184:187]
  ds_read_b64_tr_b16 a[170:171], v21 offset:160
  v_mfma_f32_16x16x32_bf16 v[188:191], a[180:183], a[108:111], v[188:191]
  ds_read_b64_tr_b16 a[172:173], v22 offset:160
  v_mfma_f32_16x16x32_bf16 v[188:191], a[176:179], a[104:107], v[188:191]
  ds_read_b64_tr_b16 a[174:175], v23 offset:160
  v_mfma_f32_16x16x32_bf16 v[192:195], a[176:179], a[112:115], v[192:195]
  v_mad_i32_i24 v50, v51, s88, v50
  v_mfma_f32_16x16x32_bf16 v[192:195], a[180:183], a[116:119], v[192:195]
  buffer_load_dwordx4 v17, s[16:19], s43 offen offset:3072 lds
  v_mfma_f32_16x16x32_bf16 v[196:199], a[180:183], a[124:127], v[196:199]
  v_add_u32 v50, s89, v50
  v_subrev_u32 v52, 18, v50
  v_mfma_f32_16x16x32_bf16 v[196:199], a[176:179], a[120:123], v[196:199]
  s_waitcnt lgkmcnt(4)
  v_mfma_f32_16x16x32_bf16 v[200:203], a[160:163], a[96:99], v[200:203]
  ds_read_b64_tr_b16 a[176:177], v20 offset:9376
  v_mfma_f32_16x16x32_bf16 v[200:203], a[164:167], a[100:103], v[200:203]
  ds_read_b64_tr_b16 a[178:179], v21 offset:9376
  v_mfma_f32_16x16x32_bf16 v[204:207], a[164:167], a[108:111], v[204:207]
  ds_read_b64_tr_b16 a[180:181], v22 offset:9376
  v_mfma_f32_16x16x32_bf16 v[204:207], a[160:163], a[104:107], v[204:207]
  ds_read_b64_tr_b16 a[182:183], v23 offset:9376
  v_mfma_f32_16x16x32_bf16 v[208:211], a[160:163], a[112:115], v[208:211]
  v_min_u32 v50, v50, v52
  v_mfma_f32_16x16x32_bf16 v[208:211], a[164:167], a[116:119], v[208:211]
  v_mfma_f32_16x16x32_bf16 v[212:215], a[164:167], a[124:127], v[212:215]
  v_mul_u32_u24 v51, 1152, v51
  v_lshl_add_u32 v53, v50, 4, v51
  v_mfma_f32_16x16x32_bf16 v[212:215], a[160:163], a[120:123], v[212:215]
  s_waitcnt lgkmcnt(4)
  v_mfma_f32_16x16x32_bf16 v[216:219], a[168:171], a[96:99], v[216:219]
  ds_read_b64_tr_b16 a[160:161], v20 offset:192
  v_mfma_f32_16x16x32_bf16 v[216:219], a[172:175], a[100:103], v[216:219]
  ds_read_b64_tr_b16 a[162:163], v21 offset:192
  v_mfma_f32_16x16x32_bf16 v[220:223], a[172:175], a[108:111], v[220:223]
  ds_read_b64_tr_b16 a[164:165], v22 offset:192
  v_mfma_f32_16x16x32_bf16 v[220:223], a[168:171], a[104:107], v[220:223]
  ds_read_b64_tr_b16 a[166:167], v23 offset:192
  v_mfma_f32_16x16x32_bf16 v[224:227], a[168:171], a[112:115], v[224:227]
  v_accvgpr_write_b32 a188, v53
  v_mfma_f32_16x16x32_bf16 v[224:227], a[172:175], a[116:119], v[224:227]
  v_mfma_f32_16x16x32_bf16 v[228:231], a[172:175], a[124:127], v[228:231]
  v_add_u32 v50, 320, v0
  v_mfma_f32_16x16x32_bf16 v[228:231], a[168:171], a[120:123], v[228:231]
  s_waitcnt lgkmcnt(4)
  v_mfma_f32_16x16x32_bf16 v[232:235], a[176:179], a[96:99], v[232:235]
  ds_read_b64_tr_b16 a[168:169], v20 offset:9408
  v_mfma_f32_16x16x32_bf16 v[232:235], a[180:183], a[100:103], v[232:235]
  ds_read_b64_tr_b16 a[170:171], v21 offset:9408
  v_mfma_f32_16x16x32_bf16 v[236:239], a[180:183], a[108:111], v[236:239]
  ds_read_b64_tr_b16 a[172:173], v22 offset:9408
  v_mfma_f32_16x16x32_bf16 v[236:239], a[176:179], a[104:107], v[236:239]
  ds_read_b64_tr_b16 a[174:175], v23 offset:9408
  v_mfma_f32_16x16x32_bf16 v[240:243], a[176:179], a[112:115], v[240:243]
  v_mfma_f32_16x16x32_bf16 v[240:243], a[180:183], a[116:119], v[240:243]
  v_mfma_f32_16x16x32_bf16 v[244:247], a[180:183], a[124:127], v[244:247]
  v_mfma_f32_16x16x32_bf16 v[244:247], a[176:179], a[120:123], v[244:247]
  s_waitcnt lgkmcnt(4)
  v_mfma_f32_16x16x32_bf16 a[0:3], a[160:163], a[96:99], a[0:3]
  ds_read_b64_tr_b16 a[176:177], v20 offset:224
  v_mfma_f32_16x16x32_bf16 a[0:3], a[164:167], a[100:103], a[0:3]
  ds_read_b64_tr_b16 a[178:179], v21 offset:224
  v_mfma_f32_16x16x32_bf16 a[4:7], a[164:167], a[108:111], a[4:7]
  ds_read_b64_tr_b16 a[180:181], v22 offset:224
  v_mfma_f32_16x16x32_bf16 a[4:7], a[160:163], a[104:107], a[4:7]
  ds_read_b64_tr_b16 a[182:183], v23 offset:224
  v_mfma_f32_16x16x32_bf16 a[8:11], a[160:163], a[112:115], a[8:11]
  s_cmp_lg_u32 s28, 0
  s_cbranch_scc1 L_n2
  v_readfirstlane_b32 s60, v253
  s_mov_b32 s64, 0
L_nonce_spin:
  s_cmp_lg_u32 s60, 0
  s_cbranch_scc1 L_nonce_ok
  buffer_load_dword v253, v254, s[56:59], 0 offen sc1
  s_waitcnt vmcnt(0)
  v_readfirstlane_b32 s60, v253
  s_add_u32 s64, s64, 1
  s_cmp_lt_u32 s64, 20000
  s_cbranch_scc1 L_nonce_spin
L_nonce_ok:
  v_mov_b32 v253, s60
  v_mov_b32 v255, 157696
  ds_write_b32 v255, v253
L_n2:
  v_mfma_f32_16x16x32_bf16 a[8:11], a[164:167], a[116:119], a[8:11]
  v_mfma_f32_16x16x32_bf16 a[12:15], a[164:167], a[124:127], a[12:15]
  v_mfma_f32_16x16x32_bf16 a[12:15], a[160:163], a[120:123], a[12:15]
  s_waitcnt lgkmcnt(4)
  v_mfma_f32_16x16x32_bf16 a[16:19], a[168:171], a[96:99], a[16:19]
  ds_read_b64_tr_b16 a[160:161], v20 offset:9440
  v_mfma_f32_16x16x32_bf16 a[16:19], a[172:175], a[100:103], a[16:19]
  ds_read_b64_tr_b16 a[162:163], v21 offset:9440
  v_mfma_f32_16x16x32_bf16 a[20:23], a[172:175], a[108:111], a[20:23]
  ds_read_b64_tr_b16 a[164:165], v22 offset:9440
  v_mfma_f32_16x16x32_bf16 a[20:23], a[168:171], a[104:107], a[20:23]
  ds_read_b64_tr_b16 a[166:167], v23 offset:9440
  v_mfma_f32_16x16x32_bf16 a[24:27], a[168:171], a[112:115], a[24:27]
  s_mov_b32 s63, 4128768
  v_mfma_f32_16x16x32_bf16 a[24:27], a[172:175], a[116:119], a[24:27]
  buffer_load_dword v252, v248, s[20:23], s63 offen
  v_mfma_f32_16x16x32_bf16 a[28:31], a[172:175], a[124:127], a[28:31]
  s_mov_b32 s63, 1024
  v_mfma_f32_16x16x32_bf16 a[28:31], a[168:171], a[120:123], a[28:31]
  s_waitcnt lgkmcnt(4)
  buffer_load_dword v252, v249, s[16:19], s63 offen
  v_mfma_f32_16x16x32_bf16 a[32:35], a[176:179], a[96:99], a[32:35]
  ds_read_b64_tr_b16 a[168:169], v20 offset:256
  v_mfma_f32_16x16x32_bf16 a[32:35], a[180:183], a[100:103], a[32:35]
  ds_read_b64_tr_b16 a[170:171], v21 offset:256
  v_mfma_f32_16x16x32_bf16 a[36:39], a[180:183], a[108:111], a[36:39]
  ds_read_b64_tr_b16 a[172:173], v22 offset:256
  v_mfma_f32_16x16x32_bf16 a[36:39], a[176:179], a[104:107], a[36:39]
  ds_read_b64_tr_b16 a[174:175], v23 offset:256
  v_mfma_f32_16x16x32_bf16 a[40:43], a[176:179], a[112:115], a[40:43]
  s_lshl_b32 s62, s3, 7
  s_add_u32 s62, s62, L_slab5-standalone__glu_gated_geglu__prompt_kernel
  s_min_u32 s62, s62, L_end-standalone__glu_gated_geglu__prompt_kernel
  s_add_u32 s62, s62, s100
  s_addc_u32 s63, s101, 0
  v_mov_b32 v46, s62
  v_mov_b32 v47, s63
  v_mfma_f32_16x16x32_bf16 a[40:43], a[180:183], a[116:119], a[40:43]
  global_load_dword v252, v[46:47], off
  v_mfma_f32_16x16x32_bf16 a[44:47], a[180:183], a[124:127], a[44:47]
  s_movk_i32 s63, 2176
  v_mfma_f32_16x16x32_bf16 a[44:47], a[176:179], a[120:123], a[44:47]
  s_waitcnt lgkmcnt(4)
  buffer_load_dword v252, v55, s[68:71], s63 offen
  v_mfma_f32_16x16x32_bf16 a[48:51], a[160:163], a[96:99], a[48:51]
  ds_read_b64_tr_b16 a[176:177], v20 offset:9472
  v_mfma_f32_16x16x32_bf16 a[48:51], a[164:167], a[100:103], a[48:51]
  ds_read_b64_tr_b16 a[178:179], v21 offset:9472
  v_mfma_f32_16x16x32_bf16 a[52:55], a[164:167], a[108:111], a[52:55]
  ds_read_b64_tr_b16 a[180:181], v22 offset:9472
  v_mfma_f32_16x16x32_bf16 a[52:55], a[160:163], a[104:107], a[52:55]
  ds_read_b64_tr_b16 a[182:183], v23 offset:9472
  v_mfma_f32_16x16x32_bf16 a[56:59], a[160:163], a[112:115], a[56:59]
  v_mfma_f32_16x16x32_bf16 a[56:59], a[164:167], a[116:119], a[56:59]
  v_mfma_f32_16x16x32_bf16 a[60:63], a[164:167], a[124:127], a[60:63]
  v_mfma_f32_16x16x32_bf16 a[60:63], a[160:163], a[120:123], a[60:63]
  s_waitcnt vmcnt(12) lgkmcnt(0)
  s_barrier
  v_add_u32 v20, 65536, v18
  v_add_u32 v21, 65536, v19
  v_add_u32 v22, 83968, v18
  v_add_u32 v23, 83968, v19
  v_mfma_f32_16x16x32_bf16 a[64:67], a[168:171], a[96:99], a[64:67]
  ds_read_b64_tr_b16 a[160:161], v20 offset:0
  v_mfma_f32_16x16x32_bf16 a[64:67], a[172:175], a[100:103], a[64:67]
  ds_read_b64_tr_b16 a[162:163], v21 offset:0
  v_mfma_f32_16x16x32_bf16 a[68:71], a[172:175], a[108:111], a[68:71]
  ds_read_b64_tr_b16 a[164:165], v22 offset:0
  v_mfma_f32_16x16x32_bf16 a[68:71], a[168:171], a[104:107], a[68:71]
  ds_read_b64_tr_b16 a[166:167], v23 offset:0
  v_mfma_f32_16x16x32_bf16 a[72:75], a[168:171], a[112:115], a[72:75]
  ds_read_b128 a[128:131], v24 offset:32768
  v_mfma_f32_16x16x32_bf16 a[72:75], a[172:175], a[116:119], a[72:75]
  ds_read_b128 a[132:135], v25 offset:32768
  v_mfma_f32_16x16x32_bf16 a[76:79], a[172:175], a[124:127], a[76:79]
  ds_read_b128 a[136:139], v24 offset:34816
  v_mfma_f32_16x16x32_bf16 a[76:79], a[168:171], a[120:123], a[76:79]
  ds_read_b128 a[140:143], v25 offset:34816
  v_mfma_f32_16x16x32_bf16 a[80:83], a[176:179], a[96:99], a[80:83]
  ds_read_b128 a[144:147], v24 offset:36864
  v_mfma_f32_16x16x32_bf16 a[80:83], a[180:183], a[100:103], a[80:83]
  ds_read_b128 a[148:151], v25 offset:36864
  v_mfma_f32_16x16x32_bf16 a[84:87], a[180:183], a[108:111], a[84:87]
  ds_read_b128 a[152:155], v24 offset:38912
  v_mfma_f32_16x16x32_bf16 a[84:87], a[176:179], a[104:107], a[84:87]
  ds_read_b128 a[156:159], v25 offset:38912
  v_mfma_f32_16x16x32_bf16 a[88:91], a[176:179], a[112:115], a[88:91]
  ds_read_b64_tr_b16 a[168:169], v20 offset:9216
  v_mfma_f32_16x16x32_bf16 a[88:91], a[180:183], a[116:119], a[88:91]
  ds_read_b64_tr_b16 a[170:171], v21 offset:9216
  v_mfma_f32_16x16x32_bf16 a[92:95], a[180:183], a[124:127], a[92:95]
  ds_read_b64_tr_b16 a[172:173], v22 offset:9216
  v_mfma_f32_16x16x32_bf16 a[92:95], a[176:179], a[120:123], a[92:95]
  ds_read_b64_tr_b16 a[174:175], v23 offset:9216
L_slab5:
  s_waitcnt lgkmcnt(4)
  v_mfma_f32_16x16x32_bf16 v[56:59], a[160:163], a[128:131], v[56:59]
  ds_read_b64_tr_b16 a[176:177], v20 offset:32
  v_mfma_f32_16x16x32_bf16 v[56:59], a[164:167], a[132:135], v[56:59]
  ds_read_b64_tr_b16 a[178:179], v21 offset:32
  v_mfma_f32_16x16x32_bf16 v[60:63], a[164:167], a[140:143], v[60:63]
  ds_read_b64_tr_b16 a[180:181], v22 offset:32
  v_mfma_f32_16x16x32_bf16 v[60:63], a[160:163], a[136:139], v[60:63]
  ds_read_b64_tr_b16 a[182:183], v23 offset:32
  v_mfma_f32_16x16x32_bf16 v[64:67], a[160:163], a[144:147], v[64:67]
  s_mul_i32 s45, s29, 0
  s_add_u32 s45, s45, s37
  s_add_u32 s45, s45, 3538944
  s_mul_i32 s44, s29, 18432
  s_add_u32 s44, s44, s39
  s_add_u32 m0, s44, 36864
  v_mul_u32_u24 v51, 3641, v50
  v_mfma_f32_16x16x32_bf16 v[64:67], a[164:167], a[148:151], v[64:67]
  buffer_load_dwordx4 v1, s[20:23], s45 offen offset:0 lds
  v_mfma_f32_16x16x32_bf16 v[68:71], a[164:167], a[156:159], v[68:71]
  v_lshrrev_b32 v51, 16, v51
  v_mad_i32_i24 v50, v51, s88, v50
  v_mfma_f32_16x16x32_bf16 v[68:71], a[160:163], a[152:155], v[68:71]
  s_waitcnt lgkmcnt(4)
  buffer_load_dwordx4 v2, s[20:23], s45 offen offset:1024 lds
  v_mfma_f32_16x16x32_bf16 v[72:75], a[168:171], a[128:131], v[72:75]
  ds_read_b64_tr_b16 a[160:161], v20 offset:9248
  v_mfma_f32_16x16x32_bf16 v[72:75], a[172:175], a[132:135], v[72:75]
  ds_read_b64_tr_b16 a[162:163], v21 offset:9248
  v_mfma_f32_16x16x32_bf16 v[76:79], a[172:175], a[140:143], v[76:79]
  ds_read_b64_tr_b16 a[164:165], v22 offset:9248
  v_mfma_f32_16x16x32_bf16 v[76:79], a[168:171], a[136:139], v[76:79]
  ds_read_b64_tr_b16 a[166:167], v23 offset:9248
  v_mfma_f32_16x16x32_bf16 v[80:83], a[168:171], a[144:147], v[80:83]
  v_add_u32 v50, s89, v50
  v_mfma_f32_16x16x32_bf16 v[80:83], a[172:175], a[148:151], v[80:83]
  buffer_load_dwordx4 v3, s[20:23], s45 offen offset:2048 lds
  v_mfma_f32_16x16x32_bf16 v[84:87], a[172:175], a[156:159], v[84:87]
  v_subrev_u32 v52, 18, v50
  v_min_u32 v50, v50, v52
  v_mfma_f32_16x16x32_bf16 v[84:87], a[168:171], a[152:155], v[84:87]
  s_waitcnt lgkmcnt(4)
  buffer_load_dwordx4 v4, s[20:23], s45 offen offset:3072 lds
  v_mfma_f32_16x16x32_bf16 v[88:91], a[176:179], a[128:131], v[88:91]
  ds_read_b64_tr_b16 a[168:169], v20 offset:64
  v_mfma_f32_16x16x32_bf16 v[88:91], a[180:183], a[132:135], v[88:91]
  ds_read_b64_tr_b16 a[170:171], v21 offset:64
  v_mfma_f32_16x16x32_bf16 v[92:95], a[180:183], a[140:143], v[92:95]
  ds_read_b64_tr_b16 a[172:173], v22 offset:64
  v_mfma_f32_16x16x32_bf16 v[92:95], a[176:179], a[136:139], v[92:95]
  ds_read_b64_tr_b16 a[174:175], v23 offset:64
  v_mfma_f32_16x16x32_bf16 v[96:99], a[176:179], a[144:147], v[96:99]
  s_add_u32 m0, s44, 40960
  v_mul_u32_u24 v51, 1152, v51
  v_mov_b32 v255, 157696
  v_mfma_f32_16x16x32_bf16 v[96:99], a[180:183], a[148:151], v[96:99]
  buffer_load_dwordx4 v5, s[20:23], s45 offen offset:0 lds
  ds_read_b32 v253, v255
  v_mfma_f32_16x16x32_bf16 v[100:103], a[180:183], a[156:159], v[100:103]
  v_lshl_add_u32 v53, v50, 4, v51
  v_subrev_u32 v53, 1024, v53
  v_mfma_f32_16x16x32_bf16 v[100:103], a[176:179], a[152:155], v[100:103]
  s_waitcnt lgkmcnt(4)
  buffer_load_dwordx4 v6, s[20:23], s45 offen offset:1024 lds
  v_mfma_f32_16x16x32_bf16 v[104:107], a[160:163], a[128:131], v[104:107]
  ds_read_b64_tr_b16 a[176:177], v20 offset:9280
  v_mfma_f32_16x16x32_bf16 v[104:107], a[164:167], a[132:135], v[104:107]
  ds_read_b64_tr_b16 a[178:179], v21 offset:9280
  v_mfma_f32_16x16x32_bf16 v[108:111], a[164:167], a[140:143], v[108:111]
  ds_read_b64_tr_b16 a[180:181], v22 offset:9280
  v_mfma_f32_16x16x32_bf16 v[108:111], a[160:163], a[136:139], v[108:111]
  ds_read_b64_tr_b16 a[182:183], v23 offset:9280
  v_mfma_f32_16x16x32_bf16 v[112:115], a[160:163], a[144:147], v[112:115]
  v_accvgpr_write_b32 a189, v53
  v_mfma_f32_16x16x32_bf16 v[112:115], a[164:167], a[148:151], v[112:115]
  buffer_load_dwordx4 v7, s[20:23], s45 offen offset:2048 lds
  v_mfma_f32_16x16x32_bf16 v[116:119], a[164:167], a[156:159], v[116:119]
  v_add_u32 v50, 384, v0
  v_mul_u32_u24 v51, 3641, v50
  v_mfma_f32_16x16x32_bf16 v[116:119], a[160:163], a[152:155], v[116:119]
  s_waitcnt lgkmcnt(4)
  buffer_load_dwordx4 v8, s[20:23], s45 offen offset:3072 lds
  v_mfma_f32_16x16x32_bf16 v[120:123], a[168:171], a[128:131], v[120:123]
  ds_read_b64_tr_b16 a[160:161], v20 offset:96
  v_mfma_f32_16x16x32_bf16 v[120:123], a[172:175], a[132:135], v[120:123]
  ds_read_b64_tr_b16 a[162:163], v21 offset:96
  v_mfma_f32_16x16x32_bf16 v[124:127], a[172:175], a[140:143], v[124:127]
  ds_read_b64_tr_b16 a[164:165], v22 offset:96
  v_mfma_f32_16x16x32_bf16 v[124:127], a[168:171], a[136:139], v[124:127]
  ds_read_b64_tr_b16 a[166:167], v23 offset:96
  v_mfma_f32_16x16x32_bf16 v[128:131], a[168:171], a[144:147], v[128:131]
  s_add_u32 m0, s44, 45056
  v_lshrrev_b32 v51, 16, v51
  v_mfma_f32_16x16x32_bf16 v[128:131], a[172:175], a[148:151], v[128:131]
  buffer_load_dwordx4 v9, s[20:23], s45 offen offset:0 lds
  v_mfma_f32_16x16x32_bf16 v[132:135], a[172:175], a[156:159], v[132:135]
  s_add_u32 s43, s36, 896
  s_add_u32 m0, s38, 32768
  v_mad_i32_i24 v50, v51, s88, v50
  v_add_u32 v50, s89, v50
  v_mfma_f32_16x16x32_bf16 v[132:135], a[168:171], a[152:155], v[132:135]
  s_waitcnt lgkmcnt(4)
  buffer_load_dwordx4 v10, s[16:19], s43 offen offset:0 lds
  v_mfma_f32_16x16x32_bf16 v[136:139], a[176:179], a[128:131], v[136:139]
  ds_read_b64_tr_b16 a[168:169], v20 offset:9312
  v_mfma_f32_16x16x32_bf16 v[136:139], a[180:183], a[132:135], v[136:139]
  ds_read_b64_tr_b16 a[170:171], v21 offset:9312
  v_mfma_f32_16x16x32_bf16 v[140:143], a[180:183], a[140:143], v[140:143]
  ds_read_b64_tr_b16 a[172:173], v22 offset:9312
  v_mfma_f32_16x16x32_bf16 v[140:143], a[176:179], a[136:139], v[140:143]
  ds_read_b64_tr_b16 a[174:175], v23 offset:9312
  v_mfma_f32_16x16x32_bf16 v[144:147], a[176:179], a[144:147], v[144:147]
  v_subrev_u32 v52, 18, v50
  v_mfma_f32_16x16x32_bf16 v[144:147], a[180:183], a[148:151], v[144:147]
  buffer_load_dwordx4 v11, s[16:19], s43 offen offset:1024 lds
  v_mfma_f32_16x16x32_bf16 v[148:151], a[180:183], a[156:159], v[148:151]
  v_min_u32 v50, v50, v52
  v_mul_u32_u24 v51, 1152, v51
  v_mfma_f32_16x16x32_bf16 v[148:151], a[176:179], a[152:155], v[148:151]
  s_waitcnt lgkmcnt(4)
  buffer_load_dwordx4 v12, s[16:19], s43 offen offset:2048 lds
  v_mfma_f32_16x16x32_bf16 v[152:155], a[160:163], a[128:131], v[152:155]
  ds_read_b64_tr_b16 a[176:177], v20 offset:128
  v_mfma_f32_16x16x32_bf16 v[152:155], a[164:167], a[132:135], v[152:155]
  ds_read_b64_tr_b16 a[178:179], v21 offset:128
  v_mfma_f32_16x16x32_bf16 v[156:159], a[164:167], a[140:143], v[156:159]
  ds_read_b64_tr_b16 a[180:181], v22 offset:128
  v_mfma_f32_16x16x32_bf16 v[156:159], a[160:163], a[136:139], v[156:159]
  ds_read_b64_tr_b16 a[182:183], v23 offset:128
  v_mfma_f32_16x16x32_bf16 v[160:163], a[160:163], a[144:147], v[160:163]
  v_lshl_add_u32 v53, v50, 4, v51
  v_mfma_f32_16x16x32_bf16 v[160:163], a[164:167], a[148:151], v[160:163]
  buffer_load_dwordx4 v13, s[16:19], s43 offen offset:3072 lds
  v_mfma_f32_16x16x32_bf16 v[164:167], a[164:167], a[156:159], v[164:167]
  s_add_u32 m0, s38, 36864
  v_subrev_u32 v53, 2048, v53
  v_accvgpr_write_b32 a190, v53
  v_mfma_f32_16x16x32_bf16 v[164:167], a[160:163], a[152:155], v[164:167]
  s_waitcnt lgkmcnt(4)
  buffer_load_dwordx4 v14, s[16:19], s43 offen offset:0 lds
  v_mfma_f32_16x16x32_bf16 v[168:171], a[168:171], a[128:131], v[168:171]
  ds_read_b64_tr_b16 a[160:161], v20 offset:9344
  v_mfma_f32_16x16x32_bf16 v[168:171], a[172:175], a[132:135], v[168:171]
  ds_read_b64_tr_b16 a[162:163], v21 offset:9344
  v_mfma_f32_16x16x32_bf16 v[172:175], a[172:175], a[140:143], v[172:175]
  ds_read_b64_tr_b16 a[164:165], v22 offset:9344
  v_mfma_f32_16x16x32_bf16 v[172:175], a[168:171], a[136:139], v[172:175]
  ds_read_b64_tr_b16 a[166:167], v23 offset:9344
  v_mfma_f32_16x16x32_bf16 v[176:179], a[168:171], a[144:147], v[176:179]
  v_add_u32 v50, 448, v0
  v_readfirstlane_b32 s14, v253
  v_mfma_f32_16x16x32_bf16 v[176:179], a[172:175], a[148:151], v[176:179]
  buffer_load_dwordx4 v15, s[16:19], s43 offen offset:1024 lds
  v_mfma_f32_16x16x32_bf16 v[180:183], a[172:175], a[156:159], v[180:183]
  v_mul_u32_u24 v51, 3641, v50
  v_lshrrev_b32 v51, 16, v51
  s_mov_b32 s15, s14
  v_mfma_f32_16x16x32_bf16 v[180:183], a[168:171], a[152:155], v[180:183]
  s_waitcnt lgkmcnt(4)
  buffer_load_dwordx4 v16, s[16:19], s43 offen offset:2048 lds
  v_mfma_f32_16x16x32_bf16 v[184:187], a[176:179], a[128:131], v[184:187]
  ds_read_b64_tr_b16 a[168:169], v20 offset:160
  v_mfma_f32_16x16x32_bf16 v[184:187], a[180:183], a[132:135], v[184:187]
  ds_read_b64_tr_b16 a[170:171], v21 offset:160
  v_mfma_f32_16x16x32_bf16 v[188:191], a[180:183], a[140:143], v[188:191]
  ds_read_b64_tr_b16 a[172:173], v22 offset:160
  v_mfma_f32_16x16x32_bf16 v[188:191], a[176:179], a[136:139], v[188:191]
  ds_read_b64_tr_b16 a[174:175], v23 offset:160
  v_mfma_f32_16x16x32_bf16 v[192:195], a[176:179], a[144:147], v[192:195]
  v_mad_i32_i24 v50, v51, s88, v50
  v_mfma_f32_16x16x32_bf16 v[192:195], a[180:183], a[148:151], v[192:195]
  buffer_load_dwordx4 v17, s[16:19], s43 offen offset:3072 lds
  v_mfma_f32_16x16x32_bf16 v[196:199], a[180:183], a[156:159], v[196:199]
  v_add_u32 v50, s89, v50
  v_subrev_u32 v52, 18, v50
  v_mfma_f32_16x16x32_bf16 v[196:199], a[176:179], a[152:155], v[196:199]
  s_waitcnt lgkmcnt(4)
  v_mfma_f32_16x16x32_bf16 v[200:203], a[160:163], a[128:131], v[200:203]
  ds_read_b64_tr_b16 a[176:177], v20 offset:9376
  v_mfma_f32_16x16x32_bf16 v[200:203], a[164:167], a[132:135], v[200:203]
  ds_read_b64_tr_b16 a[178:179], v21 offset:9376
  v_mfma_f32_16x16x32_bf16 v[204:207], a[164:167], a[140:143], v[204:207]
  ds_read_b64_tr_b16 a[180:181], v22 offset:9376
  v_mfma_f32_16x16x32_bf16 v[204:207], a[160:163], a[136:139], v[204:207]
  ds_read_b64_tr_b16 a[182:183], v23 offset:9376
  v_mfma_f32_16x16x32_bf16 v[208:211], a[160:163], a[144:147], v[208:211]
  v_min_u32 v50, v50, v52
  v_mfma_f32_16x16x32_bf16 v[208:211], a[164:167], a[148:151], v[208:211]
  v_mfma_f32_16x16x32_bf16 v[212:215], a[164:167], a[156:159], v[212:215]
  v_mul_u32_u24 v51, 1152, v51
  v_lshl_add_u32 v53, v50, 4, v51
  v_mfma_f32_16x16x32_bf16 v[212:215], a[160:163], a[152:155], v[212:215]
  s_waitcnt lgkmcnt(4)
  v_mfma_f32_16x16x32_bf16 v[216:219], a[168:171], a[128:131], v[216:219]
  ds_read_b64_tr_b16 a[160:161], v20 offset:192
  v_mfma_f32_16x16x32_bf16 v[216:219], a[172:175], a[132:135], v[216:219]
  ds_read_b64_tr_b16 a[162:163], v21 offset:192
  v_mfma_f32_16x16x32_bf16 v[220:223], a[172:175], a[140:143], v[220:223]
  ds_read_b64_tr_b16 a[164:165], v22 offset:192
  v_mfma_f32_16x16x32_bf16 v[220:223], a[168:171], a[136:139], v[220:223]
  ds_read_b64_tr_b16 a[166:167], v23 offset:192
  v_mfma_f32_16x16x32_bf16 v[224:227], a[168:171], a[144:147], v[224:227]
  v_subrev_u32 v53, 3072, v53
  v_mfma_f32_16x16x32_bf16 v[224:227], a[172:175], a[148:151], v[224:227]
  v_mfma_f32_16x16x32_bf16 v[228:231], a[172:175], a[156:159], v[228:231]
  v_accvgpr_write_b32 a191, v53
  v_mfma_f32_16x16x32_bf16 v[228:231], a[168:171], a[152:155], v[228:231]
  s_waitcnt lgkmcnt(4)
  v_mfma_f32_16x16x32_bf16 v[232:235], a[176:179], a[128:131], v[232:235]
  ds_read_b64_tr_b16 a[168:169], v20 offset:9408
  v_mfma_f32_16x16x32_bf16 v[232:235], a[180:183], a[132:135], v[232:235]
  ds_read_b64_tr_b16 a[170:171], v21 offset:9408
  v_mfma_f32_16x16x32_bf16 v[236:239], a[180:183], a[140:143], v[236:239]
  ds_read_b64_tr_b16 a[172:173], v22 offset:9408
  v_mfma_f32_16x16x32_bf16 v[236:239], a[176:179], a[136:139], v[236:239]
  ds_read_b64_tr_b16 a[174:175], v23 offset:9408
  v_mfma_f32_16x16x32_bf16 v[240:243], a[176:179], a[144:147], v[240:243]
  v_mfma_f32_16x16x32_bf16 v[240:243], a[180:183], a[148:151], v[240:243]
  v_mfma_f32_16x16x32_bf16 v[244:247], a[180:183], a[156:159], v[244:247]
  v_mfma_f32_16x16x32_bf16 v[244:247], a[176:179], a[152:155], v[244:247]
  s_waitcnt lgkmcnt(4)
  v_mfma_f32_16x16x32_bf16 a[0:3], a[160:163], a[128:131], a[0:3]
  ds_read_b64_tr_b16 a[176:177], v20 offset:224
  v_mfma_f32_16x16x32_bf16 a[0:3], a[164:167], a[132:135], a[0:3]
  ds_read_b64_tr_b16 a[178:179], v21 offset:224
  v_mfma_f32_16x16x32_bf16 a[4:7], a[164:167], a[140:143], a[4:7]
  ds_read_b64_tr_b16 a[180:181], v22 offset:224
  v_mfma_f32_16x16x32_bf16 a[4:7], a[160:163], a[136:139], a[4:7]
  ds_read_b64_tr_b16 a[182:183], v23 offset:224
  v_mfma_f32_16x16x32_bf16 a[8:11], a[160:163], a[144:147], a[8:11]
  v_mfma_f32_16x16x32_bf16 a[8:11], a[164:167], a[148:151], a[8:11]
  v_mfma_f32_16x16x32_bf16 a[12:15], a[164:167], a[156:159], a[12:15]
  v_mfma_f32_16x16x32_bf16 a[12:15], a[160:163], a[152:155], a[12:15]
  s_waitcnt lgkmcnt(4)
  v_mfma_f32_16x16x32_bf16 a[16:19], a[168:171], a[128:131], a[16:19]
  ds_read_b64_tr_b16 a[160:161], v20 offset:9440
  v_mfma_f32_16x16x32_bf16 a[16:19], a[172:175], a[132:135], a[16:19]
  ds_read_b64_tr_b16 a[162:163], v21 offset:9440
  v_mfma_f32_16x16x32_bf16 a[20:23], a[172:175], a[140:143], a[20:23]
  ds_read_b64_tr_b16 a[164:165], v22 offset:9440
  v_mfma_f32_16x16x32_bf16 a[20:23], a[168:171], a[136:139], a[20:23]
  ds_read_b64_tr_b16 a[166:167], v23 offset:9440
  v_mfma_f32_16x16x32_bf16 a[24:27], a[168:171], a[144:147], a[24:27]
  s_mov_b32 s63, 4718592
  v_mfma_f32_16x16x32_bf16 a[24:27], a[172:175], a[148:151], a[24:27]
  buffer_load_dword v252, v248, s[20:23], s63 offen
  v_mfma_f32_16x16x32_bf16 a[28:31], a[172:175], a[156:159], a[28:31]
  s_movk_i32 s63, 4352
  v_mfma_f32_16x16x32_bf16 a[28:31], a[168:171], a[152:155], a[28:31]
  s_waitcnt lgkmcnt(4)
  buffer_load_dword v252, v55, s[68:71], s63 offen
  v_mfma_f32_16x16x32_bf16 a[32:35], a[176:179], a[128:131], a[32:35]
  ds_read_b64_tr_b16 a[168:169], v20 offset:256
  v_mfma_f32_16x16x32_bf16 a[32:35], a[180:183], a[132:135], a[32:35]
  ds_read_b64_tr_b16 a[170:171], v21 offset:256
  v_mfma_f32_16x16x32_bf16 a[36:39], a[180:183], a[140:143], a[36:39]
  ds_read_b64_tr_b16 a[172:173], v22 offset:256
  v_mfma_f32_16x16x32_bf16 a[36:39], a[176:179], a[136:139], a[36:39]
  ds_read_b64_tr_b16 a[174:175], v23 offset:256
  v_mfma_f32_16x16x32_bf16 a[40:43], a[176:179], a[144:147], a[40:43]
  v_mfma_f32_16x16x32_bf16 a[40:43], a[180:183], a[148:151], a[40:43]
  v_mfma_f32_16x16x32_bf16 a[44:47], a[180:183], a[156:159], a[44:47]
  v_mfma_f32_16x16x32_bf16 a[44:47], a[176:179], a[152:155], a[44:47]
  s_waitcnt lgkmcnt(4)
  v_mfma_f32_16x16x32_bf16 a[48:51], a[160:163], a[128:131], a[48:51]
  ds_read_b64_tr_b16 a[176:177], v20 offset:9472
  v_mfma_f32_16x16x32_bf16 a[48:51], a[164:167], a[132:135], a[48:51]
  ds_read_b64_tr_b16 a[178:179], v21 offset:9472
  v_mfma_f32_16x16x32_bf16 a[52:55], a[164:167], a[140:143], a[52:55]
  ds_read_b64_tr_b16 a[180:181], v22 offset:9472
  v_mfma_f32_16x16x32_bf16 a[52:55], a[160:163], a[136:139], a[52:55]
  ds_read_b64_tr_b16 a[182:183], v23 offset:9472
  v_mfma_f32_16x16x32_bf16 a[56:59], a[160:163], a[144:147], a[56:59]
  v_mfma_f32_16x16x32_bf16 a[56:59], a[164:167], a[148:151], a[56:59]
  v_mfma_f32_16x16x32_bf16 a[60:63], a[164:167], a[156:159], a[60:63]
  v_mfma_f32_16x16x32_bf16 a[60:63], a[160:163], a[152:155], a[60:63]
  s_waitcnt vmcnt(10) lgkmcnt(0)
  s_barrier
  v_add_u32 v20, 102400, v18
  v_add_u32 v21, 102400, v19
  v_add_u32 v22, 120832, v18
  v_add_u32 v23, 120832, v19
  v_mfma_f32_16x16x32_bf16 a[64:67], a[168:171], a[128:131], a[64:67]
  ds_read_b64_tr_b16 a[160:161], v20 offset:0
  v_mfma_f32_16x16x32_bf16 a[64:67], a[172:175], a[132:135], a[64:67]
  ds_read_b64_tr_b16 a[162:163], v21 offset:0
  v_mfma_f32_16x16x32_bf16 a[68:71], a[172:175], a[140:143], a[68:71]
  ds_read_b64_tr_b16 a[164:165], v22 offset:0
  v_mfma_f32_16x16x32_bf16 a[68:71], a[168:171], a[136:139], a[68:71]
  ds_read_b64_tr_b16 a[166:167], v23 offset:0
  v_mfma_f32_16x16x32_bf16 a[72:75], a[168:171], a[144:147], a[72:75]
  ds_read_b128 a[96:99], v24 offset:0
  v_mfma_f32_16x16x32_bf16 a[72:75], a[172:175], a[148:151], a[72:75]
  ds_read_b128 a[100:103], v25 offset:0
  v_mfma_f32_16x16x32_bf16 a[76:79], a[172:175], a[156:159], a[76:79]
  ds_read_b128 a[104:107], v24 offset:2048
  v_mfma_f32_16x16x32_bf16 a[76:79], a[168:171], a[152:155], a[76:79]
  ds_read_b128 a[108:111], v25 offset:2048
  v_mfma_f32_16x16x32_bf16 a[80:83], a[176:179], a[128:131], a[80:83]
  ds_read_b128 a[112:115], v24 offset:4096
  v_mfma_f32_16x16x32_bf16 a[80:83], a[180:183], a[132:135], a[80:83]
  ds_read_b128 a[116:119], v25 offset:4096
  v_mfma_f32_16x16x32_bf16 a[84:87], a[180:183], a[140:143], a[84:87]
  ds_read_b128 a[120:123], v24 offset:6144
  v_mfma_f32_16x16x32_bf16 a[84:87], a[176:179], a[136:139], a[84:87]
  ds_read_b128 a[124:127], v25 offset:6144
  v_mfma_f32_16x16x32_bf16 a[88:91], a[176:179], a[144:147], a[88:91]
  ds_read_b64_tr_b16 a[168:169], v20 offset:9216
  v_mfma_f32_16x16x32_bf16 a[88:91], a[180:183], a[148:151], a[88:91]
  ds_read_b64_tr_b16 a[170:171], v21 offset:9216
  v_mfma_f32_16x16x32_bf16 a[92:95], a[180:183], a[156:159], a[92:95]
  ds_read_b64_tr_b16 a[172:173], v22 offset:9216
  v_mfma_f32_16x16x32_bf16 a[92:95], a[176:179], a[152:155], a[92:95]
  ds_read_b64_tr_b16 a[174:175], v23 offset:9216
L_slab6:
  s_waitcnt lgkmcnt(4)
  v_mfma_f32_16x16x32_bf16 v[56:59], a[160:163], a[96:99], v[56:59]
  ds_read_b64_tr_b16 a[176:177], v20 offset:32
  v_mfma_f32_16x16x32_bf16 v[56:59], a[164:167], a[100:103], v[56:59]
  ds_read_b64_tr_b16 a[178:179], v21 offset:32
  v_mfma_f32_16x16x32_bf16 v[60:63], a[164:167], a[108:111], v[60:63]
  ds_read_b64_tr_b16 a[180:181], v22 offset:32
  v_mfma_f32_16x16x32_bf16 v[60:63], a[160:163], a[104:107], v[60:63]
  ds_read_b64_tr_b16 a[182:183], v23 offset:32
  v_mfma_f32_16x16x32_bf16 v[64:67], a[160:163], a[112:115], v[64:67]
  s_mul_i32 s45, s29, 0
  s_add_u32 s45, s45, s37
  s_add_u32 s45, s45, 4128768
  s_mul_i32 s44, s29, -73728
  s_add_u32 s44, s44, s39
  s_add_u32 m0, s44, 73728
  v_add_u32 v50, 512, v0
  v_mfma_f32_16x16x32_bf16 v[64:67], a[164:167], a[116:119], v[64:67]
  buffer_load_dwordx4 v1, s[20:23], s45 offen offset:0 lds
  v_mfma_f32_16x16x32_bf16 v[68:71], a[164:167], a[124:127], v[68:71]
  v_mul_u32_u24 v51, 3641, v50
  v_lshrrev_b32 v51, 16, v51
  v_mfma_f32_16x16x32_bf16 v[68:71], a[160:163], a[120:123], v[68:71]
  s_waitcnt lgkmcnt(4)
  buffer_load_dwordx4 v2, s[20:23], s45 offen offset:1024 lds
  v_mfma_f32_16x16x32_bf16 v[72:75], a[168:171], a[96:99], v[72:75]
  ds_read_b64_tr_b16 a[160:161], v20 offset:9248
  v_mfma_f32_16x16x32_bf16 v[72:75], a[172:175], a[100:103], v[72:75]
  ds_read_b64_tr_b16 a[162:163], v21 offset:9248
  v_mfma_f32_16x16x32_bf16 v[76:79], a[172:175], a[108:111], v[76:79]
  ds_read_b64_tr_b16 a[164:165], v22 offset:9248
  v_mfma_f32_16x16x32_bf16 v[76:79], a[168:171], a[104:107], v[76:79]
  ds_read_b64_tr_b16 a[166:167], v23 offset:9248
  v_mfma_f32_16x16x32_bf16 v[80:83], a[168:171], a[112:115], v[80:83]
  v_mad_i32_i24 v50, v51, s88, v50
  v_mfma_f32_16x16x32_bf16 v[80:83], a[172:175], a[116:119], v[80:83]
  buffer_load_dwordx4 v3, s[20:23], s45 offen offset:2048 lds
  v_mfma_f32_16x16x32_bf16 v[84:87], a[172:175], a[124:127], v[84:87]
  v_add_u32 v50, s89, v50
  v_subrev_u32 v52, 18, v50
  v_mfma_f32_16x16x32_bf16 v[84:87], a[168:171], a[120:123], v[84:87]
  s_waitcnt lgkmcnt(4)
  buffer_load_dwordx4 v4, s[20:23], s45 offen offset:3072 lds
  v_mfma_f32_16x16x32_bf16 v[88:91], a[176:179], a[96:99], v[88:91]
  ds_read_b64_tr_b16 a[168:169], v20 offset:64
  v_mfma_f32_16x16x32_bf16 v[88:91], a[180:183], a[100:103], v[88:91]
  ds_read_b64_tr_b16 a[170:171], v21 offset:64
  v_mfma_f32_16x16x32_bf16 v[92:95], a[180:183], a[108:111], v[92:95]
  ds_read_b64_tr_b16 a[172:173], v22 offset:64
  v_mfma_f32_16x16x32_bf16 v[92:95], a[176:179], a[104:107], v[92:95]
  ds_read_b64_tr_b16 a[174:175], v23 offset:64
  v_mfma_f32_16x16x32_bf16 v[96:99], a[176:179], a[112:115], v[96:99]
  s_add_u32 m0, s44, 77824
  v_min_u32 v50, v50, v52
  v_mfma_f32_16x16x32_bf16 v[96:99], a[180:183], a[116:119], v[96:99]
  buffer_load_dwordx4 v5, s[20:23], s45 offen offset:0 lds
  v_mfma_f32_16x16x32_bf16 v[100:103], a[180:183], a[124:127], v[100:103]
  v_mul_u32_u24 v51, 1152, v51
  v_lshl_add_u32 v53, v50, 4, v51
  v_mfma_f32_16x16x32_bf16 v[100:103], a[176:179], a[120:123], v[100:103]
  s_waitcnt lgkmcnt(4)
  buffer_load_dwordx4 v6, s[20:23], s45 offen offset:1024 lds
  v_mfma_f32_16x16x32_bf16 v[104:107], a[160:163], a[96:99], v[104:107]
  ds_read_b64_tr_b16 a[176:177], v20 offset:9280
  v_mfma_f32_16x16x32_bf16 v[104:107], a[164:167], a[100:103], v[104:107]
  ds_read_b64_tr_b16 a[178:179], v21 offset:9280
  v_mfma_f32_16x16x32_bf16 v[108:111], a[164:167], a[108:111], v[108:111]
  ds_read_b64_tr_b16 a[180:181], v22 offset:9280
  v_mfma_f32_16x16x32_bf16 v[108:111], a[160:163], a[104:107], v[108:111]
  ds_read_b64_tr_b16 a[182:183], v23 offset:9280
  v_mfma_f32_16x16x32_bf16 v[112:115], a[160:163], a[112:115], v[112:115]
  v_accvgpr_write_b32 a192, v53
  v_mfma_f32_16x16x32_bf16 v[112:115], a[164:167], a[116:119], v[112:115]
  buffer_load_dwordx4 v7, s[20:23], s45 offen offset:2048 lds
  v_mfma_f32_16x16x32_bf16 v[116:119], a[164:167], a[124:127], v[116:119]
  v_lshrrev_b32 v50, 4, v0
  v_and_b32 v51, 15, v0
  v_mfma_f32_16x16x32_bf16 v[116:119], a[160:163], a[120:123], v[116:119]
  s_waitcnt lgkmcnt(4)
  buffer_load_dwordx4 v8, s[20:23], s45 offen offset:3072 lds
  v_mfma_f32_16x16x32_bf16 v[120:123], a[168:171], a[96:99], v[120:123]
  ds_read_b64_tr_b16 a[160:161], v20 offset:96
  v_mfma_f32_16x16x32_bf16 v[120:123], a[172:175], a[100:103], v[120:123]
  ds_read_b64_tr_b16 a[162:163], v21 offset:96
  v_mfma_f32_16x16x32_bf16 v[124:127], a[172:175], a[108:111], v[124:127]
  ds_read_b64_tr_b16 a[164:165], v22 offset:96
  v_mfma_f32_16x16x32_bf16 v[124:127], a[168:171], a[104:107], v[124:127]
  ds_read_b64_tr_b16 a[166:167], v23 offset:96
  v_mfma_f32_16x16x32_bf16 v[128:131], a[168:171], a[112:115], v[128:131]
  s_add_u32 m0, s44, 81920
  v_lshrrev_b32 v52, 2, v51
  v_mfma_f32_16x16x32_bf16 v[128:131], a[172:175], a[116:119], v[128:131]
  buffer_load_dwordx4 v9, s[20:23], s45 offen offset:0 lds
  v_mfma_f32_16x16x32_bf16 v[132:135], a[172:175], a[124:127], v[132:135]
  s_add_u32 s43, s36, 1024
  s_add_u32 m0, s38, 0
  v_lshlrev_b32 v53, 2, v50
  v_add_u32 v52, v52, v53
  v_mfma_f32_16x16x32_bf16 v[132:135], a[168:171], a[120:123], v[132:135]
  s_waitcnt lgkmcnt(4)
  buffer_load_dwordx4 v10, s[16:19], s43 offen offset:0 lds
  v_mfma_f32_16x16x32_bf16 v[136:139], a[176:179], a[96:99], v[136:139]
  ds_read_b64_tr_b16 a[168:169], v20 offset:9312
  v_mfma_f32_16x16x32_bf16 v[136:139], a[180:183], a[100:103], v[136:139]
  ds_read_b64_tr_b16 a[170:171], v21 offset:9312
  v_mfma_f32_16x16x32_bf16 v[140:143], a[180:183], a[108:111], v[140:143]
  ds_read_b64_tr_b16 a[172:173], v22 offset:9312
  v_mfma_f32_16x16x32_bf16 v[140:143], a[176:179], a[104:107], v[140:143]
  ds_read_b64_tr_b16 a[174:175], v23 offset:9312
  v_mfma_f32_16x16x32_bf16 v[144:147], a[176:179], a[112:115], v[144:147]
  v_mul_u32_u24 v52, 288, v52
  v_mfma_f32_16x16x32_bf16 v[144:147], a[180:183], a[116:119], v[144:147]
  buffer_load_dwordx4 v11, s[16:19], s43 offen offset:1024 lds
  v_mfma_f32_16x16x32_bf16 v[148:151], a[180:183], a[124:127], v[148:151]
  v_and_b32 v53, 3, v51
  v_lshlrev_b32 v53, 3, v53
  v_mfma_f32_16x16x32_bf16 v[148:151], a[176:179], a[120:123], v[148:151]
  s_waitcnt lgkmcnt(4)
  buffer_load_dwordx4 v12, s[16:19], s43 offen offset:2048 lds
  v_mfma_f32_16x16x32_bf16 v[152:155], a[160:163], a[96:99], v[152:155]
  ds_read_b64_tr_b16 a[176:177], v20 offset:128
  v_mfma_f32_16x16x32_bf16 v[152:155], a[164:167], a[100:103], v[152:155]
  ds_read_b64_tr_b16 a[178:179], v21 offset:128
  v_mfma_f32_16x16x32_bf16 v[156:159], a[164:167], a[108:111], v[156:159]
  ds_read_b64_tr_b16 a[180:181], v22 offset:128
  v_mfma_f32_16x16x32_bf16 v[156:159], a[160:163], a[104:107], v[156:159]
  ds_read_b64_tr_b16 a[182:183], v23 offset:128
  v_mfma_f32_16x16x32_bf16 v[160:163], a[160:163], a[112:115], v[160:163]
  v_add_u32 v52, v52, v53
  v_mfma_f32_16x16x32_bf16 v[160:163], a[164:167], a[116:119], v[160:163]
  buffer_load_dwordx4 v13, s[16:19], s43 offen offset:3072 lds
  v_mfma_f32_16x16x32_bf16 v[164:167], a[164:167], a[124:127], v[164:167]
  s_add_u32 m0, s38, 4096
  v_accvgpr_write_b32 a193, v52
  v_lshrrev_b32 v50, 3, v0
  v_mfma_f32_16x16x32_bf16 v[164:167], a[160:163], a[120:123], v[164:167]
  s_waitcnt lgkmcnt(4)
  buffer_load_dwordx4 v14, s[16:19], s43 offen offset:0 lds
  v_mfma_f32_16x16x32_bf16 v[168:171], a[168:171], a[96:99], v[168:171]
  ds_read_b64_tr_b16 a[160:161], v20 offset:9344
  v_mfma_f32_16x16x32_bf16 v[168:171], a[172:175], a[100:103], v[168:171]
  ds_read_b64_tr_b16 a[162:163], v21 offset:9344
  v_mfma_f32_16x16x32_bf16 v[172:175], a[172:175], a[108:111], v[172:175]
  ds_read_b64_tr_b16 a[164:165], v22 offset:9344
  v_mfma_f32_16x16x32_bf16 v[172:175], a[168:171], a[104:107], v[172:175]
  ds_read_b64_tr_b16 a[166:167], v23 offset:9344
  v_mfma_f32_16x16x32_bf16 v[176:179], a[168:171], a[112:115], v[176:179]
  v_mul_u32_u24 v50, 36864, v50
  v_mfma_f32_16x16x32_bf16 v[176:179], a[172:175], a[116:119], v[176:179]
  buffer_load_dwordx4 v15, s[16:19], s43 offen offset:1024 lds
  v_mfma_f32_16x16x32_bf16 v[180:183], a[172:175], a[124:127], v[180:183]
  v_and_b32 v51, 7, v0
  v_lshlrev_b32 v51, 7, v51
  v_mfma_f32_16x16x32_bf16 v[180:183], a[168:171], a[120:123], v[180:183]
  s_waitcnt lgkmcnt(4)
  buffer_load_dwordx4 v16, s[16:19], s43 offen offset:2048 lds
  v_mfma_f32_16x16x32_bf16 v[184:187], a[176:179], a[96:99], v[184:187]
  ds_read_b64_tr_b16 a[168:169], v20 offset:160
  v_mfma_f32_16x16x32_bf16 v[184:187], a[180:183], a[100:103], v[184:187]
  ds_read_b64_tr_b16 a[170:171], v21 offset:160
  v_mfma_f32_16x16x32_bf16 v[188:191], a[180:183], a[108:111], v[188:191]
  ds_read_b64_tr_b16 a[172:173], v22 offset:160
  v_mfma_f32_16x16x32_bf16 v[188:191], a[176:179], a[104:107], v[188:191]
  ds_read_b64_tr_b16 a[174:175], v23 offset:160
  v_mfma_f32_16x16x32_bf16 v[192:195], a[176:179], a[112:115], v[192:195]
  v_add_u32 v50, v50, v51
  v_mfma_f32_16x16x32_bf16 v[192:195], a[180:183], a[116:119], v[192:195]
  buffer_load_dwordx4 v17, s[16:19], s43 offen offset:3072 lds
  v_mfma_f32_16x16x32_bf16 v[196:199], a[180:183], a[124:127], v[196:199]
  v_mov_b32 v51, 2130706432
  v_cmp_gt_u32 vcc, 32, v0
  s_nop 1
  v_cndmask_b32 v50, v51, v50, vcc
  v_mfma_f32_16x16x32_bf16 v[196:199], a[176:179], a[120:123], v[196:199]
  s_waitcnt lgkmcnt(4)
  v_mfma_f32_16x16x32_bf16 v[200:203], a[160:163], a[96:99], v[200:203]
  ds_read_b64_tr_b16 a[176:177], v20 offset:9376
  v_mfma_f32_16x16x32_bf16 v[200:203], a[164:167], a[100:103], v[200:203]
  ds_read_b64_tr_b16 a[178:179], v21 offset:9376
  v_mfma_f32_16x16x32_bf16 v[204:207], a[164:167], a[108:111], v[204:207]
  ds_read_b64_tr_b16 a[180:181], v22 offset:9376
  v_mfma_f32_16x16x32_bf16 v[204:207], a[160:163], a[104:107], v[204:207]
  ds_read_b64_tr_b16 a[182:183], v23 offset:9376
  v_mfma_f32_16x16x32_bf16 v[208:211], a[160:163], a[112:115], v[208:211]
  v_accvgpr_write_b32 a194, v50
  v_mfma_f32_16x16x32_bf16 v[208:211], a[164:167], a[116:119], v[208:211]
  v_mfma_f32_16x16x32_bf16 v[212:215], a[164:167], a[124:127], v[212:215]
  v_lshlrev_b32 v50, 7, v0
  v_mov_b32 v51, 2130706432
  v_mfma_f32_16x16x32_bf16 v[212:215], a[160:163], a[120:123], v[212:215]
  s_waitcnt lgkmcnt(4)
  v_mfma_f32_16x16x32_bf16 v[216:219], a[168:171], a[96:99], v[216:219]
  ds_read_b64_tr_b16 a[160:161], v20 offset:192
  v_mfma_f32_16x16x32_bf16 v[216:219], a[172:175], a[100:103], v[216:219]
  ds_read_b64_tr_b16 a[162:163], v21 offset:192
  v_mfma_f32_16x16x32_bf16 v[220:223], a[172:175], a[108:111], v[220:223]
  ds_read_b64_tr_b16 a[164:165], v22 offset:192
  v_mfma_f32_16x16x32_bf16 v[220:223], a[168:171], a[104:107], v[220:223]
  ds_read_b64_tr_b16 a[166:167], v23 offset:192
  v_mfma_f32_16x16x32_bf16 v[224:227], a[168:171], a[112:115], v[224:227]
  v_cmp_gt_u32 vcc, 8, v0
  s_nop 1
  v_cndmask_b32 v248, v51, v50, vcc
  v_mfma_f32_16x16x32_bf16 v[224:227], a[172:175], a[116:119], v[224:227]
  v_mfma_f32_16x16x32_bf16 v[228:231], a[172:175], a[124:127], v[228:231]
  v_mfma_f32_16x16x32_bf16 v[228:231], a[168:171], a[120:123], v[228:231]
  s_waitcnt lgkmcnt(4)
  v_mfma_f32_16x16x32_bf16 v[232:235], a[176:179], a[96:99], v[232:235]
  ds_read_b64_tr_b16 a[168:169], v20 offset:9408
  v_mfma_f32_16x16x32_bf16 v[232:235], a[180:183], a[100:103], v[232:235]
  ds_read_b64_tr_b16 a[170:171], v21 offset:9408
  v_mfma_f32_16x16x32_bf16 v[236:239], a[180:183], a[108:111], v[236:239]
  ds_read_b64_tr_b16 a[172:173], v22 offset:9408
  v_mfma_f32_16x16x32_bf16 v[236:239], a[176:179], a[104:107], v[236:239]
  ds_read_b64_tr_b16 a[174:175], v23 offset:9408
  v_mfma_f32_16x16x32_bf16 v[240:243], a[176:179], a[112:115], v[240:243]
  v_mfma_f32_16x16x32_bf16 v[240:243], a[180:183], a[116:119], v[240:243]
  v_mfma_f32_16x16x32_bf16 v[244:247], a[180:183], a[124:127], v[244:247]
  v_mfma_f32_16x16x32_bf16 v[244:247], a[176:179], a[120:123], v[244:247]
  s_waitcnt lgkmcnt(4)
  v_mfma_f32_16x16x32_bf16 a[0:3], a[160:163], a[96:99], a[0:3]
  ds_read_b64_tr_b16 a[176:177], v20 offset:224
  v_mfma_f32_16x16x32_bf16 a[0:3], a[164:167], a[100:103], a[0:3]
  ds_read_b64_tr_b16 a[178:179], v21 offset:224
  v_mfma_f32_16x16x32_bf16 a[4:7], a[164:167], a[108:111], a[4:7]
  ds_read_b64_tr_b16 a[180:181], v22 offset:224
  v_mfma_f32_16x16x32_bf16 a[4:7], a[160:163], a[104:107], a[4:7]
  ds_read_b64_tr_b16 a[182:183], v23 offset:224
  v_mfma_f32_16x16x32_bf16 a[8:11], a[160:163], a[112:115], a[8:11]
  v_mfma_f32_16x16x32_bf16 a[8:11], a[164:167], a[116:119], a[8:11]
  v_mfma_f32_16x16x32_bf16 a[12:15], a[164:167], a[124:127], a[12:15]
  v_mfma_f32_16x16x32_bf16 a[12:15], a[160:163], a[120:123], a[12:15]
  s_waitcnt lgkmcnt(4)
  v_mfma_f32_16x16x32_bf16 a[16:19], a[168:171], a[96:99], a[16:19]
  ds_read_b64_tr_b16 a[160:161], v20 offset:9440
  v_mfma_f32_16x16x32_bf16 a[16:19], a[172:175], a[100:103], a[16:19]
  ds_read_b64_tr_b16 a[162:163], v21 offset:9440
  v_mfma_f32_16x16x32_bf16 a[20:23], a[172:175], a[108:111], a[20:23]
  ds_read_b64_tr_b16 a[164:165], v22 offset:9440
  v_mfma_f32_16x16x32_bf16 a[20:23], a[168:171], a[104:107], a[20:23]
  ds_read_b64_tr_b16 a[166:167], v23 offset:9440
  v_mfma_f32_16x16x32_bf16 a[24:27], a[168:171], a[112:115], a[24:27]
  s_lshl_b32 s62, s3, 7
  s_add_u32 s62, s62, L_slab7-standalone__glu_gated_geglu__prompt_kernel
  s_min_u32 s62, s62, L_end-standalone__glu_gated_geglu__prompt_kernel
  s_add_u32 s62, s62, s100
  s_addc_u32 s63, s101, 0
  v_mov_b32 v46, s62
  v_mov_b32 v47, s63
  v_mfma_f32_16x16x32_bf16 a[24:27], a[172:175], a[116:119], a[24:27]
  global_load_dword v252, v[46:47], off
  v_mfma_f32_16x16x32_bf16 a[28:31], a[172:175], a[124:127], a[28:31]
  s_movk_i32 s63, 6528
  v_mfma_f32_16x16x32_bf16 a[28:31], a[168:171], a[120:123], a[28:31]
  s_waitcnt lgkmcnt(4)
  buffer_load_dword v252, v55, s[68:71], s63 offen
  v_mfma_f32_16x16x32_bf16 a[32:35], a[176:179], a[96:99], a[32:35]
  ds_read_b64_tr_b16 a[168:169], v20 offset:256
  v_mfma_f32_16x16x32_bf16 a[32:35], a[180:183], a[100:103], a[32:35]
  ds_read_b64_tr_b16 a[170:171], v21 offset:256
  v_mfma_f32_16x16x32_bf16 a[36:39], a[180:183], a[108:111], a[36:39]
  ds_read_b64_tr_b16 a[172:173], v22 offset:256
  v_mfma_f32_16x16x32_bf16 a[36:39], a[176:179], a[104:107], a[36:39]
  ds_read_b64_tr_b16 a[174:175], v23 offset:256
  v_mfma_f32_16x16x32_bf16 a[40:43], a[176:179], a[112:115], a[40:43]
  s_movk_i32 s63, 8704
  v_mfma_f32_16x16x32_bf16 a[40:43], a[180:183], a[116:119], a[40:43]
  buffer_load_dword v252, v55, s[68:71], s63 offen
  v_mfma_f32_16x16x32_bf16 a[44:47], a[180:183], a[124:127], a[44:47]
  v_mfma_f32_16x16x32_bf16 a[44:47], a[176:179], a[120:123], a[44:47]
  s_waitcnt lgkmcnt(4)
  v_mfma_f32_16x16x32_bf16 a[48:51], a[160:163], a[96:99], a[48:51]
  ds_read_b64_tr_b16 a[176:177], v20 offset:9472
  v_mfma_f32_16x16x32_bf16 a[48:51], a[164:167], a[100:103], a[48:51]
  ds_read_b64_tr_b16 a[178:179], v21 offset:9472
  v_mfma_f32_16x16x32_bf16 a[52:55], a[164:167], a[108:111], a[52:55]
  ds_read_b64_tr_b16 a[180:181], v22 offset:9472
  v_mfma_f32_16x16x32_bf16 a[52:55], a[160:163], a[104:107], a[52:55]
  ds_read_b64_tr_b16 a[182:183], v23 offset:9472
  v_mfma_f32_16x16x32_bf16 a[56:59], a[160:163], a[112:115], a[56:59]
  v_mfma_f32_16x16x32_bf16 a[56:59], a[164:167], a[116:119], a[56:59]
  v_mfma_f32_16x16x32_bf16 a[60:63], a[164:167], a[124:127], a[60:63]
  v_mfma_f32_16x16x32_bf16 a[60:63], a[160:163], a[120:123], a[60:63]
  s_waitcnt vmcnt(11) lgkmcnt(0)
  s_barrier
  v_add_u32 v20, 139264, v18
  v_add_u32 v21, 139264, v19
  v_add_u32 v22, 65536, v18
  v_add_u32 v23, 65536, v19
  v_mfma_f32_16x16x32_bf16 a[64:67], a[168:171], a[96:99], a[64:67]
  ds_read_b64_tr_b16 a[160:161], v20 offset:0
  v_mfma_f32_16x16x32_bf16 a[64:67], a[172:175], a[100:103], a[64:67]
  ds_read_b64_tr_b16 a[162:163], v21 offset:0
  v_mfma_f32_16x16x32_bf16 a[68:71], a[172:175], a[108:111], a[68:71]
  ds_read_b64_tr_b16 a[164:165], v22 offset:0
  v_mfma_f32_16x16x32_bf16 a[68:71], a[168:171], a[104:107], a[68:71]
  ds_read_b64_tr_b16 a[166:167], v23 offset:0
  v_mfma_f32_16x16x32_bf16 a[72:75], a[168:171], a[112:115], a[72:75]
  ds_read_b128 a[128:131], v24 offset:32768
  v_mfma_f32_16x16x32_bf16 a[72:75], a[172:175], a[116:119], a[72:75]
  ds_read_b128 a[132:135], v25 offset:32768
  v_mfma_f32_16x16x32_bf16 a[76:79], a[172:175], a[124:127], a[76:79]
  ds_read_b128 a[136:139], v24 offset:34816
  v_mfma_f32_16x16x32_bf16 a[76:79], a[168:171], a[120:123], a[76:79]
  ds_read_b128 a[140:143], v25 offset:34816
  v_mfma_f32_16x16x32_bf16 a[80:83], a[176:179], a[96:99], a[80:83]
  ds_read_b128 a[144:147], v24 offset:36864
  v_mfma_f32_16x16x32_bf16 a[80:83], a[180:183], a[100:103], a[80:83]
  ds_read_b128 a[148:151], v25 offset:36864
  v_mfma_f32_16x16x32_bf16 a[84:87], a[180:183], a[108:111], a[84:87]
  ds_read_b128 a[152:155], v24 offset:38912
  v_mfma_f32_16x16x32_bf16 a[84:87], a[176:179], a[104:107], a[84:87]
  ds_read_b128 a[156:159], v25 offset:38912
  v_mfma_f32_16x16x32_bf16 a[88:91], a[176:179], a[112:115], a[88:91]
  ds_read_b64_tr_b16 a[168:169], v20 offset:9216
  v_mfma_f32_16x16x32_bf16 a[88:91], a[180:183], a[116:119], a[88:91]
  ds_read_b64_tr_b16 a[170:171], v21 offset:9216
  v_mfma_f32_16x16x32_bf16 a[92:95], a[180:183], a[124:127], a[92:95]
  ds_read_b64_tr_b16 a[172:173], v22 offset:9216
  v_mfma_f32_16x16x32_bf16 a[92:95], a[176:179], a[120:123], a[92:95]
  ds_read_b64_tr_b16 a[174:175], v23 offset:9216
L_slab7:
  s_waitcnt lgkmcnt(4)
  v_mfma_f32_16x16x32_bf16 v[56:59], a[160:163], a[128:131], v[56:59]
  ds_read_b64_tr_b16 a[176:177], v20 offset:32
  v_mfma_f32_16x16x32_bf16 v[56:59], a[164:167], a[132:135], v[56:59]
  ds_read_b64_tr_b16 a[178:179], v21 offset:32
  v_mfma_f32_16x16x32_bf16 v[60:63], a[164:167], a[140:143], v[60:63]
  ds_read_b64_tr_b16 a[180:181], v22 offset:32
  v_mfma_f32_16x16x32_bf16 v[60:63], a[160:163], a[136:139], v[60:63]
  ds_read_b64_tr_b16 a[182:183], v23 offset:32
  v_mfma_f32_16x16x32_bf16 v[64:67], a[160:163], a[144:147], v[64:67]
  s_mul_i32 s45, s29, 0
  s_add_u32 s45, s45, s37
  s_add_u32 s45, s45, 4718592
  s_mul_i32 s44, s29, 18432
  s_add_u32 s44, s44, s39
  s_add_u32 m0, s44, 18432
  s_lshr_b32 s40, s31, 2
  s_and_b32 s41, s31, 3
  v_mfma_f32_16x16x32_bf16 v[64:67], a[164:167], a[148:151], v[64:67]
  buffer_load_dwordx4 v1, s[20:23], s45 offen offset:0 lds
  v_mfma_f32_16x16x32_bf16 v[68:71], a[164:167], a[156:159], v[68:71]
  s_mul_i32 s78, s32, 1327104
  s_mul_i32 s42, s41, 288
  s_add_u32 s78, s78, s42
  s_mul_i32 s42, s29, 9
  v_mfma_f32_16x16x32_bf16 v[68:71], a[160:163], a[152:155], v[68:71]
  s_waitcnt lgkmcnt(4)
  buffer_load_dwordx4 v2, s[20:23], s45 offen offset:1024 lds
  v_mfma_f32_16x16x32_bf16 v[72:75], a[168:171], a[128:131], v[72:75]
  ds_read_b64_tr_b16 a[160:161], v20 offset:9248
  v_mfma_f32_16x16x32_bf16 v[72:75], a[172:175], a[132:135], v[72:75]
  ds_read_b64_tr_b16 a[162:163], v21 offset:9248
  v_mfma_f32_16x16x32_bf16 v[76:79], a[172:175], a[140:143], v[76:79]
  ds_read_b64_tr_b16 a[164:165], v22 offset:9248
  v_mfma_f32_16x16x32_bf16 v[76:79], a[168:171], a[136:139], v[76:79]
  ds_read_b64_tr_b16 a[166:167], v23 offset:9248
  v_mfma_f32_16x16x32_bf16 v[80:83], a[168:171], a[144:147], v[80:83]
  s_mul_i32 s79, s30, 5
  s_add_u32 s42, s42, s79
  v_mfma_f32_16x16x32_bf16 v[80:83], a[172:175], a[148:151], v[80:83]
  buffer_load_dwordx4 v3, s[20:23], s45 offen offset:2048 lds
  v_mfma_f32_16x16x32_bf16 v[84:87], a[172:175], a[156:159], v[84:87]
  s_mul_i32 s42, s42, 36864
  s_mul_i32 s79, s28, 331776
  s_add_u32 s79, s79, s78
  s_add_u32 s79, s79, 147456
  v_mfma_f32_16x16x32_bf16 v[84:87], a[168:171], a[152:155], v[84:87]
  s_waitcnt lgkmcnt(4)
  buffer_load_dwordx4 v4, s[20:23], s45 offen offset:3072 lds
  s_barrier
  v_mfma_f32_16x16x32_bf16 v[88:91], a[176:179], a[128:131], v[88:91]
  ds_read_b64_tr_b16 a[168:169], v20 offset:64
  v_mfma_f32_16x16x32_bf16 v[88:91], a[180:183], a[132:135], v[88:91]
  ds_read_b64_tr_b16 a[170:171], v21 offset:64
  v_mfma_f32_16x16x32_bf16 v[92:95], a[180:183], a[140:143], v[92:95]
  ds_read_b64_tr_b16 a[172:173], v22 offset:64
  v_mfma_f32_16x16x32_bf16 v[92:95], a[176:179], a[136:139], v[92:95]
  ds_read_b64_tr_b16 a[174:175], v23 offset:64
  v_mfma_f32_16x16x32_bf16 v[96:99], a[176:179], a[144:147], v[96:99]
  s_add_u32 m0, s44, 22528
  s_add_u32 s78, s78, s42
  s_mul_i32 s80, s28, 9216
  v_mfma_f32_16x16x32_bf16 v[96:99], a[180:183], a[148:151], v[96:99]
  buffer_load_dwordx4 v5, s[20:23], s45 offen offset:0 lds
  v_mfma_f32_16x16x32_bf16 v[100:103], a[180:183], a[156:159], v[100:103]
  s_add_u32 s92, s80, 32768
  s_add_u32 s93, s80, 130048
  s_add_u32 s94, s80, 0
  s_cmp_eq_u32 s28, 3
  s_cselect_b32 s92, 120832, s92
  v_mfma_f32_16x16x32_bf16 v[100:103], a[176:179], a[152:155], v[100:103]
  s_waitcnt lgkmcnt(4)
  buffer_load_dwordx4 v6, s[20:23], s45 offen offset:1024 lds
  v_mfma_f32_16x16x32_bf16 v[104:107], a[160:163], a[128:131], v[104:107]
  ds_read_b64_tr_b16 a[176:177], v20 offset:9280
  v_mfma_f32_16x16x32_bf16 v[104:107], a[164:167], a[132:135], v[104:107]
  ds_read_b64_tr_b16 a[178:179], v21 offset:9280
  v_mfma_f32_16x16x32_bf16 v[108:111], a[164:167], a[140:143], v[108:111]
  ds_read_b64_tr_b16 a[180:181], v22 offset:9280
  v_mfma_f32_16x16x32_bf16 v[108:111], a[160:163], a[136:139], v[108:111]
  ds_read_b64_tr_b16 a[182:183], v23 offset:9280
  v_mfma_f32_16x16x32_bf16 v[112:115], a[160:163], a[144:147], v[112:115]
  s_cmp_eq_u32 s28, 3
  s_cselect_b32 s93, 65536, s93
  s_cmp_eq_u32 s28, 3
  s_cselect_b32 s94, 74752, s94
  v_mfma_f32_16x16x32_bf16 v[112:115], a[164:167], a[148:151], v[112:115]
  buffer_load_dwordx4 v7, s[20:23], s45 offen offset:2048 lds
  v_mfma_f32_16x16x32_bf16 v[116:119], a[164:167], a[156:159], v[116:119]
  s_lshl_b32 s46, s32, 7
  s_lshl_b32 s47, s33, 4
  s_add_u32 s46, s46, s47
  s_lshl_b32 s47, s28, 2
  v_mfma_f32_16x16x32_bf16 v[116:119], a[160:163], a[152:155], v[116:119]
  s_waitcnt lgkmcnt(4)
  buffer_load_dwordx4 v8, s[20:23], s45 offen offset:3072 lds
  v_mfma_f32_16x16x32_bf16 v[120:123], a[168:171], a[128:131], v[120:123]
  ds_read_b64_tr_b16 a[160:161], v20 offset:96
  v_mfma_f32_16x16x32_bf16 v[120:123], a[172:175], a[132:135], v[120:123]
  ds_read_b64_tr_b16 a[162:163], v21 offset:96
  v_mfma_f32_16x16x32_bf16 v[124:127], a[172:175], a[140:143], v[124:127]
  ds_read_b64_tr_b16 a[164:165], v22 offset:96
  v_mfma_f32_16x16x32_bf16 v[124:127], a[168:171], a[136:139], v[124:127]
  ds_read_b64_tr_b16 a[166:167], v23 offset:96
  v_mfma_f32_16x16x32_bf16 v[128:131], a[168:171], a[144:147], v[128:131]
  s_add_u32 m0, s44, 26624
  s_add_u32 s47, s46, s47
  s_mul_i32 s47, s47, 36864
  v_mfma_f32_16x16x32_bf16 v[128:131], a[172:175], a[148:151], v[128:131]
  buffer_load_dwordx4 v9, s[20:23], s45 offen offset:0 lds
  v_mfma_f32_16x16x32_bf16 v[132:135], a[172:175], a[156:159], v[132:135]
  s_lshl_b32 s48, s31, 10
  s_add_u32 s48, s48, s47
  s_lshr_b32 s49, s31, 1
  s_add_u32 s49, s49, 32
  v_mfma_f32_16x16x32_bf16 v[132:135], a[168:171], a[152:155], v[132:135]
  s_waitcnt lgkmcnt(4)
  v_mfma_f32_16x16x32_bf16 v[136:139], a[176:179], a[128:131], v[136:139]
  ds_read_b64_tr_b16 a[168:169], v20 offset:9312
  v_accvgpr_read_b32 v1, a184
  v_accvgpr_read_b32 v2, a185
  v_mfma_f32_16x16x32_bf16 v[136:139], a[180:183], a[132:135], v[136:139]
  ds_read_b64_tr_b16 a[170:171], v21 offset:9312
  v_mfma_f32_16x16x32_bf16 v[140:143], a[180:183], a[140:143], v[140:143]
  ds_read_b64_tr_b16 a[172:173], v22 offset:9312
  v_accvgpr_read_b32 v3, a186
  v_accvgpr_read_b32 v4, a187
  v_mfma_f32_16x16x32_bf16 v[140:143], a[176:179], a[136:139], v[140:143]
  ds_read_b64_tr_b16 a[174:175], v23 offset:9312
  v_mfma_f32_16x16x32_bf16 v[144:147], a[176:179], a[144:147], v[144:147]
  s_lshl_b32 s49, s49, 10
  s_add_u32 s49, s49, s47
  v_mfma_f32_16x16x32_bf16 v[144:147], a[180:183], a[148:151], v[144:147]
  v_mfma_f32_16x16x32_bf16 v[148:151], a[180:183], a[156:159], v[148:151]
  s_lshl_b32 s50, s35, 9
  s_add_u32 s49, s49, s50
  v_lshlrev_b32 v27, 3, v0
  s_lshl_b32 s50, s40, 3
  v_mfma_f32_16x16x32_bf16 v[148:151], a[176:179], a[152:155], v[148:151]
  s_waitcnt lgkmcnt(4)
  v_mfma_f32_16x16x32_bf16 v[152:155], a[160:163], a[128:131], v[152:155]
  ds_read_b64_tr_b16 a[176:177], v20 offset:128
  v_accvgpr_read_b32 v5, a188
  v_accvgpr_read_b32 v6, a189
  v_mfma_f32_16x16x32_bf16 v[152:155], a[164:167], a[132:135], v[152:155]
  ds_read_b64_tr_b16 a[178:179], v21 offset:128
  v_mfma_f32_16x16x32_bf16 v[156:159], a[164:167], a[140:143], v[156:159]
  ds_read_b64_tr_b16 a[180:181], v22 offset:128
  v_accvgpr_read_b32 v7, a190
  v_accvgpr_read_b32 v8, a191
  v_mfma_f32_16x16x32_bf16 v[156:159], a[160:163], a[136:139], v[156:159]
  ds_read_b64_tr_b16 a[182:183], v23 offset:128
  v_mfma_f32_16x16x32_bf16 v[160:163], a[160:163], a[144:147], v[160:163]
  s_add_u32 s46, s46, s50
  s_lshl_b32 s50, s28, 1
  v_mfma_f32_16x16x32_bf16 v[160:163], a[164:167], a[148:151], v[160:163]
  v_mfma_f32_16x16x32_bf16 v[164:167], a[164:167], a[156:159], v[164:167]
  s_add_u32 s46, s46, s50
  s_mul_i32 s46, s46, 36864
  s_add_u32 s76, s46, 36864
  s_mov_b32 s72, 0
  v_mfma_f32_16x16x32_bf16 v[164:167], a[160:163], a[152:155], v[164:167]
  s_waitcnt lgkmcnt(4)
  v_mfma_f32_16x16x32_bf16 v[168:171], a[168:171], a[128:131], v[168:171]
  ds_read_b64_tr_b16 a[160:161], v20 offset:9344
  v_accvgpr_read_b32 v9, a192
  v_mfma_f32_16x16x32_bf16 v[168:171], a[172:175], a[132:135], v[168:171]
  ds_read_b64_tr_b16 a[162:163], v21 offset:9344
  v_mfma_f32_16x16x32_bf16 v[172:175], a[172:175], a[140:143], v[172:175]
  ds_read_b64_tr_b16 a[164:165], v22 offset:9344
  v_mfma_f32_16x16x32_bf16 v[172:175], a[168:171], a[136:139], v[172:175]
  ds_read_b64_tr_b16 a[166:167], v23 offset:9344
  v_mfma_f32_16x16x32_bf16 v[176:179], a[168:171], a[144:147], v[176:179]
  s_mov_b32 s73, 0
  v_mfma_f32_16x16x32_bf16 v[176:179], a[172:175], a[148:151], v[176:179]
  v_mfma_f32_16x16x32_bf16 v[180:183], a[172:175], a[156:159], v[180:183]
  v_mfma_f32_16x16x32_bf16 v[180:183], a[168:171], a[152:155], v[180:183]
  s_waitcnt lgkmcnt(4)
  v_mfma_f32_16x16x32_bf16 v[184:187], a[176:179], a[128:131], v[184:187]
  ds_read_b64_tr_b16 a[168:169], v20 offset:160
  v_mfma_f32_16x16x32_bf16 v[184:187], a[180:183], a[132:135], v[184:187]
  ds_read_b64_tr_b16 a[170:171], v21 offset:160
  v_mfma_f32_16x16x32_bf16 v[188:191], a[180:183], a[140:143], v[188:191]
  ds_read_b64_tr_b16 a[172:173], v22 offset:160
  v_mfma_f32_16x16x32_bf16 v[188:191], a[176:179], a[136:139], v[188:191]
  ds_read_b64_tr_b16 a[174:175], v23 offset:160
  v_mfma_f32_16x16x32_bf16 v[192:195], a[176:179], a[144:147], v[192:195]
  s_add_u32 s45, s78, 0
  s_add_u32 m0, s92, 0
  v_mfma_f32_16x16x32_bf16 v[192:195], a[180:183], a[148:151], v[192:195]
  buffer_load_dwordx4 v1, s[68:71], s45 offen offset:0 lds
  v_mfma_f32_16x16x32_bf16 v[196:199], a[180:183], a[156:159], v[196:199]
  v_mfma_f32_16x16x32_bf16 v[196:199], a[176:179], a[152:155], v[196:199]
  s_waitcnt lgkmcnt(4)
  buffer_load_dwordx4 v2, s[68:71], s45 offen offset:1024 lds
  v_mfma_f32_16x16x32_bf16 v[200:203], a[160:163], a[128:131], v[200:203]
  ds_read_b64_tr_b16 a[176:177], v20 offset:9376
  v_mfma_f32_16x16x32_bf16 v[200:203], a[164:167], a[132:135], v[200:203]
  ds_read_b64_tr_b16 a[178:179], v21 offset:9376
  v_mfma_f32_16x16x32_bf16 v[204:207], a[164:167], a[140:143], v[204:207]
  ds_read_b64_tr_b16 a[180:181], v22 offset:9376
  v_mfma_f32_16x16x32_bf16 v[204:207], a[160:163], a[136:139], v[204:207]
  ds_read_b64_tr_b16 a[182:183], v23 offset:9376
  v_mfma_f32_16x16x32_bf16 v[208:211], a[160:163], a[144:147], v[208:211]
  v_mfma_f32_16x16x32_bf16 v[208:211], a[164:167], a[148:151], v[208:211]
  buffer_load_dwordx4 v3, s[68:71], s45 offen offset:2048 lds
  v_mfma_f32_16x16x32_bf16 v[212:215], a[164:167], a[156:159], v[212:215]
  v_mfma_f32_16x16x32_bf16 v[212:215], a[160:163], a[152:155], v[212:215]
  s_waitcnt lgkmcnt(4)
  buffer_load_dwordx4 v4, s[68:71], s45 offen offset:3072 lds
  v_mfma_f32_16x16x32_bf16 v[216:219], a[168:171], a[128:131], v[216:219]
  ds_read_b64_tr_b16 a[160:161], v20 offset:192
  v_mfma_f32_16x16x32_bf16 v[216:219], a[172:175], a[132:135], v[216:219]
  ds_read_b64_tr_b16 a[162:163], v21 offset:192
  v_mfma_f32_16x16x32_bf16 v[220:223], a[172:175], a[140:143], v[220:223]
  ds_read_b64_tr_b16 a[164:165], v22 offset:192
  v_mfma_f32_16x16x32_bf16 v[220:223], a[168:171], a[136:139], v[220:223]
  ds_read_b64_tr_b16 a[166:167], v23 offset:192
  v_mfma_f32_16x16x32_bf16 v[224:227], a[168:171], a[144:147], v[224:227]
  s_add_u32 m0, s92, 4096
  v_mfma_f32_16x16x32_bf16 v[224:227], a[172:175], a[148:151], v[224:227]
  buffer_load_dwordx4 v5, s[68:71], s45 offen offset:0 lds
  v_mfma_f32_16x16x32_bf16 v[228:231], a[172:175], a[156:159], v[228:231]
  v_mfma_f32_16x16x32_bf16 v[228:231], a[168:171], a[152:155], v[228:231]
  s_waitcnt lgkmcnt(4)
  buffer_load_dwordx4 v6, s[68:71], s45 offen offset:1024 lds
  v_mfma_f32_16x16x32_bf16 v[232:235], a[176:179], a[128:131], v[232:235]
  ds_read_b64_tr_b16 a[168:169], v20 offset:9408
  v_mfma_f32_16x16x32_bf16 v[232:235], a[180:183], a[132:135], v[232:235]
  ds_read_b64_tr_b16 a[170:171], v21 offset:9408
  v_mfma_f32_16x16x32_bf16 v[236:239], a[180:183], a[140:143], v[236:239]
  ds_read_b64_tr_b16 a[172:173], v22 offset:9408
  v_mfma_f32_16x16x32_bf16 v[236:239], a[176:179], a[136:139], v[236:239]
  ds_read_b64_tr_b16 a[174:175], v23 offset:9408
  v_mfma_f32_16x16x32_bf16 v[240:243], a[176:179], a[144:147], v[240:243]
  v_mfma_f32_16x16x32_bf16 v[240:243], a[180:183], a[148:151], v[240:243]
  buffer_load_dwordx4 v7, s[68:71], s45 offen offset:2048 lds
  v_mfma_f32_16x16x32_bf16 v[244:247], a[180:183], a[156:159], v[244:247]
  v_mfma_f32_16x16x32_bf16 v[244:247], a[176:179], a[152:155], v[244:247]
  s_waitcnt lgkmcnt(4)
  buffer_load_dwordx4 v8, s[68:71], s45 offen offset:3072 lds
  v_mfma_f32_16x16x32_bf16 a[0:3], a[160:163], a[128:131], a[0:3]
  ds_read_b64_tr_b16 a[176:177], v20 offset:224
  v_mfma_f32_16x16x32_bf16 a[0:3], a[164:167], a[132:135], a[0:3]
  ds_read_b64_tr_b16 a[178:179], v21 offset:224
  v_mfma_f32_16x16x32_bf16 a[4:7], a[164:167], a[140:143], a[4:7]
  ds_read_b64_tr_b16 a[180:181], v22 offset:224
  v_mfma_f32_16x16x32_bf16 a[4:7], a[160:163], a[136:139], a[4:7]
  ds_read_b64_tr_b16 a[182:183], v23 offset:224
  v_mfma_f32_16x16x32_bf16 a[8:11], a[160:163], a[144:147], a[8:11]
  s_add_u32 m0, s92, 8192
  v_mfma_f32_16x16x32_bf16 a[8:11], a[164:167], a[148:151], a[8:11]
  buffer_load_dwordx4 v9, s[68:71], s45 offen offset:0 lds
  v_mfma_f32_16x16x32_bf16 a[12:15], a[164:167], a[156:159], a[12:15]
  v_mfma_f32_16x16x32_bf16 a[12:15], a[160:163], a[152:155], a[12:15]
  s_waitcnt lgkmcnt(4)
  v_mfma_f32_16x16x32_bf16 a[16:19], a[168:171], a[128:131], a[16:19]
  ds_read_b64_tr_b16 a[160:161], v20 offset:9440
  v_mfma_f32_16x16x32_bf16 a[16:19], a[172:175], a[132:135], a[16:19]
  ds_read_b64_tr_b16 a[162:163], v21 offset:9440
  v_mfma_f32_16x16x32_bf16 a[20:23], a[172:175], a[140:143], a[20:23]
  ds_read_b64_tr_b16 a[164:165], v22 offset:9440
  v_mfma_f32_16x16x32_bf16 a[20:23], a[168:171], a[136:139], a[20:23]
  ds_read_b64_tr_b16 a[166:167], v23 offset:9440
  v_mfma_f32_16x16x32_bf16 a[24:27], a[168:171], a[144:147], a[24:27]
  v_mfma_f32_16x16x32_bf16 a[24:27], a[172:175], a[148:151], a[24:27]
  v_mfma_f32_16x16x32_bf16 a[28:31], a[172:175], a[156:159], a[28:31]
  v_mfma_f32_16x16x32_bf16 a[28:31], a[168:171], a[152:155], a[28:31]
  s_waitcnt lgkmcnt(4)
  v_mfma_f32_16x16x32_bf16 a[32:35], a[176:179], a[128:131], a[32:35]
  ds_read_b64_tr_b16 a[168:169], v20 offset:256
  v_mfma_f32_16x16x32_bf16 a[32:35], a[180:183], a[132:135], a[32:35]
  ds_read_b64_tr_b16 a[170:171], v21 offset:256
  v_mfma_f32_16x16x32_bf16 a[36:39], a[180:183], a[140:143], a[36:39]
  ds_read_b64_tr_b16 a[172:173], v22 offset:256
  v_mfma_f32_16x16x32_bf16 a[36:39], a[176:179], a[136:139], a[36:39]
  ds_read_b64_tr_b16 a[174:175], v23 offset:256
  v_mfma_f32_16x16x32_bf16 a[40:43], a[176:179], a[144:147], a[40:43]
  v_mfma_f32_16x16x32_bf16 a[40:43], a[180:183], a[148:151], a[40:43]
  v_mfma_f32_16x16x32_bf16 a[44:47], a[180:183], a[156:159], a[44:47]
  v_mfma_f32_16x16x32_bf16 a[44:47], a[176:179], a[152:155], a[44:47]
  s_waitcnt lgkmcnt(4)
  v_mfma_f32_16x16x32_bf16 a[48:51], a[160:163], a[128:131], a[48:51]
  ds_read_b64_tr_b16 a[176:177], v20 offset:9472
  v_mfma_f32_16x16x32_bf16 a[48:51], a[164:167], a[132:135], a[48:51]
  ds_read_b64_tr_b16 a[178:179], v21 offset:9472
  v_mfma_f32_16x16x32_bf16 a[52:55], a[164:167], a[140:143], a[52:55]
  ds_read_b64_tr_b16 a[180:181], v22 offset:9472
  v_mfma_f32_16x16x32_bf16 a[52:55], a[160:163], a[136:139], a[52:55]
  ds_read_b64_tr_b16 a[182:183], v23 offset:9472
  v_mfma_f32_16x16x32_bf16 a[56:59], a[160:163], a[144:147], a[56:59]
  v_mfma_f32_16x16x32_bf16 a[56:59], a[164:167], a[148:151], a[56:59]
  v_mfma_f32_16x16x32_bf16 a[60:63], a[164:167], a[156:159], a[60:63]
  v_mfma_f32_16x16x32_bf16 a[60:63], a[160:163], a[152:155], a[60:63]
  s_waitcnt vmcnt(9) lgkmcnt(0)
  s_barrier
  v_add_u32 v20, 83968, v18
  v_add_u32 v21, 83968, v19
  v_add_u32 v22, 102400, v18
  v_add_u32 v23, 102400, v19
  v_mfma_f32_16x16x32_bf16 a[64:67], a[168:171], a[128:131], a[64:67]
  ds_read_b64_tr_b16 a[160:161], v20 offset:0
  v_mfma_f32_16x16x32_bf16 a[64:67], a[172:175], a[132:135], a[64:67]
  ds_read_b64_tr_b16 a[162:163], v21 offset:0
  v_mfma_f32_16x16x32_bf16 a[68:71], a[172:175], a[140:143], a[68:71]
  ds_read_b64_tr_b16 a[164:165], v22 offset:0
  v_mfma_f32_16x16x32_bf16 a[68:71], a[168:171], a[136:139], a[68:71]
  ds_read_b64_tr_b16 a[166:167], v23 offset:0
  v_mfma_f32_16x16x32_bf16 a[72:75], a[168:171], a[144:147], a[72:75]
  ds_read_b128 a[96:99], v24 offset:0
  v_mfma_f32_16x16x32_bf16 a[72:75], a[172:175], a[148:151], a[72:75]
  ds_read_b128 a[100:103], v25 offset:0
  v_mfma_f32_16x16x32_bf16 a[76:79], a[172:175], a[156:159], a[76:79]
  ds_read_b128 a[104:107], v24 offset:2048
  v_mfma_f32_16x16x32_bf16 a[76:79], a[168:171], a[152:155], a[76:79]
  ds_read_b128 a[108:111], v25 offset:2048
  v_mfma_f32_16x16x32_bf16 a[80:83], a[176:179], a[128:131], a[80:83]
  ds_read_b128 a[112:115], v24 offset:4096
  v_mfma_f32_16x16x32_bf16 a[80:83], a[180:183], a[132:135], a[80:83]
  ds_read_b128 a[116:119], v25 offset:4096
  v_mfma_f32_16x16x32_bf16 a[84:87], a[180:183], a[140:143], a[84:87]
  ds_read_b128 a[120:123], v24 offset:6144
  v_mfma_f32_16x16x32_bf16 a[84:87], a[176:179], a[136:139], a[84:87]
  ds_read_b128 a[124:127], v25 offset:6144
  v_mfma_f32_16x16x32_bf16 a[88:91], a[176:179], a[144:147], a[88:91]
  ds_read_b64_tr_b16 a[168:169], v20 offset:9216
  v_mfma_f32_16x16x32_bf16 a[88:91], a[180:183], a[148:151], a[88:91]
  ds_read_b64_tr_b16 a[170:171], v21 offset:9216
  v_mfma_f32_16x16x32_bf16 a[92:95], a[180:183], a[156:159], a[92:95]
  ds_read_b64_tr_b16 a[172:173], v22 offset:9216
  v_mfma_f32_16x16x32_bf16 a[92:95], a[176:179], a[152:155], a[92:95]
  ds_read_b64_tr_b16 a[174:175], v23 offset:9216
L_slab8:
  s_waitcnt lgkmcnt(4)
  v_mfma_f32_16x16x32_bf16 v[56:59], a[160:163], a[96:99], v[56:59]
  ds_read_b64_tr_b16 a[176:177], v20 offset:32
  v_mfma_f32_16x16x32_bf16 v[56:59], a[164:167], a[100:103], v[56:59]
  ds_read_b64_tr_b16 a[178:179], v21 offset:32
  v_mfma_f32_16x16x32_bf16 v[60:63], a[164:167], a[108:111], v[60:63]
  ds_read_b64_tr_b16 a[180:181], v22 offset:32
  v_accvgpr_read_b32 v18, a193
  v_mfma_f32_16x16x32_bf16 v[60:63], a[160:163], a[104:107], v[60:63]
  ds_read_b64_tr_b16 a[182:183], v23 offset:32
  v_mfma_f32_16x16x32_bf16 v[64:67], a[160:163], a[112:115], v[64:67]
  v_accvgpr_read_b32 v249, a194
  s_add_u32 s45, s78, 663552
  s_add_u32 m0, s93, 0
  v_mfma_f32_16x16x32_bf16 v[64:67], a[164:167], a[116:119], v[64:67]
  buffer_load_dwordx4 v1, s[68:71], s45 offen offset:0 lds
  v_mfma_f32_16x16x32_bf16 v[68:71], a[164:167], a[124:127], v[68:71]
  v_mfma_f32_16x16x32_bf16 v[68:71], a[160:163], a[120:123], v[68:71]
  s_waitcnt lgkmcnt(4)
  buffer_load_dwordx4 v2, s[68:71], s45 offen offset:1024 lds
  v_mfma_f32_16x16x32_bf16 v[72:75], a[168:171], a[96:99], v[72:75]
  ds_read_b64_tr_b16 a[160:161], v20 offset:9248
  v_mfma_f32_16x16x32_bf16 v[72:75], a[172:175], a[100:103], v[72:75]
  ds_read_b64_tr_b16 a[162:163], v21 offset:9248
  v_mfma_f32_16x16x32_bf16 v[76:79], a[172:175], a[108:111], v[76:79]
  ds_read_b64_tr_b16 a[164:165], v22 offset:9248
  v_mfma_f32_16x16x32_bf16 v[76:79], a[168:171], a[104:107], v[76:79]
  ds_read_b64_tr_b16 a[166:167], v23 offset:9248
  v_mfma_f32_16x16x32_bf16 v[80:83], a[168:171], a[112:115], v[80:83]
  v_mfma_f32_16x16x32_bf16 v[80:83], a[172:175], a[116:119], v[80:83]
  buffer_load_dwordx4 v3, s[68:71], s45 offen offset:2048 lds
  v_mfma_f32_16x16x32_bf16 v[84:87], a[172:175], a[124:127], v[84:87]
  v_mfma_f32_16x16x32_bf16 v[84:87], a[168:171], a[120:123], v[84:87]
  s_waitcnt lgkmcnt(4)
  s_barrier
  buffer_load_dwordx4 v4, s[68:71], s45 offen offset:3072 lds
  v_mfma_f32_16x16x32_bf16 v[88:91], a[176:179], a[96:99], v[88:91]
  ds_read_b64_tr_b16 a[168:169], v20 offset:64
  v_mfma_f32_16x16x32_bf16 v[88:91], a[180:183], a[100:103], v[88:91]
  ds_read_b64_tr_b16 a[170:171], v21 offset:64
  v_mfma_f32_16x16x32_bf16 v[92:95], a[180:183], a[108:111], v[92:95]
  ds_read_b64_tr_b16 a[172:173], v22 offset:64
  v_mfma_f32_16x16x32_bf16 v[92:95], a[176:179], a[104:107], v[92:95]
  ds_read_b64_tr_b16 a[174:175], v23 offset:64
  v_mfma_f32_16x16x32_bf16 v[96:99], a[176:179], a[112:115], v[96:99]
  s_add_u32 m0, s93, 4096
  v_mfma_f32_16x16x32_bf16 v[96:99], a[180:183], a[116:119], v[96:99]
  buffer_load_dwordx4 v5, s[68:71], s45 offen offset:0 lds
  v_mfma_f32_16x16x32_bf16 v[100:103], a[180:183], a[124:127], v[100:103]
  v_mfma_f32_16x16x32_bf16 v[100:103], a[176:179], a[120:123], v[100:103]
  s_waitcnt lgkmcnt(4)
  buffer_load_dwordx4 v6, s[68:71], s45 offen offset:1024 lds
  v_mfma_f32_16x16x32_bf16 v[104:107], a[160:163], a[96:99], v[104:107]
  ds_read_b64_tr_b16 a[176:177], v20 offset:9280
  v_mfma_f32_16x16x32_bf16 v[104:107], a[164:167], a[100:103], v[104:107]
  ds_read_b64_tr_b16 a[178:179], v21 offset:9280
  v_mfma_f32_16x16x32_bf16 v[108:111], a[164:167], a[108:111], v[108:111]
  ds_read_b64_tr_b16 a[180:181], v22 offset:9280
  v_mfma_f32_16x16x32_bf16 v[108:111], a[160:163], a[104:107], v[108:111]
  ds_read_b64_tr_b16 a[182:183], v23 offset:9280
  v_mfma_f32_16x16x32_bf16 v[112:115], a[160:163], a[112:115], v[112:115]
  v_mfma_f32_16x16x32_bf16 v[112:115], a[164:167], a[116:119], v[112:115]
  buffer_load_dwordx4 v7, s[68:71], s45 offen offset:2048 lds
  v_mfma_f32_16x16x32_bf16 v[116:119], a[164:167], a[124:127], v[116:119]
  v_mfma_f32_16x16x32_bf16 v[116:119], a[160:163], a[120:123], v[116:119]
  s_waitcnt lgkmcnt(4)
  buffer_load_dwordx4 v8, s[68:71], s45 offen offset:3072 lds
  v_mfma_f32_16x16x32_bf16 v[120:123], a[168:171], a[96:99], v[120:123]
  ds_read_b64_tr_b16 a[160:161], v20 offset:96
  v_mfma_f32_16x16x32_bf16 v[120:123], a[172:175], a[100:103], v[120:123]
  ds_read_b64_tr_b16 a[162:163], v21 offset:96
  v_mfma_f32_16x16x32_bf16 v[124:127], a[172:175], a[108:111], v[124:127]
  ds_read_b64_tr_b16 a[164:165], v22 offset:96
  v_mfma_f32_16x16x32_bf16 v[124:127], a[168:171], a[104:107], v[124:127]
  ds_read_b64_tr_b16 a[166:167], v23 offset:96
  v_mfma_f32_16x16x32_bf16 v[128:131], a[168:171], a[112:115], v[128:131]
  s_add_u32 m0, s93, 8192
  v_mfma_f32_16x16x32_bf16 v[128:131], a[172:175], a[116:119], v[128:131]
  buffer_load_dwordx4 v9, s[68:71], s45 offen offset:0 lds
  v_mfma_f32_16x16x32_bf16 v[132:135], a[172:175], a[124:127], v[132:135]
  s_add_u32 s45, s78, 36864
  s_add_u32 m0, s94, 0
  v_mfma_f32_16x16x32_bf16 v[132:135], a[168:171], a[120:123], v[132:135]
  s_waitcnt lgkmcnt(4)
  buffer_load_dwordx4 v1, s[68:71], s45 offen offset:0 lds
  v_mfma_f32_16x16x32_bf16 v[136:139], a[176:179], a[96:99], v[136:139]
  ds_read_b64_tr_b16 a[168:169], v20 offset:9312
  v_mfma_f32_16x16x32_bf16 v[136:139], a[180:183], a[100:103], v[136:139]
  ds_read_b64_tr_b16 a[170:171], v21 offset:9312
  v_mul_f32 v34, v56, v56
  v_mfma_f32_16x16x32_bf16 v[140:143], a[180:183], a[108:111], v[140:143]
  ds_read_b64_tr_b16 a[172:173], v22 offset:9312
  v_mul_f32 v35, v57, v57
  v_mfma_f32_16x16x32_bf16 v[140:143], a[176:179], a[104:107], v[140:143]
  ds_read_b64_tr_b16 a[174:175], v23 offset:9312
  v_mul_f32 v36, v58, v58
  v_mfma_f32_16x16x32_bf16 v[144:147], a[176:179], a[112:115], v[144:147]
  v_mul_f32 v37, v59, v59
  v_mul_f32 v38, v88, v88
  v_mfma_f32_16x16x32_bf16 v[144:147], a[180:183], a[116:119], v[144:147]
  buffer_load_dwordx4 v2, s[68:71], s45 offen offset:1024 lds
  v_mfma_f32_16x16x32_bf16 v[148:151], a[180:183], a[124:127], v[148:151]
  v_mul_f32 v39, v89, v89
  v_mul_f32 v40, v90, v90
  v_mfma_f32_16x16x32_bf16 v[148:151], a[176:179], a[120:123], v[148:151]
  s_waitcnt lgkmcnt(4)
  buffer_load_dwordx4 v3, s[68:71], s45 offen offset:2048 lds
  v_mfma_f32_16x16x32_bf16 v[152:155], a[160:163], a[96:99], v[152:155]
  ds_read_b64_tr_b16 a[176:177], v20 offset:128
  v_mul_f32 v41, v91, v91
  v_mfma_f32_16x16x32_bf16 v[152:155], a[164:167], a[100:103], v[152:155]
  ds_read_b64_tr_b16 a[178:179], v21 offset:128
  v_fmaak_f32 v34, v34, v30, 0xc0135761
  v_mfma_f32_16x16x32_bf16 v[156:159], a[164:167], a[108:111], v[156:159]
  ds_read_b64_tr_b16 a[180:181], v22 offset:128
  v_fmaak_f32 v35, v35, v30, 0xc0135761
  v_mfma_f32_16x16x32_bf16 v[156:159], a[160:163], a[104:107], v[156:159]
  ds_read_b64_tr_b16 a[182:183], v23 offset:128
  v_fmaak_f32 v36, v36, v30, 0xc0135761
  v_mfma_f32_16x16x32_bf16 v[160:163], a[160:163], a[112:115], v[160:163]
  v_fmaak_f32 v37, v37, v30, 0xc0135761
  v_fmaak_f32 v38, v38, v30, 0xc0135761
  v_mfma_f32_16x16x32_bf16 v[160:163], a[164:167], a[116:119], v[160:163]
  buffer_load_dwordx4 v4, s[68:71], s45 offen offset:3072 lds
  v_mfma_f32_16x16x32_bf16 v[164:167], a[164:167], a[124:127], v[164:167]
  s_add_u32 m0, s94, 4096
  v_fmaak_f32 v39, v39, v30, 0xc0135761
  v_mfma_f32_16x16x32_bf16 v[164:167], a[160:163], a[120:123], v[164:167]
  s_waitcnt lgkmcnt(4)
  buffer_load_dwordx4 v5, s[68:71], s45 offen offset:0 lds
  v_mfma_f32_16x16x32_bf16 v[168:171], a[168:171], a[96:99], v[168:171]
  ds_read_b64_tr_b16 a[160:161], v20 offset:9344
  v_fmaak_f32 v40, v40, v30, 0xc0135761
  v_mfma_f32_16x16x32_bf16 v[168:171], a[172:175], a[100:103], v[168:171]
  ds_read_b64_tr_b16 a[162:163], v21 offset:9344
  v_fmaak_f32 v41, v41, v30, 0xc0135761
  v_mfma_f32_16x16x32_bf16 v[172:175], a[172:175], a[108:111], v[172:175]
  ds_read_b64_tr_b16 a[164:165], v22 offset:9344
  v_mul_f32 v34, v56, v34
  v_mfma_f32_16x16x32_bf16 v[172:175], a[168:171], a[104:107], v[172:175]
  ds_read_b64_tr_b16 a[166:167], v23 offset:9344
  v_mul_f32 v35, v57, v35
  v_mfma_f32_16x16x32_bf16 v[176:179], a[168:171], a[112:115], v[176:179]
  v_mul_f32 v36, v58, v36
  v_mul_f32 v37, v59, v37
  v_mfma_f32_16x16x32_bf16 v[176:179], a[172:175], a[116:119], v[176:179]
  buffer_load_dwordx4 v6, s[68:71], s45 offen offset:1024 lds
  v_mfma_f32_16x16x32_bf16 v[180:183], a[172:175], a[124:127], v[180:183]
  v_mul_f32 v38, v88, v38
  v_mul_f32 v39, v89, v39
  v_mfma_f32_16x16x32_bf16 v[180:183], a[168:171], a[120:123], v[180:183]
  s_waitcnt lgkmcnt(4)
  buffer_load_dwordx4 v7, s[68:71], s45 offen offset:2048 lds
  v_mfma_f32_16x16x32_bf16 v[184:187], a[176:179], a[96:99], v[184:187]
  ds_read_b64_tr_b16 a[168:169], v20 offset:160
  v_mul_f32 v40, v90, v40
  v_mfma_f32_16x16x32_bf16 v[184:187], a[180:183], a[100:103], v[184:187]
  ds_read_b64_tr_b16 a[170:171], v21 offset:160
  v_mul_f32 v41, v91, v41
  v_mfma_f32_16x16x32_bf16 v[188:191], a[180:183], a[108:111], v[188:191]
  ds_read_b64_tr_b16 a[172:173], v22 offset:160
  v_mul_f32 v72, v56, v72
  v_mfma_f32_16x16x32_bf16 v[188:191], a[176:179], a[104:107], v[188:191]
  ds_read_b64_tr_b16 a[174:175], v23 offset:160
  v_mul_f32 v73, v57, v73
  v_mfma_f32_16x16x32_bf16 v[192:195], a[176:179], a[112:115], v[192:195]
  v_mul_f32 v74, v58, v74
  v_mul_f32 v75, v59, v75
  v_mfma_f32_16x16x32_bf16 v[192:195], a[180:183], a[116:119], v[192:195]
  buffer_load_dwordx4 v8, s[68:71], s45 offen offset:3072 lds
  v_mfma_f32_16x16x32_bf16 v[196:199], a[180:183], a[124:127], v[196:199]
  s_add_u32 m0, s94, 8192
  v_mul_f32 v104, v88, v104
  v_mfma_f32_16x16x32_bf16 v[196:199], a[176:179], a[120:123], v[196:199]
  s_waitcnt lgkmcnt(4)
  buffer_load_dwordx4 v9, s[68:71], s45 offen offset:0 lds
  v_mfma_f32_16x16x32_bf16 v[200:203], a[160:163], a[96:99], v[200:203]
  ds_read_b64_tr_b16 a[176:177], v20 offset:9376
  v_mul_f32 v105, v89, v105
  v_mfma_f32_16x16x32_bf16 v[200:203], a[164:167], a[100:103], v[200:203]
  ds_read_b64_tr_b16 a[178:179], v21 offset:9376
  v_mul_f32 v106, v90, v106
  v_mfma_f32_16x16x32_bf16 v[204:207], a[164:167], a[108:111], v[204:207]
  ds_read_b64_tr_b16 a[180:181], v22 offset:9376
  v_mul_f32 v107, v91, v107
  v_mfma_f32_16x16x32_bf16 v[204:207], a[160:163], a[104:107], v[204:207]
  ds_read_b64_tr_b16 a[182:183], v23 offset:9376
  v_exp_f32 v34, v34
  v_mfma_f32_16x16x32_bf16 v[208:211], a[160:163], a[112:115], v[208:211]
  v_exp_f32 v35, v35
  v_mfma_f32_16x16x32_bf16 v[208:211], a[164:167], a[116:119], v[208:211]
  v_exp_f32 v36, v36
  v_mfma_f32_16x16x32_bf16 v[212:215], a[164:167], a[124:127], v[212:215]
  v_exp_f32 v37, v37
  v_mfma_f32_16x16x32_bf16 v[212:215], a[160:163], a[120:123], v[212:215]
  s_waitcnt lgkmcnt(4)
  v_exp_f32 v38, v38
  v_mfma_f32_16x16x32_bf16 v[216:219], a[168:171], a[96:99], v[216:219]
  ds_read_b64_tr_b16 a[160:161], v20 offset:192
  v_exp_f32 v39, v39
  v_mfma_f32_16x16x32_bf16 v[216:219], a[172:175], a[100:103], v[216:219]
  ds_read_b64_tr_b16 a[162:163], v21 offset:192
  v_exp_f32 v40, v40
  v_mfma_f32_16x16x32_bf16 v[220:223], a[172:175], a[108:111], v[220:223]
  ds_read_b64_tr_b16 a[164:165], v22 offset:192
  v_exp_f32 v41, v41
  v_mfma_f32_16x16x32_bf16 v[220:223], a[168:171], a[104:107], v[220:223]
  ds_read_b64_tr_b16 a[166:167], v23 offset:192
  v_add_f32 v34, 1.0, v34
  v_mfma_f32_16x16x32_bf16 v[224:227], a[168:171], a[112:115], v[224:227]
  v_add_f32 v35, 1.0, v35
  v_add_f32 v36, 1.0, v36
  v_mfma_f32_16x16x32_bf16 v[224:227], a[172:175], a[116:119], v[224:227]
  v_add_f32 v37, 1.0, v37
  v_add_f32 v38, 1.0, v38
  v_mfma_f32_16x16x32_bf16 v[228:231], a[172:175], a[124:127], v[228:231]
  v_add_f32 v39, 1.0, v39
  v_add_f32 v40, 1.0, v40
  v_mfma_f32_16x16x32_bf16 v[228:231], a[168:171], a[120:123], v[228:231]
  s_waitcnt lgkmcnt(4)
  v_add_f32 v41, 1.0, v41
  v_mfma_f32_16x16x32_bf16 v[232:235], a[176:179], a[96:99], v[232:235]
  ds_read_b64_tr_b16 a[168:169], v20 offset:9408
  v_rcp_f32 v34, v34
  v_mfma_f32_16x16x32_bf16 v[232:235], a[180:183], a[100:103], v[232:235]
  ds_read_b64_tr_b16 a[170:171], v21 offset:9408
  v_rcp_f32 v35, v35
  v_mfma_f32_16x16x32_bf16 v[236:239], a[180:183], a[108:111], v[236:239]
  ds_read_b64_tr_b16 a[172:173], v22 offset:9408
  v_rcp_f32 v36, v36
  v_mfma_f32_16x16x32_bf16 v[236:239], a[176:179], a[104:107], v[236:239]
  ds_read_b64_tr_b16 a[174:175], v23 offset:9408
  v_rcp_f32 v37, v37
  v_mfma_f32_16x16x32_bf16 v[240:243], a[176:179], a[112:115], v[240:243]
  v_rcp_f32 v38, v38
  v_mfma_f32_16x16x32_bf16 v[240:243], a[180:183], a[116:119], v[240:243]
  v_rcp_f32 v39, v39
  v_mfma_f32_16x16x32_bf16 v[244:247], a[180:183], a[124:127], v[244:247]
  v_rcp_f32 v40, v40
  v_mfma_f32_16x16x32_bf16 v[244:247], a[176:179], a[120:123], v[244:247]
  s_waitcnt lgkmcnt(4)
  v_rcp_f32 v41, v41
  v_mfma_f32_16x16x32_bf16 a[0:3], a[160:163], a[96:99], a[0:3]
  ds_read_b64_tr_b16 a[176:177], v20 offset:224
  v_mul_f32 v72, v72, v34
  v_mfma_f32_16x16x32_bf16 a[0:3], a[164:167], a[100:103], a[0:3]
  ds_read_b64_tr_b16 a[178:179], v21 offset:224
  v_mul_f32 v73, v73, v35
  v_mfma_f32_16x16x32_bf16 a[4:7], a[164:167], a[108:111], a[4:7]
  ds_read_b64_tr_b16 a[180:181], v22 offset:224
  v_mul_f32 v74, v74, v36
  v_mfma_f32_16x16x32_bf16 a[4:7], a[160:163], a[104:107], a[4:7]
  ds_read_b64_tr_b16 a[182:183], v23 offset:224
  v_mul_f32 v75, v75, v37
  v_mfma_f32_16x16x32_bf16 a[8:11], a[160:163], a[112:115], a[8:11]
  v_mul_f32 v104, v104, v38
  v_mul_f32 v105, v105, v39
  v_mfma_f32_16x16x32_bf16 a[8:11], a[164:167], a[116:119], a[8:11]
  v_mul_f32 v106, v106, v40
  v_mul_f32 v107, v107, v41
  v_mfma_f32_16x16x32_bf16 a[12:15], a[164:167], a[124:127], a[12:15]
  v_cvt_pk_bf16_f32 v42, v72, v73
  v_cvt_pk_bf16_f32 v43, v74, v75
  v_mfma_f32_16x16x32_bf16 a[12:15], a[160:163], a[120:123], a[12:15]
  s_waitcnt lgkmcnt(4)
  v_cvt_pk_bf16_f32 v44, v104, v105
  v_mfma_f32_16x16x32_bf16 a[16:19], a[168:171], a[96:99], a[16:19]
  ds_read_b64_tr_b16 a[160:161], v20 offset:9440
  v_cvt_pk_bf16_f32 v45, v106, v107
  v_mfma_f32_16x16x32_bf16 a[16:19], a[172:175], a[100:103], a[16:19]
  ds_read_b64_tr_b16 a[162:163], v21 offset:9440
  s_add_u32 s51, s48, 0
  v_mfma_f32_16x16x32_bf16 a[20:23], a[172:175], a[108:111], a[20:23]
  ds_read_b64_tr_b16 a[164:165], v22 offset:9440
  buffer_store_dwordx4 v[42:45], v26, s[24:27], s51 offen sc1
  v_mfma_f32_16x16x32_bf16 a[20:23], a[168:171], a[104:107], a[20:23]
  ds_read_b64_tr_b16 a[166:167], v23 offset:9440
  v_mfma_f32_16x16x32_bf16 a[24:27], a[168:171], a[112:115], a[24:27]
  v_mfma_f32_16x16x32_bf16 a[24:27], a[172:175], a[116:119], a[24:27]
  v_mfma_f32_16x16x32_bf16 a[28:31], a[172:175], a[124:127], a[28:31]
  v_mfma_f32_16x16x32_bf16 a[28:31], a[168:171], a[120:123], a[28:31]
  s_waitcnt lgkmcnt(4)
  v_mfma_f32_16x16x32_bf16 a[32:35], a[176:179], a[96:99], a[32:35]
  ds_read_b64_tr_b16 a[168:169], v20 offset:256
  v_mfma_f32_16x16x32_bf16 a[32:35], a[180:183], a[100:103], a[32:35]
  ds_read_b64_tr_b16 a[170:171], v21 offset:256
  v_mfma_f32_16x16x32_bf16 a[36:39], a[180:183], a[108:111], a[36:39]
  ds_read_b64_tr_b16 a[172:173], v22 offset:256
  v_mfma_f32_16x16x32_bf16 a[36:39], a[176:179], a[104:107], a[36:39]
  ds_read_b64_tr_b16 a[174:175], v23 offset:256
  v_mfma_f32_16x16x32_bf16 a[40:43], a[176:179], a[112:115], a[40:43]
  v_mfma_f32_16x16x32_bf16 a[40:43], a[180:183], a[116:119], a[40:43]
  v_mfma_f32_16x16x32_bf16 a[44:47], a[180:183], a[124:127], a[44:47]
  v_mfma_f32_16x16x32_bf16 a[44:47], a[176:179], a[120:123], a[44:47]
  s_waitcnt lgkmcnt(4)
  v_mfma_f32_16x16x32_bf16 a[48:51], a[160:163], a[96:99], a[48:51]
  ds_read_b64_tr_b16 a[176:177], v20 offset:9472
  v_mfma_f32_16x16x32_bf16 a[48:51], a[164:167], a[100:103], a[48:51]
  ds_read_b64_tr_b16 a[178:179], v21 offset:9472
  v_mfma_f32_16x16x32_bf16 a[52:55], a[164:167], a[108:111], a[52:55]
  ds_read_b64_tr_b16 a[180:181], v22 offset:9472
  v_mfma_f32_16x16x32_bf16 a[52:55], a[160:163], a[104:107], a[52:55]
  ds_read_b64_tr_b16 a[182:183], v23 offset:9472
  v_mfma_f32_16x16x32_bf16 a[56:59], a[160:163], a[112:115], a[56:59]
  v_mfma_f32_16x16x32_bf16 a[56:59], a[164:167], a[116:119], a[56:59]
  v_mfma_f32_16x16x32_bf16 a[60:63], a[164:167], a[124:127], a[60:63]
  v_mfma_f32_16x16x32_bf16 a[60:63], a[160:163], a[120:123], a[60:63]
  s_waitcnt lgkmcnt(0)
  s_barrier
  v_mfma_f32_16x16x32_bf16 a[64:67], a[168:171], a[96:99], a[64:67]
  v_mfma_f32_16x16x32_bf16 a[64:67], a[172:175], a[100:103], a[64:67]
  v_mfma_f32_16x16x32_bf16 a[68:71], a[172:175], a[108:111], a[68:71]
  v_mfma_f32_16x16x32_bf16 a[68:71], a[168:171], a[104:107], a[68:71]
  v_mfma_f32_16x16x32_bf16 a[72:75], a[168:171], a[112:115], a[72:75]
  s_lshl_b32 s62, s3, 7
  s_add_u32 s62, s62, L_gelu-standalone__glu_gated_geglu__prompt_kernel
  s_min_u32 s62, s62, L_end-standalone__glu_gated_geglu__prompt_kernel
  s_add_u32 s62, s62, s100
  v_mfma_f32_16x16x32_bf16 a[72:75], a[172:175], a[116:119], a[72:75]
  s_addc_u32 s63, s101, 0
  v_mov_b32 v46, s62
  v_mov_b32 v47, s63
  v_mfma_f32_16x16x32_bf16 a[76:79], a[172:175], a[124:127], a[76:79]
  global_load_dword v252, v[46:47], off
  v_mfma_f32_16x16x32_bf16 a[76:79], a[168:171], a[120:123], a[76:79]
  v_mfma_f32_16x16x32_bf16 a[80:83], a[176:179], a[96:99], a[80:83]
  v_mfma_f32_16x16x32_bf16 a[80:83], a[180:183], a[100:103], a[80:83]
  v_mfma_f32_16x16x32_bf16 a[84:87], a[180:183], a[108:111], a[84:87]
  v_mfma_f32_16x16x32_bf16 a[84:87], a[176:179], a[104:107], a[84:87]
  v_mfma_f32_16x16x32_bf16 a[88:91], a[176:179], a[112:115], a[88:91]
  v_mfma_f32_16x16x32_bf16 a[88:91], a[180:183], a[116:119], a[88:91]
  v_mfma_f32_16x16x32_bf16 a[92:95], a[180:183], a[124:127], a[92:95]
  v_mfma_f32_16x16x32_bf16 a[92:95], a[176:179], a[120:123], a[92:95]
L_gelu:
  v_add_u32 v19, 65536, v18
  v_add_u32 v20, 131072, v18
  v_pk_mul_f32 v[34:35], v[60:61], v[60:61]
  v_pk_mul_f32 v[36:37], v[62:63], v[62:63]
  v_pk_mul_f32 v[38:39], v[92:93], v[92:93]
  v_pk_mul_f32 v[40:41], v[94:95], v[94:95]
  v_pk_fma_f32 v[34:35], v[34:35], v[30:31], v[28:29]
  v_pk_fma_f32 v[36:37], v[36:37], v[30:31], v[28:29]
  v_pk_fma_f32 v[38:39], v[38:39], v[30:31], v[28:29]
  v_pk_fma_f32 v[40:41], v[40:41], v[30:31], v[28:29]
  s_add_u32 s45, s78, 700416
  s_add_u32 m0, s80, 83968
  s_nop 0
  buffer_load_dwordx4 v1, s[68:71], s45 offen offset:0 lds
  v_pk_mul_f32 v[34:35], v[60:61], v[34:35]
  v_pk_mul_f32 v[36:37], v[62:63], v[36:37]
  v_pk_mul_f32 v[38:39], v[92:93], v[38:39]
  v_pk_mul_f32 v[40:41], v[94:95], v[40:41]
  v_pk_mul_f32 v[76:77], v[60:61], v[76:77]
  v_pk_mul_f32 v[78:79], v[62:63], v[78:79]
  v_pk_mul_f32 v[108:109], v[92:93], v[108:109]
  v_pk_mul_f32 v[110:111], v[94:95], v[110:111]
  v_exp_f32 v34, v34
  v_exp_f32 v35, v35
  v_exp_f32 v36, v36
  v_exp_f32 v37, v37
  v_exp_f32 v38, v38
  v_exp_f32 v39, v39
  v_exp_f32 v40, v40
  v_exp_f32 v41, v41
  v_pk_add_f32 v[34:35], v[34:35], v[32:33]
  v_pk_add_f32 v[36:37], v[36:37], v[32:33]
  v_pk_add_f32 v[38:39], v[38:39], v[32:33]
  v_pk_add_f32 v[40:41], v[40:41], v[32:33]
  v_rcp_f32 v34, v34
  v_rcp_f32 v35, v35
  v_rcp_f32 v36, v36
  v_rcp_f32 v37, v37
  v_rcp_f32 v38, v38
  v_rcp_f32 v39, v39
  v_rcp_f32 v40, v40
  v_rcp_f32 v41, v41
  v_pk_mul_f32 v[76:77], v[76:77], v[34:35]
  v_pk_mul_f32 v[78:79], v[78:79], v[36:37]
  v_pk_mul_f32 v[108:109], v[108:109], v[38:39]
  v_pk_mul_f32 v[110:111], v[110:111], v[40:41]
  v_cvt_pk_bf16_f32 v42, v76, v77
  v_cvt_pk_bf16_f32 v43, v78, v79
  v_cvt_pk_bf16_f32 v44, v108, v109
  v_cvt_pk_bf16_f32 v45, v110, v111
  s_add_u32 s51, s48, 36864
  buffer_store_dwordx4 v[42:45], v26, s[24:27], s51 offen sc1
  v_pk_mul_f32 v[34:35], v[64:65], v[64:65]
  v_pk_mul_f32 v[36:37], v[66:67], v[66:67]
  v_pk_mul_f32 v[38:39], v[96:97], v[96:97]
  v_pk_mul_f32 v[40:41], v[98:99], v[98:99]
  v_pk_mul_f32 v[56:57], v[68:69], v[68:69]
  v_pk_mul_f32 v[58:59], v[70:71], v[70:71]
  v_pk_mul_f32 v[72:73], v[100:101], v[100:101]
  v_pk_mul_f32 v[74:75], v[102:103], v[102:103]
  v_pk_fma_f32 v[34:35], v[34:35], v[30:31], v[28:29]
  v_pk_fma_f32 v[36:37], v[36:37], v[30:31], v[28:29]
  v_pk_fma_f32 v[38:39], v[38:39], v[30:31], v[28:29]
  v_pk_fma_f32 v[40:41], v[40:41], v[30:31], v[28:29]
  v_pk_fma_f32 v[56:57], v[56:57], v[30:31], v[28:29]
  v_pk_fma_f32 v[58:59], v[58:59], v[30:31], v[28:29]
  v_pk_fma_f32 v[72:73], v[72:73], v[30:31], v[28:29]
  v_pk_fma_f32 v[74:75], v[74:75], v[30:31], v[28:29]
  buffer_load_dwordx4 v2, s[68:71], s45 offen offset:1024 lds
  v_pk_mul_f32 v[34:35], v[64:65], v[34:35]
  v_pk_mul_f32 v[36:37], v[66:67], v[36:37]
  v_pk_mul_f32 v[38:39], v[96:97], v[38:39]
  v_pk_mul_f32 v[40:41], v[98:99], v[40:41]
  v_pk_mul_f32 v[56:57], v[68:69], v[56:57]
  v_pk_mul_f32 v[58:59], v[70:71], v[58:59]
  v_pk_mul_f32 v[72:73], v[100:101], v[72:73]
  v_pk_mul_f32 v[74:75], v[102:103], v[74:75]
  v_pk_mul_f32 v[80:81], v[64:65], v[80:81]
  v_pk_mul_f32 v[82:83], v[66:67], v[82:83]
  v_pk_mul_f32 v[112:113], v[96:97], v[112:113]
  v_pk_mul_f32 v[114:115], v[98:99], v[114:115]
  v_pk_mul_f32 v[84:85], v[68:69], v[84:85]
  v_pk_mul_f32 v[86:87], v[70:71], v[86:87]
  v_pk_mul_f32 v[116:117], v[100:101], v[116:117]
  v_pk_mul_f32 v[118:119], v[102:103], v[118:119]
  buffer_load_dwordx4 v3, s[68:71], s45 offen offset:2048 lds
  v_exp_f32 v34, v34
  v_exp_f32 v35, v35
  v_exp_f32 v36, v36
  v_exp_f32 v37, v37
  v_exp_f32 v38, v38
  v_exp_f32 v39, v39
  v_exp_f32 v40, v40
  v_exp_f32 v41, v41
  v_exp_f32 v56, v56
  v_exp_f32 v57, v57
  v_exp_f32 v58, v58
  v_exp_f32 v59, v59
  v_exp_f32 v72, v72
  v_exp_f32 v73, v73
  v_exp_f32 v74, v74
  v_exp_f32 v75, v75
  v_pk_add_f32 v[34:35], v[34:35], v[32:33]
  v_pk_add_f32 v[36:37], v[36:37], v[32:33]
  v_pk_add_f32 v[38:39], v[38:39], v[32:33]
  v_pk_add_f32 v[40:41], v[40:41], v[32:33]
  v_pk_add_f32 v[56:57], v[56:57], v[32:33]
  v_pk_add_f32 v[58:59], v[58:59], v[32:33]
  v_pk_add_f32 v[72:73], v[72:73], v[32:33]
  v_pk_add_f32 v[74:75], v[74:75], v[32:33]
  v_rcp_f32 v34, v34
  v_rcp_f32 v35, v35
  v_rcp_f32 v36, v36
  v_rcp_f32 v37, v37
  v_rcp_f32 v38, v38
  v_rcp_f32 v39, v39
  v_rcp_f32 v40, v40
  v_rcp_f32 v41, v41
  v_rcp_f32 v56, v56
  v_rcp_f32 v57, v57
  v_rcp_f32 v58, v58
  v_rcp_f32 v59, v59
  v_rcp_f32 v72, v72
  v_rcp_f32 v73, v73
  v_rcp_f32 v74, v74
  v_rcp_f32 v75, v75
  v_pk_mul_f32 v[80:81], v[80:81], v[34:35]
  v_pk_mul_f32 v[82:83], v[82:83], v[36:37]
  v_pk_mul_f32 v[112:113], v[112:113], v[38:39]
  v_pk_mul_f32 v[114:115], v[114:115], v[40:41]
  v_pk_mul_f32 v[84:85], v[84:85], v[56:57]
  v_pk_mul_f32 v[86:87], v[86:87], v[58:59]
  v_pk_mul_f32 v[116:117], v[116:117], v[72:73]
  v_pk_mul_f32 v[118:119], v[118:119], v[74:75]
  v_cvt_pk_bf16_f32 v42, v80, v81
  v_cvt_pk_bf16_f32 v43, v82, v83
  v_cvt_pk_bf16_f32 v44, v112, v113
  v_cvt_pk_bf16_f32 v45, v114, v115
  v_cvt_pk_bf16_f32 v46, v84, v85
  v_cvt_pk_bf16_f32 v47, v86, v87
  v_cvt_pk_bf16_f32 v48, v116, v117
  v_cvt_pk_bf16_f32 v49, v118, v119
  s_add_u32 s51, s48, 73728
  buffer_store_dwordx4 v[42:45], v26, s[24:27], s51 offen sc1
  s_add_u32 s51, s48, 110592
  buffer_store_dwordx4 v[46:49], v26, s[24:27], s51 offen sc1
  v_pk_mul_f32 v[34:35], v[120:121], v[120:121]
  v_pk_mul_f32 v[36:37], v[122:123], v[122:123]
  v_pk_mul_f32 v[38:39], v[152:153], v[152:153]
  v_pk_mul_f32 v[40:41], v[154:155], v[154:155]
  v_pk_mul_f32 v[56:57], v[124:125], v[124:125]
  v_pk_mul_f32 v[58:59], v[126:127], v[126:127]
  v_pk_mul_f32 v[72:73], v[156:157], v[156:157]
  v_pk_mul_f32 v[74:75], v[158:159], v[158:159]
  v_pk_fma_f32 v[34:35], v[34:35], v[30:31], v[28:29]
  v_pk_fma_f32 v[36:37], v[36:37], v[30:31], v[28:29]
  v_pk_fma_f32 v[38:39], v[38:39], v[30:31], v[28:29]
  v_pk_fma_f32 v[40:41], v[40:41], v[30:31], v[28:29]
  v_pk_fma_f32 v[56:57], v[56:57], v[30:31], v[28:29]
  v_pk_fma_f32 v[58:59], v[58:59], v[30:31], v[28:29]
  v_pk_fma_f32 v[72:73], v[72:73], v[30:31], v[28:29]
  v_pk_fma_f32 v[74:75], v[74:75], v[30:31], v[28:29]
  buffer_load_dwordx4 v4, s[68:71], s45 offen offset:3072 lds
  v_pk_mul_f32 v[34:35], v[120:121], v[34:35]
  v_pk_mul_f32 v[36:37], v[122:123], v[36:37]
  v_pk_mul_f32 v[38:39], v[152:153], v[38:39]
  v_pk_mul_f32 v[40:41], v[154:155], v[40:41]
  v_pk_mul_f32 v[56:57], v[124:125], v[56:57]
  v_pk_mul_f32 v[58:59], v[126:127], v[58:59]
  v_pk_mul_f32 v[72:73], v[156:157], v[72:73]
  v_pk_mul_f32 v[74:75], v[158:159], v[74:75]
  v_pk_mul_f32 v[136:137], v[120:121], v[136:137]
  v_pk_mul_f32 v[138:139], v[122:123], v[138:139]
  v_pk_mul_f32 v[168:169], v[152:153], v[168:169]
  v_pk_mul_f32 v[170:171], v[154:155], v[170:171]
  v_pk_mul_f32 v[140:141], v[124:125], v[140:141]
  v_pk_mul_f32 v[142:143], v[126:127], v[142:143]
  v_pk_mul_f32 v[172:173], v[156:157], v[172:173]
  v_pk_mul_f32 v[174:175], v[158:159], v[174:175]
  s_add_u32 m0, s80, 88064
  s_nop 0
  buffer_load_dwordx4 v5, s[68:71], s45 offen offset:0 lds
  v_exp_f32 v34, v34
  v_exp_f32 v35, v35
  v_exp_f32 v36, v36
  v_exp_f32 v37, v37
  v_exp_f32 v38, v38
  v_exp_f32 v39, v39
  v_exp_f32 v40, v40
  v_exp_f32 v41, v41
  v_exp_f32 v56, v56
  v_exp_f32 v57, v57
  v_exp_f32 v58, v58
  v_exp_f32 v59, v59
  v_exp_f32 v72, v72
  v_exp_f32 v73, v73
  v_exp_f32 v74, v74
  v_exp_f32 v75, v75
  v_pk_add_f32 v[34:35], v[34:35], v[32:33]
  v_pk_add_f32 v[36:37], v[36:37], v[32:33]
  v_pk_add_f32 v[38:39], v[38:39], v[32:33]
  v_pk_add_f32 v[40:41], v[40:41], v[32:33]
  v_pk_add_f32 v[56:57], v[56:57], v[32:33]
  v_pk_add_f32 v[58:59], v[58:59], v[32:33]
  v_pk_add_f32 v[72:73], v[72:73], v[32:33]
  v_pk_add_f32 v[74:75], v[74:75], v[32:33]
  v_rcp_f32 v34, v34
  v_rcp_f32 v35, v35
  v_rcp_f32 v36, v36
  v_rcp_f32 v37, v37
  v_rcp_f32 v38, v38
  v_rcp_f32 v39, v39
  v_rcp_f32 v40, v40
  v_rcp_f32 v41, v41
  v_rcp_f32 v56, v56
  v_rcp_f32 v57, v57
  v_rcp_f32 v58, v58
  v_rcp_f32 v59, v59
  v_rcp_f32 v72, v72
  v_rcp_f32 v73, v73
  v_rcp_f32 v74, v74
  v_rcp_f32 v75, v75
  v_pk_mul_f32 v[136:137], v[136:137], v[34:35]
  v_pk_mul_f32 v[138:139], v[138:139], v[36:37]
  v_pk_mul_f32 v[168:169], v[168:169], v[38:39]
  v_pk_mul_f32 v[170:171], v[170:171], v[40:41]
  v_pk_mul_f32 v[140:141], v[140:141], v[56:57]
  v_pk_mul_f32 v[142:143], v[142:143], v[58:59]
  v_pk_mul_f32 v[172:173], v[172:173], v[72:73]
  v_pk_mul_f32 v[174:175], v[174:175], v[74:75]
  v_cvt_pk_bf16_f32 v42, v136, v137
  v_cvt_pk_bf16_f32 v43, v138, v139
  v_cvt_pk_bf16_f32 v44, v168, v169
  v_cvt_pk_bf16_f32 v45, v170, v171
  v_cvt_pk_bf16_f32 v46, v140, v141
  v_cvt_pk_bf16_f32 v47, v142, v143
  v_cvt_pk_bf16_f32 v48, v172, v173
  v_cvt_pk_bf16_f32 v49, v174, v175
  s_add_u32 s51, s48, 8192
  buffer_store_dwordx4 v[42:45], v26, s[24:27], s51 offen sc1
  s_add_u32 s51, s48, 45056
  buffer_store_dwordx4 v[46:49], v26, s[24:27], s51 offen sc1
  v_pk_mul_f32 v[34:35], v[128:129], v[128:129]
  v_pk_mul_f32 v[36:37], v[130:131], v[130:131]
  v_pk_mul_f32 v[38:39], v[160:161], v[160:161]
  v_pk_mul_f32 v[40:41], v[162:163], v[162:163]
  v_pk_mul_f32 v[56:57], v[132:133], v[132:133]
  v_pk_mul_f32 v[58:59], v[134:135], v[134:135]
  v_pk_mul_f32 v[72:73], v[164:165], v[164:165]
  v_pk_mul_f32 v[74:75], v[166:167], v[166:167]
  v_pk_fma_f32 v[34:35], v[34:35], v[30:31], v[28:29]
  v_pk_fma_f32 v[36:37], v[36:37], v[30:31], v[28:29]
  v_pk_fma_f32 v[38:39], v[38:39], v[30:31], v[28:29]
  v_pk_fma_f32 v[40:41], v[40:41], v[30:31], v[28:29]
  v_pk_fma_f32 v[56:57], v[56:57], v[30:31], v[28:29]
  v_pk_fma_f32 v[58:59], v[58:59], v[30:31], v[28:29]
  v_pk_fma_f32 v[72:73], v[72:73], v[30:31], v[28:29]
  v_pk_fma_f32 v[74:75], v[74:75], v[30:31], v[28:29]
  buffer_load_dwordx4 v6, s[68:71], s45 offen offset:1024 lds
  v_pk_mul_f32 v[34:35], v[128:129], v[34:35]
  v_pk_mul_f32 v[36:37], v[130:131], v[36:37]
  v_pk_mul_f32 v[38:39], v[160:161], v[38:39]
  v_pk_mul_f32 v[40:41], v[162:163], v[40:41]
  v_pk_mul_f32 v[56:57], v[132:133], v[56:57]
  v_pk_mul_f32 v[58:59], v[134:135], v[58:59]
  v_pk_mul_f32 v[72:73], v[164:165], v[72:73]
  v_pk_mul_f32 v[74:75], v[166:167], v[74:75]
  v_pk_mul_f32 v[144:145], v[128:129], v[144:145]
  v_pk_mul_f32 v[146:147], v[130:131], v[146:147]
  v_pk_mul_f32 v[176:177], v[160:161], v[176:177]
  v_pk_mul_f32 v[178:179], v[162:163], v[178:179]
  v_pk_mul_f32 v[148:149], v[132:133], v[148:149]
  v_pk_mul_f32 v[150:151], v[134:135], v[150:151]
  v_pk_mul_f32 v[180:181], v[164:165], v[180:181]
  v_pk_mul_f32 v[182:183], v[166:167], v[182:183]
  buffer_load_dwordx4 v7, s[68:71], s45 offen offset:2048 lds
  v_exp_f32 v34, v34
  v_exp_f32 v35, v35
  v_exp_f32 v36, v36
  v_exp_f32 v37, v37
  v_exp_f32 v38, v38
  v_exp_f32 v39, v39
  v_exp_f32 v40, v40
  v_exp_f32 v41, v41
  v_exp_f32 v56, v56
  v_exp_f32 v57, v57
  v_exp_f32 v58, v58
  v_exp_f32 v59, v59
  v_exp_f32 v72, v72
  v_exp_f32 v73, v73
  v_exp_f32 v74, v74
  v_exp_f32 v75, v75
  v_pk_add_f32 v[34:35], v[34:35], v[32:33]
  v_pk_add_f32 v[36:37], v[36:37], v[32:33]
  v_pk_add_f32 v[38:39], v[38:39], v[32:33]
  v_pk_add_f32 v[40:41], v[40:41], v[32:33]
  v_pk_add_f32 v[56:57], v[56:57], v[32:33]
  v_pk_add_f32 v[58:59], v[58:59], v[32:33]
  v_pk_add_f32 v[72:73], v[72:73], v[32:33]
  v_pk_add_f32 v[74:75], v[74:75], v[32:33]
  v_rcp_f32 v34, v34
  v_rcp_f32 v35, v35
  v_rcp_f32 v36, v36
  v_rcp_f32 v37, v37
  v_rcp_f32 v38, v38
  v_rcp_f32 v39, v39
  v_rcp_f32 v40, v40
  v_rcp_f32 v41, v41
  v_rcp_f32 v56, v56
  v_rcp_f32 v57, v57
  v_rcp_f32 v58, v58
  v_rcp_f32 v59, v59
  v_rcp_f32 v72, v72
  v_rcp_f32 v73, v73
  v_rcp_f32 v74, v74
  v_rcp_f32 v75, v75
  v_pk_mul_f32 v[144:145], v[144:145], v[34:35]
  v_pk_mul_f32 v[146:147], v[146:147], v[36:37]
  v_pk_mul_f32 v[176:177], v[176:177], v[38:39]
  v_pk_mul_f32 v[178:179], v[178:179], v[40:41]
  v_pk_mul_f32 v[148:149], v[148:149], v[56:57]
  v_pk_mul_f32 v[150:151], v[150:151], v[58:59]
  v_pk_mul_f32 v[180:181], v[180:181], v[72:73]
  v_pk_mul_f32 v[182:183], v[182:183], v[74:75]
  v_cvt_pk_bf16_f32 v42, v144, v145
  v_cvt_pk_bf16_f32 v43, v146, v147
  v_cvt_pk_bf16_f32 v44, v176, v177
  v_cvt_pk_bf16_f32 v45, v178, v179
  v_cvt_pk_bf16_f32 v46, v148, v149
  v_cvt_pk_bf16_f32 v47, v150, v151
  v_cvt_pk_bf16_f32 v48, v180, v181
  v_cvt_pk_bf16_f32 v49, v182, v183
  s_add_u32 s51, s48, 81920
  buffer_store_dwordx4 v[42:45], v26, s[24:27], s51 offen sc1
  s_add_u32 s51, s48, 118784
  buffer_store_dwordx4 v[46:49], v26, s[24:27], s51 offen sc1
  s_lshl_b32 s62, s3, 7
  s_add_u32 s62, s62, L_p2-standalone__glu_gated_geglu__prompt_kernel
  s_min_u32 s62, s62, L_end-standalone__glu_gated_geglu__prompt_kernel
  s_add_u32 s62, s62, s100
  s_addc_u32 s63, s101, 0
  v_mov_b32 v46, s62
  v_mov_b32 v47, s63
  global_load_dword v252, v[46:47], off
  v_pk_mul_f32 v[34:35], v[184:185], v[184:185]
  v_pk_mul_f32 v[36:37], v[186:187], v[186:187]
  v_pk_mul_f32 v[38:39], v[216:217], v[216:217]
  v_pk_mul_f32 v[40:41], v[218:219], v[218:219]
  v_pk_mul_f32 v[56:57], v[188:189], v[188:189]
  v_pk_mul_f32 v[58:59], v[190:191], v[190:191]
  v_pk_mul_f32 v[72:73], v[220:221], v[220:221]
  v_pk_mul_f32 v[74:75], v[222:223], v[222:223]
  v_pk_fma_f32 v[34:35], v[34:35], v[30:31], v[28:29]
  v_pk_fma_f32 v[36:37], v[36:37], v[30:31], v[28:29]
  v_pk_fma_f32 v[38:39], v[38:39], v[30:31], v[28:29]
  v_pk_fma_f32 v[40:41], v[40:41], v[30:31], v[28:29]
  v_pk_fma_f32 v[56:57], v[56:57], v[30:31], v[28:29]
  v_pk_fma_f32 v[58:59], v[58:59], v[30:31], v[28:29]
  v_pk_fma_f32 v[72:73], v[72:73], v[30:31], v[28:29]
  v_pk_fma_f32 v[74:75], v[74:75], v[30:31], v[28:29]
  buffer_load_dwordx4 v8, s[68:71], s45 offen offset:3072 lds
  v_pk_mul_f32 v[34:35], v[184:185], v[34:35]
  v_pk_mul_f32 v[36:37], v[186:187], v[36:37]
  v_pk_mul_f32 v[38:39], v[216:217], v[38:39]
  v_pk_mul_f32 v[40:41], v[218:219], v[40:41]
  v_pk_mul_f32 v[56:57], v[188:189], v[56:57]
  v_pk_mul_f32 v[58:59], v[190:191], v[58:59]
  v_pk_mul_f32 v[72:73], v[220:221], v[72:73]
  v_pk_mul_f32 v[74:75], v[222:223], v[74:75]
  v_pk_mul_f32 v[200:201], v[184:185], v[200:201]
  v_pk_mul_f32 v[202:203], v[186:187], v[202:203]
  v_pk_mul_f32 v[232:233], v[216:217], v[232:233]
  v_pk_mul_f32 v[234:235], v[218:219], v[234:235]
  v_pk_mul_f32 v[204:205], v[188:189], v[204:205]
  v_pk_mul_f32 v[206:207], v[190:191], v[206:207]
  v_pk_mul_f32 v[236:237], v[220:221], v[236:237]
  v_pk_mul_f32 v[238:239], v[222:223], v[238:239]
  s_add_u32 m0, s80, 92160
  s_nop 0
  buffer_load_dwordx4 v9, s[68:71], s45 offen offset:0 lds
  v_exp_f32 v34, v34
  v_exp_f32 v35, v35
  v_exp_f32 v36, v36
  v_exp_f32 v37, v37
  v_exp_f32 v38, v38
  v_exp_f32 v39, v39
  v_exp_f32 v40, v40
  v_exp_f32 v41, v41
  v_exp_f32 v56, v56
  v_exp_f32 v57, v57
  v_exp_f32 v58, v58
  v_exp_f32 v59, v59
  v_exp_f32 v72, v72
  v_exp_f32 v73, v73
  v_exp_f32 v74, v74
  v_exp_f32 v75, v75
  v_pk_add_f32 v[34:35], v[34:35], v[32:33]
  v_pk_add_f32 v[36:37], v[36:37], v[32:33]
  v_pk_add_f32 v[38:39], v[38:39], v[32:33]
  v_pk_add_f32 v[40:41], v[40:41], v[32:33]
  v_pk_add_f32 v[56:57], v[56:57], v[32:33]
  v_pk_add_f32 v[58:59], v[58:59], v[32:33]
  v_pk_add_f32 v[72:73], v[72:73], v[32:33]
  v_pk_add_f32 v[74:75], v[74:75], v[32:33]
  v_rcp_f32 v34, v34
  v_rcp_f32 v35, v35
  v_rcp_f32 v36, v36
  v_rcp_f32 v37, v37
  v_rcp_f32 v38, v38
  v_rcp_f32 v39, v39
  v_rcp_f32 v40, v40
  v_rcp_f32 v41, v41
  v_rcp_f32 v56, v56
  v_rcp_f32 v57, v57
  v_rcp_f32 v58, v58
  v_rcp_f32 v59, v59
  v_rcp_f32 v72, v72
  v_rcp_f32 v73, v73
  v_rcp_f32 v74, v74
  v_rcp_f32 v75, v75
  v_pk_mul_f32 v[200:201], v[200:201], v[34:35]
  v_pk_mul_f32 v[202:203], v[202:203], v[36:37]
  v_pk_mul_f32 v[232:233], v[232:233], v[38:39]
  v_pk_mul_f32 v[234:235], v[234:235], v[40:41]
  v_pk_mul_f32 v[204:205], v[204:205], v[56:57]
  v_pk_mul_f32 v[206:207], v[206:207], v[58:59]
  v_pk_mul_f32 v[236:237], v[236:237], v[72:73]
  v_pk_mul_f32 v[238:239], v[238:239], v[74:75]
  v_cvt_pk_bf16_f32 v42, v200, v201
  v_cvt_pk_bf16_f32 v43, v202, v203
  v_cvt_pk_bf16_f32 v44, v232, v233
  v_cvt_pk_bf16_f32 v45, v234, v235
  v_cvt_pk_bf16_f32 v46, v204, v205
  v_cvt_pk_bf16_f32 v47, v206, v207
  v_cvt_pk_bf16_f32 v48, v236, v237
  v_cvt_pk_bf16_f32 v49, v238, v239
  s_add_u32 s51, s48, 16384
  buffer_store_dwordx4 v[42:45], v26, s[24:27], s51 offen sc1
  s_add_u32 s51, s48, 53248
  buffer_store_dwordx4 v[46:49], v26, s[24:27], s51 offen sc1
  v_pk_mul_f32 v[34:35], v[192:193], v[192:193]
  v_pk_mul_f32 v[36:37], v[194:195], v[194:195]
  v_pk_mul_f32 v[38:39], v[224:225], v[224:225]
  v_pk_mul_f32 v[40:41], v[226:227], v[226:227]
  v_pk_mul_f32 v[56:57], v[196:197], v[196:197]
  v_pk_mul_f32 v[58:59], v[198:199], v[198:199]
  v_pk_mul_f32 v[72:73], v[228:229], v[228:229]
  v_pk_mul_f32 v[74:75], v[230:231], v[230:231]
  v_pk_fma_f32 v[34:35], v[34:35], v[30:31], v[28:29]
  v_pk_fma_f32 v[36:37], v[36:37], v[30:31], v[28:29]
  v_pk_fma_f32 v[38:39], v[38:39], v[30:31], v[28:29]
  v_pk_fma_f32 v[40:41], v[40:41], v[30:31], v[28:29]
  v_pk_fma_f32 v[56:57], v[56:57], v[30:31], v[28:29]
  v_pk_fma_f32 v[58:59], v[58:59], v[30:31], v[28:29]
  v_pk_fma_f32 v[72:73], v[72:73], v[30:31], v[28:29]
  v_pk_fma_f32 v[74:75], v[74:75], v[30:31], v[28:29]
  v_pk_mul_f32 v[34:35], v[192:193], v[34:35]
  v_pk_mul_f32 v[36:37], v[194:195], v[36:37]
  v_pk_mul_f32 v[38:39], v[224:225], v[38:39]
  v_pk_mul_f32 v[40:41], v[226:227], v[40:41]
  v_pk_mul_f32 v[56:57], v[196:197], v[56:57]
  v_pk_mul_f32 v[58:59], v[198:199], v[58:59]
  v_pk_mul_f32 v[72:73], v[228:229], v[72:73]
  v_pk_mul_f32 v[74:75], v[230:231], v[74:75]
  v_pk_mul_f32 v[208:209], v[192:193], v[208:209]
  v_pk_mul_f32 v[210:211], v[194:195], v[210:211]
  v_pk_mul_f32 v[240:241], v[224:225], v[240:241]
  v_pk_mul_f32 v[242:243], v[226:227], v[242:243]
  v_pk_mul_f32 v[212:213], v[196:197], v[212:213]
  v_pk_mul_f32 v[214:215], v[198:199], v[214:215]
  v_pk_mul_f32 v[244:245], v[228:229], v[244:245]
  v_pk_mul_f32 v[246:247], v[230:231], v[246:247]
  v_exp_f32 v34, v34
  v_exp_f32 v35, v35
  v_exp_f32 v36, v36
  v_exp_f32 v37, v37
  v_exp_f32 v38, v38
  v_exp_f32 v39, v39
  v_exp_f32 v40, v40
  v_exp_f32 v41, v41
  v_exp_f32 v56, v56
  v_exp_f32 v57, v57
  v_exp_f32 v58, v58
  v_exp_f32 v59, v59
  v_exp_f32 v72, v72
  v_exp_f32 v73, v73
  v_exp_f32 v74, v74
  v_exp_f32 v75, v75
  v_pk_add_f32 v[34:35], v[34:35], v[32:33]
  v_pk_add_f32 v[36:37], v[36:37], v[32:33]
  v_pk_add_f32 v[38:39], v[38:39], v[32:33]
  v_pk_add_f32 v[40:41], v[40:41], v[32:33]
  v_pk_add_f32 v[56:57], v[56:57], v[32:33]
  v_pk_add_f32 v[58:59], v[58:59], v[32:33]
  v_pk_add_f32 v[72:73], v[72:73], v[32:33]
  v_pk_add_f32 v[74:75], v[74:75], v[32:33]
  v_rcp_f32 v34, v34
  v_rcp_f32 v35, v35
  v_rcp_f32 v36, v36
  v_rcp_f32 v37, v37
  v_rcp_f32 v38, v38
  v_rcp_f32 v39, v39
  v_rcp_f32 v40, v40
  v_rcp_f32 v41, v41
  v_rcp_f32 v56, v56
  v_rcp_f32 v57, v57
  v_rcp_f32 v58, v58
  v_rcp_f32 v59, v59
  v_rcp_f32 v72, v72
  v_rcp_f32 v73, v73
  v_rcp_f32 v74, v74
  v_rcp_f32 v75, v75
  v_pk_mul_f32 v[208:209], v[208:209], v[34:35]
  v_pk_mul_f32 v[210:211], v[210:211], v[36:37]
  v_pk_mul_f32 v[240:241], v[240:241], v[38:39]
  v_pk_mul_f32 v[242:243], v[242:243], v[40:41]
  v_pk_mul_f32 v[212:213], v[212:213], v[56:57]
  v_pk_mul_f32 v[214:215], v[214:215], v[58:59]
  v_pk_mul_f32 v[244:245], v[244:245], v[72:73]
  v_pk_mul_f32 v[246:247], v[246:247], v[74:75]
  v_cvt_pk_bf16_f32 v42, v208, v209
  v_cvt_pk_bf16_f32 v43, v210, v211
  v_cvt_pk_bf16_f32 v44, v240, v241
  v_cvt_pk_bf16_f32 v45, v242, v243
  v_cvt_pk_bf16_f32 v46, v212, v213
  v_cvt_pk_bf16_f32 v47, v214, v215
  v_cvt_pk_bf16_f32 v48, v244, v245
  v_cvt_pk_bf16_f32 v49, v246, v247
  s_add_u32 s51, s48, 90112
  buffer_store_dwordx4 v[42:45], v26, s[24:27], s51 offen sc1
  s_add_u32 s51, s48, 126976
  buffer_store_dwordx4 v[46:49], v26, s[24:27], s51 offen sc1
  s_waitcnt vmcnt(7)
  s_add_u32 s51, s48, 0
  buffer_load_dword v252, v249, s[24:27], s51 offen
  s_add_u32 s51, s48, 8192
  buffer_load_dword v252, v249, s[24:27], s51 offen
  s_add_u32 s51, s65, 4096
  buffer_store_dword v253, v254, s[24:27], s51 offen sc1
  v_accvgpr_read_b32 v56, a0
  v_accvgpr_read_b32 v57, a1
  v_accvgpr_read_b32 v58, a2
  v_accvgpr_read_b32 v59, a3
  v_accvgpr_read_b32 v60, a16
  v_accvgpr_read_b32 v61, a17
  v_accvgpr_read_b32 v62, a18
  v_accvgpr_read_b32 v63, a19
  v_accvgpr_read_b32 v64, a32
  v_accvgpr_read_b32 v65, a33
  v_accvgpr_read_b32 v66, a34
  v_accvgpr_read_b32 v67, a35
  v_accvgpr_read_b32 v68, a48
  v_accvgpr_read_b32 v69, a49
  v_accvgpr_read_b32 v70, a50
  v_accvgpr_read_b32 v71, a51
  v_accvgpr_read_b32 v72, a4
  v_accvgpr_read_b32 v73, a5
  v_accvgpr_read_b32 v74, a6
  v_accvgpr_read_b32 v75, a7
  v_accvgpr_read_b32 v76, a20
  v_accvgpr_read_b32 v77, a21
  v_accvgpr_read_b32 v78, a22
  v_accvgpr_read_b32 v79, a23
  v_accvgpr_read_b32 v80, a36
  v_accvgpr_read_b32 v81, a37
  v_accvgpr_read_b32 v82, a38
  v_accvgpr_read_b32 v83, a39
  v_accvgpr_read_b32 v84, a52
  v_accvgpr_read_b32 v85, a53
  v_accvgpr_read_b32 v86, a54
  v_accvgpr_read_b32 v87, a55
  v_pk_mul_f32 v[34:35], v[56:57], v[56:57]
  v_pk_mul_f32 v[36:37], v[58:59], v[58:59]
  v_pk_mul_f32 v[38:39], v[64:65], v[64:65]
  v_pk_mul_f32 v[40:41], v[66:67], v[66:67]
  v_pk_mul_f32 v[120:121], v[72:73], v[72:73]
  v_pk_mul_f32 v[122:123], v[74:75], v[74:75]
  v_pk_mul_f32 v[124:125], v[80:81], v[80:81]
  v_pk_mul_f32 v[126:127], v[82:83], v[82:83]
  v_pk_fma_f32 v[34:35], v[34:35], v[30:31], v[28:29]
  v_pk_fma_f32 v[36:37], v[36:37], v[30:31], v[28:29]
  v_pk_fma_f32 v[38:39], v[38:39], v[30:31], v[28:29]
  v_pk_fma_f32 v[40:41], v[40:41], v[30:31], v[28:29]
  v_pk_fma_f32 v[120:121], v[120:121], v[30:31], v[28:29]
  v_pk_fma_f32 v[122:123], v[122:123], v[30:31], v[28:29]
  v_pk_fma_f32 v[124:125], v[124:125], v[30:31], v[28:29]
  v_pk_fma_f32 v[126:127], v[126:127], v[30:31], v[28:29]
  v_pk_mul_f32 v[34:35], v[56:57], v[34:35]
  v_pk_mul_f32 v[36:37], v[58:59], v[36:37]
  v_pk_mul_f32 v[38:39], v[64:65], v[38:39]
  v_pk_mul_f32 v[40:41], v[66:67], v[40:41]
  v_pk_mul_f32 v[120:121], v[72:73], v[120:121]
  v_pk_mul_f32 v[122:123], v[74:75], v[122:123]
  v_pk_mul_f32 v[124:125], v[80:81], v[124:125]
  v_pk_mul_f32 v[126:127], v[82:83], v[126:127]
  v_pk_mul_f32 v[60:61], v[56:57], v[60:61]
  v_pk_mul_f32 v[62:63], v[58:59], v[62:63]
  v_pk_mul_f32 v[68:69], v[64:65], v[68:69]
  v_pk_mul_f32 v[70:71], v[66:67], v[70:71]
  v_pk_mul_f32 v[76:77], v[72:73], v[76:77]
  v_pk_mul_f32 v[78:79], v[74:75], v[78:79]
  v_pk_mul_f32 v[84:85], v[80:81], v[84:85]
  v_pk_mul_f32 v[86:87], v[82:83], v[86:87]
  v_exp_f32 v34, v34
  v_exp_f32 v35, v35
  v_exp_f32 v36, v36
  v_exp_f32 v37, v37
  v_exp_f32 v38, v38
  v_exp_f32 v39, v39
  v_exp_f32 v40, v40
  v_exp_f32 v41, v41
  v_exp_f32 v120, v120
  v_exp_f32 v121, v121
  v_exp_f32 v122, v122
  v_exp_f32 v123, v123
  v_exp_f32 v124, v124
  v_exp_f32 v125, v125
  v_exp_f32 v126, v126
  v_exp_f32 v127, v127
  v_pk_add_f32 v[34:35], v[34:35], v[32:33]
  v_pk_add_f32 v[36:37], v[36:37], v[32:33]
  v_pk_add_f32 v[38:39], v[38:39], v[32:33]
  v_pk_add_f32 v[40:41], v[40:41], v[32:33]
  v_pk_add_f32 v[120:121], v[120:121], v[32:33]
  v_pk_add_f32 v[122:123], v[122:123], v[32:33]
  v_pk_add_f32 v[124:125], v[124:125], v[32:33]
  v_pk_add_f32 v[126:127], v[126:127], v[32:33]
  v_rcp_f32 v34, v34
  v_rcp_f32 v35, v35
  v_rcp_f32 v36, v36
  v_rcp_f32 v37, v37
  v_rcp_f32 v38, v38
  v_rcp_f32 v39, v39
  v_rcp_f32 v40, v40
  v_rcp_f32 v41, v41
  v_rcp_f32 v120, v120
  v_rcp_f32 v121, v121
  v_rcp_f32 v122, v122
  v_rcp_f32 v123, v123
  v_rcp_f32 v124, v124
  v_rcp_f32 v125, v125
  v_rcp_f32 v126, v126
  v_rcp_f32 v127, v127
  v_pk_mul_f32 v[60:61], v[60:61], v[34:35]
  v_pk_mul_f32 v[62:63], v[62:63], v[36:37]
  v_pk_mul_f32 v[68:69], v[68:69], v[38:39]
  v_pk_mul_f32 v[70:71], v[70:71], v[40:41]
  v_pk_mul_f32 v[76:77], v[76:77], v[120:121]
  v_pk_mul_f32 v[78:79], v[78:79], v[122:123]
  v_pk_mul_f32 v[84:85], v[84:85], v[124:125]
  v_pk_mul_f32 v[86:87], v[86:87], v[126:127]
  v_cvt_pk_bf16_f32 v42, v60, v61
  v_cvt_pk_bf16_f32 v43, v62, v63
  v_cvt_pk_bf16_f32 v44, v68, v69
  v_cvt_pk_bf16_f32 v45, v70, v71
  v_cvt_pk_bf16_f32 v46, v76, v77
  v_cvt_pk_bf16_f32 v47, v78, v79
  v_cvt_pk_bf16_f32 v48, v84, v85
  v_cvt_pk_bf16_f32 v49, v86, v87
  s_add_u32 s51, s48, 24576
  buffer_store_dwordx4 v[42:45], v26, s[24:27], s51 offen sc1
  s_add_u32 s51, s48, 61440
  buffer_store_dwordx4 v[46:49], v26, s[24:27], s51 offen sc1
  v_accvgpr_read_b32 v56, a8
  v_accvgpr_read_b32 v57, a9
  v_accvgpr_read_b32 v58, a10
  v_accvgpr_read_b32 v59, a11
  v_accvgpr_read_b32 v60, a24
  v_accvgpr_read_b32 v61, a25
  v_accvgpr_read_b32 v62, a26
  v_accvgpr_read_b32 v63, a27
  v_accvgpr_read_b32 v64, a40
  v_accvgpr_read_b32 v65, a41
  v_accvgpr_read_b32 v66, a42
  v_accvgpr_read_b32 v67, a43
  v_accvgpr_read_b32 v68, a56
  v_accvgpr_read_b32 v69, a57
  v_accvgpr_read_b32 v70, a58
  v_accvgpr_read_b32 v71, a59
  v_accvgpr_read_b32 v72, a12
  v_accvgpr_read_b32 v73, a13
  v_accvgpr_read_b32 v74, a14
  v_accvgpr_read_b32 v75, a15
  v_accvgpr_read_b32 v76, a28
  v_accvgpr_read_b32 v77, a29
  v_accvgpr_read_b32 v78, a30
  v_accvgpr_read_b32 v79, a31
  v_accvgpr_read_b32 v80, a44
  v_accvgpr_read_b32 v81, a45
  v_accvgpr_read_b32 v82, a46
  v_accvgpr_read_b32 v83, a47
  v_accvgpr_read_b32 v84, a60
  v_accvgpr_read_b32 v85, a61
  v_accvgpr_read_b32 v86, a62
  v_accvgpr_read_b32 v87, a63
  v_pk_mul_f32 v[34:35], v[56:57], v[56:57]
  v_pk_mul_f32 v[36:37], v[58:59], v[58:59]
  v_pk_mul_f32 v[38:39], v[64:65], v[64:65]
  v_pk_mul_f32 v[40:41], v[66:67], v[66:67]
  v_pk_mul_f32 v[120:121], v[72:73], v[72:73]
  v_pk_mul_f32 v[122:123], v[74:75], v[74:75]
  v_pk_mul_f32 v[124:125], v[80:81], v[80:81]
  v_pk_mul_f32 v[126:127], v[82:83], v[82:83]
  v_pk_fma_f32 v[34:35], v[34:35], v[30:31], v[28:29]
  v_pk_fma_f32 v[36:37], v[36:37], v[30:31], v[28:29]
  v_pk_fma_f32 v[38:39], v[38:39], v[30:31], v[28:29]
  v_pk_fma_f32 v[40:41], v[40:41], v[30:31], v[28:29]
  v_pk_fma_f32 v[120:121], v[120:121], v[30:31], v[28:29]
  v_pk_fma_f32 v[122:123], v[122:123], v[30:31], v[28:29]
  v_pk_fma_f32 v[124:125], v[124:125], v[30:31], v[28:29]
  v_pk_fma_f32 v[126:127], v[126:127], v[30:31], v[28:29]
  v_pk_mul_f32 v[34:35], v[56:57], v[34:35]
  v_pk_mul_f32 v[36:37], v[58:59], v[36:37]
  v_pk_mul_f32 v[38:39], v[64:65], v[38:39]
  v_pk_mul_f32 v[40:41], v[66:67], v[40:41]
  v_pk_mul_f32 v[120:121], v[72:73], v[120:121]
  v_pk_mul_f32 v[122:123], v[74:75], v[122:123]
  v_pk_mul_f32 v[124:125], v[80:81], v[124:125]
  v_pk_mul_f32 v[126:127], v[82:83], v[126:127]
  v_pk_mul_f32 v[60:61], v[56:57], v[60:61]
  v_pk_mul_f32 v[62:63], v[58:59], v[62:63]
  v_pk_mul_f32 v[68:69], v[64:65], v[68:69]
  v_pk_mul_f32 v[70:71], v[66:67], v[70:71]
  v_pk_mul_f32 v[76:77], v[72:73], v[76:77]
  v_pk_mul_f32 v[78:79], v[74:75], v[78:79]
  v_pk_mul_f32 v[84:85], v[80:81], v[84:85]
  v_pk_mul_f32 v[86:87], v[82:83], v[86:87]
  v_exp_f32 v34, v34
  v_exp_f32 v35, v35
  v_exp_f32 v36, v36
  v_exp_f32 v37, v37
  v_exp_f32 v38, v38
  v_exp_f32 v39, v39
  v_exp_f32 v40, v40
  v_exp_f32 v41, v41
  v_exp_f32 v120, v120
  v_exp_f32 v121, v121
  v_exp_f32 v122, v122
  v_exp_f32 v123, v123
  v_exp_f32 v124, v124
  v_exp_f32 v125, v125
  v_exp_f32 v126, v126
  v_exp_f32 v127, v127
  v_pk_add_f32 v[34:35], v[34:35], v[32:33]
  v_pk_add_f32 v[36:37], v[36:37], v[32:33]
  v_pk_add_f32 v[38:39], v[38:39], v[32:33]
  v_pk_add_f32 v[40:41], v[40:41], v[32:33]
  v_pk_add_f32 v[120:121], v[120:121], v[32:33]
  v_pk_add_f32 v[122:123], v[122:123], v[32:33]
  v_pk_add_f32 v[124:125], v[124:125], v[32:33]
  v_pk_add_f32 v[126:127], v[126:127], v[32:33]
  v_rcp_f32 v34, v34
  v_rcp_f32 v35, v35
  v_rcp_f32 v36, v36
  v_rcp_f32 v37, v37
  v_rcp_f32 v38, v38
  v_rcp_f32 v39, v39
  v_rcp_f32 v40, v40
  v_rcp_f32 v41, v41
  v_rcp_f32 v120, v120
  v_rcp_f32 v121, v121
  v_rcp_f32 v122, v122
  v_rcp_f32 v123, v123
  v_rcp_f32 v124, v124
  v_rcp_f32 v125, v125
  v_rcp_f32 v126, v126
  v_rcp_f32 v127, v127
  v_pk_mul_f32 v[60:61], v[60:61], v[34:35]
  v_pk_mul_f32 v[62:63], v[62:63], v[36:37]
  v_pk_mul_f32 v[68:69], v[68:69], v[38:39]
  v_pk_mul_f32 v[70:71], v[70:71], v[40:41]
  v_pk_mul_f32 v[76:77], v[76:77], v[120:121]
  v_pk_mul_f32 v[78:79], v[78:79], v[122:123]
  v_pk_mul_f32 v[84:85], v[84:85], v[124:125]
  v_pk_mul_f32 v[86:87], v[86:87], v[126:127]
  v_cvt_pk_bf16_f32 v42, v60, v61
  v_cvt_pk_bf16_f32 v43, v62, v63
  v_cvt_pk_bf16_f32 v44, v68, v69
  v_cvt_pk_bf16_f32 v45, v70, v71
  v_cvt_pk_bf16_f32 v46, v76, v77
  v_cvt_pk_bf16_f32 v47, v78, v79
  v_cvt_pk_bf16_f32 v48, v84, v85
  v_cvt_pk_bf16_f32 v49, v86, v87
  s_add_u32 s51, s48, 98304
  buffer_store_dwordx4 v[42:45], v26, s[24:27], s51 offen sc1
  s_add_u32 s51, s48, 135168
  buffer_store_dwordx4 v[46:49], v26, s[24:27], s51 offen sc1
  s_waitcnt vmcnt(7)
  s_add_u32 s51, s65, 8192
  buffer_store_dword v253, v254, s[24:27], s51 offen sc1
  s_add_u32 s51, s66, 4096
  s_load_dword s4, s[52:53], s51 offset:0 glc
  s_load_dword s5, s[52:53], s51 offset:128 glc
  s_load_dword s6, s[52:53], s51 offset:256 glc
  s_load_dword s7, s[52:53], s51 offset:384 glc
  s_load_dword s8, s[52:53], s51 offset:512 glc
  s_load_dword s9, s[52:53], s51 offset:640 glc
  s_load_dword s10, s[52:53], s51 offset:768 glc
  s_load_dword s11, s[52:53], s51 offset:896 glc
  v_accvgpr_read_b32 v56, a64
  v_accvgpr_read_b32 v57, a65
  v_accvgpr_read_b32 v58, a66
  v_accvgpr_read_b32 v59, a67
  v_accvgpr_read_b32 v60, a80
  v_accvgpr_read_b32 v61, a81
  v_accvgpr_read_b32 v62, a82
  v_accvgpr_read_b32 v63, a83
  v_accvgpr_read_b32 v72, a68
  v_accvgpr_read_b32 v73, a69
  v_accvgpr_read_b32 v74, a70
  v_accvgpr_read_b32 v75, a71
  v_accvgpr_read_b32 v76, a84
  v_accvgpr_read_b32 v77, a85
  v_accvgpr_read_b32 v78, a86
  v_accvgpr_read_b32 v79, a87
  v_pk_mul_f32 v[34:35], v[56:57], v[56:57]
  v_pk_mul_f32 v[36:37], v[58:59], v[58:59]
  v_pk_mul_f32 v[38:39], v[72:73], v[72:73]
  v_pk_mul_f32 v[40:41], v[74:75], v[74:75]
  v_pk_fma_f32 v[34:35], v[34:35], v[30:31], v[28:29]
  v_pk_fma_f32 v[36:37], v[36:37], v[30:31], v[28:29]
  v_pk_fma_f32 v[38:39], v[38:39], v[30:31], v[28:29]
  v_pk_fma_f32 v[40:41], v[40:41], v[30:31], v[28:29]
  v_pk_mul_f32 v[34:35], v[56:57], v[34:35]
  v_pk_mul_f32 v[36:37], v[58:59], v[36:37]
  v_pk_mul_f32 v[38:39], v[72:73], v[38:39]
  v_pk_mul_f32 v[40:41], v[74:75], v[40:41]
  v_pk_mul_f32 v[60:61], v[56:57], v[60:61]
  v_pk_mul_f32 v[62:63], v[58:59], v[62:63]
  v_pk_mul_f32 v[76:77], v[72:73], v[76:77]
  v_pk_mul_f32 v[78:79], v[74:75], v[78:79]
  v_exp_f32 v34, v34
  v_exp_f32 v35, v35
  v_exp_f32 v36, v36
  v_exp_f32 v37, v37
  v_exp_f32 v38, v38
  v_exp_f32 v39, v39
  v_exp_f32 v40, v40
  v_exp_f32 v41, v41
  v_pk_add_f32 v[34:35], v[34:35], v[32:33]
  v_pk_add_f32 v[36:37], v[36:37], v[32:33]
  v_pk_add_f32 v[38:39], v[38:39], v[32:33]
  v_pk_add_f32 v[40:41], v[40:41], v[32:33]
  v_rcp_f32 v34, v34
  v_rcp_f32 v35, v35
  v_rcp_f32 v36, v36
  v_rcp_f32 v37, v37
  v_rcp_f32 v38, v38
  v_rcp_f32 v39, v39
  v_rcp_f32 v40, v40
  v_rcp_f32 v41, v41
  v_pk_mul_f32 v[60:61], v[60:61], v[34:35]
  v_pk_mul_f32 v[62:63], v[62:63], v[36:37]
  v_pk_mul_f32 v[76:77], v[76:77], v[38:39]
  v_pk_mul_f32 v[78:79], v[78:79], v[40:41]
  v_cvt_pk_bf16_f32 v42, v60, v61
  v_cvt_pk_bf16_f32 v43, v62, v63
  v_cvt_pk_bf16_f32 v44, v76, v77
  v_cvt_pk_bf16_f32 v45, v78, v79
  s_add_u32 s51, s49, 0
  buffer_store_dwordx2 v[42:43], v27, s[24:27], s51 offen sc1
  s_add_u32 s51, s49, 36864
  buffer_store_dwordx2 v[44:45], v27, s[24:27], s51 offen sc1
  v_accvgpr_read_b32 v56, a72
  v_accvgpr_read_b32 v57, a73
  v_accvgpr_read_b32 v58, a74
  v_accvgpr_read_b32 v59, a75
  v_accvgpr_read_b32 v60, a88
  v_accvgpr_read_b32 v61, a89
  v_accvgpr_read_b32 v62, a90
  v_accvgpr_read_b32 v63, a91
  v_accvgpr_read_b32 v72, a76
  v_accvgpr_read_b32 v73, a77
  v_accvgpr_read_b32 v74, a78
  v_accvgpr_read_b32 v75, a79
  v_accvgpr_read_b32 v76, a92
  v_accvgpr_read_b32 v77, a93
  v_accvgpr_read_b32 v78, a94
  v_accvgpr_read_b32 v79, a95
  v_pk_mul_f32 v[34:35], v[56:57], v[56:57]
  v_pk_mul_f32 v[36:37], v[58:59], v[58:59]
  v_pk_mul_f32 v[38:39], v[72:73], v[72:73]
  v_pk_mul_f32 v[40:41], v[74:75], v[74:75]
  v_pk_fma_f32 v[34:35], v[34:35], v[30:31], v[28:29]
  v_pk_fma_f32 v[36:37], v[36:37], v[30:31], v[28:29]
  v_pk_fma_f32 v[38:39], v[38:39], v[30:31], v[28:29]
  v_pk_fma_f32 v[40:41], v[40:41], v[30:31], v[28:29]
  v_pk_mul_f32 v[34:35], v[56:57], v[34:35]
  v_pk_mul_f32 v[36:37], v[58:59], v[36:37]
  v_pk_mul_f32 v[38:39], v[72:73], v[38:39]
  v_pk_mul_f32 v[40:41], v[74:75], v[40:41]
  v_pk_mul_f32 v[60:61], v[56:57], v[60:61]
  v_pk_mul_f32 v[62:63], v[58:59], v[62:63]
  v_pk_mul_f32 v[76:77], v[72:73], v[76:77]
  v_pk_mul_f32 v[78:79], v[74:75], v[78:79]
  v_exp_f32 v34, v34
  v_exp_f32 v35, v35
  v_exp_f32 v36, v36
  v_exp_f32 v37, v37
  v_exp_f32 v38, v38
  v_exp_f32 v39, v39
  v_exp_f32 v40, v40
  v_exp_f32 v41, v41
  v_pk_add_f32 v[34:35], v[34:35], v[32:33]
  v_pk_add_f32 v[36:37], v[36:37], v[32:33]
  v_pk_add_f32 v[38:39], v[38:39], v[32:33]
  v_pk_add_f32 v[40:41], v[40:41], v[32:33]
  v_rcp_f32 v34, v34
  v_rcp_f32 v35, v35
  v_rcp_f32 v36, v36
  v_rcp_f32 v37, v37
  v_rcp_f32 v38, v38
  v_rcp_f32 v39, v39
  v_rcp_f32 v40, v40
  v_rcp_f32 v41, v41
  v_pk_mul_f32 v[60:61], v[60:61], v[34:35]
  v_pk_mul_f32 v[62:63], v[62:63], v[36:37]
  v_pk_mul_f32 v[76:77], v[76:77], v[38:39]
  v_pk_mul_f32 v[78:79], v[78:79], v[40:41]
  v_cvt_pk_bf16_f32 v42, v60, v61
  v_cvt_pk_bf16_f32 v43, v62, v63
  v_cvt_pk_bf16_f32 v44, v76, v77
  v_cvt_pk_bf16_f32 v45, v78, v79
  s_add_u32 s51, s49, 73728
  buffer_store_dwordx2 v[42:43], v27, s[24:27], s51 offen sc1
  s_add_u32 s51, s49, 110592
  buffer_store_dwordx2 v[44:45], v27, s[24:27], s51 offen sc1
  s_waitcnt lgkmcnt(0)
  s_cmp_eq_u64 s[4:5], s[14:15]
  s_cbranch_scc0 L_siteA
  s_cmp_eq_u64 s[6:7], s[14:15]
  s_cbranch_scc0 L_siteA
  s_cmp_eq_u64 s[8:9], s[14:15]
  s_cbranch_scc0 L_siteA
  s_cmp_eq_u64 s[10:11], s[14:15]
  s_cbranch_scc0 L_siteA
  s_add_u32 s47, s46, 0
  buffer_load_dwordx4 a[96:99], v26, s[24:27], s47 offen offset:0 sc1
  buffer_load_dwordx4 a[104:107], v26, s[24:27], s47 offen offset:1024 sc1
  buffer_load_dwordx4 a[112:115], v26, s[24:27], s47 offen offset:2048 sc1
  buffer_load_dwordx4 a[120:123], v26, s[24:27], s47 offen offset:3072 sc1
  s_add_u32 s47, s76, 0
  buffer_load_dwordx4 a[100:103], v26, s[24:27], s47 offen offset:0 sc1
  buffer_load_dwordx4 a[108:111], v26, s[24:27], s47 offen offset:1024 sc1
  buffer_load_dwordx4 a[116:119], v26, s[24:27], s47 offen offset:2048 sc1
  buffer_load_dwordx4 a[124:127], v26, s[24:27], s47 offen offset:3072 sc1
  s_mov_b32 s72, 18
L_siteA:
L_p2:
  s_cmp_eq_u32 s72, 18
  s_cbranch_scc1 L_hw18
  s_mov_b32 s64, 0
  s_add_u32 s51, s66, 4096
L_poll1:
  s_load_dword s4, s[52:53], s51 offset:0 glc
  s_load_dword s5, s[52:53], s51 offset:128 glc
  s_load_dword s6, s[52:53], s51 offset:256 glc
  s_load_dword s7, s[52:53], s51 offset:384 glc
  s_load_dword s8, s[52:53], s51 offset:512 glc
  s_load_dword s9, s[52:53], s51 offset:640 glc
  s_load_dword s10, s[52:53], s51 offset:768 glc
  s_load_dword s11, s[52:53], s51 offset:896 glc
  s_add_u32 s64, s64, 1
  s_cmp_gt_u32 s64, 20000
  s_cbranch_scc1 L_poll1_ok
  s_waitcnt lgkmcnt(0)
  s_cmp_eq_u64 s[4:5], s[14:15]
  s_cbranch_scc0 L_poll1
  s_cmp_eq_u64 s[6:7], s[14:15]
  s_cbranch_scc0 L_poll1
  s_cmp_eq_u64 s[8:9], s[14:15]
  s_cbranch_scc0 L_poll1
  s_cmp_eq_u64 s[10:11], s[14:15]
  s_cbranch_scc0 L_poll1
L_poll1_ok:
  s_waitcnt lgkmcnt(0)
  s_add_u32 s47, s46, 0
  buffer_load_dwordx4 a[96:99], v26, s[24:27], s47 offen offset:0 sc1
  buffer_load_dwordx4 a[104:107], v26, s[24:27], s47 offen offset:1024 sc1
  buffer_load_dwordx4 a[112:115], v26, s[24:27], s47 offen offset:2048 sc1
  buffer_load_dwordx4 a[120:123], v26, s[24:27], s47 offen offset:3072 sc1
  s_add_u32 s47, s76, 0
  buffer_load_dwordx4 a[100:103], v26, s[24:27], s47 offen offset:0 sc1
  buffer_load_dwordx4 a[108:111], v26, s[24:27], s47 offen offset:1024 sc1
  buffer_load_dwordx4 a[116:119], v26, s[24:27], s47 offen offset:2048 sc1
  buffer_load_dwordx4 a[124:127], v26, s[24:27], s47 offen offset:3072 sc1
  s_waitcnt vmcnt(0)
  s_branch L_h0done
L_hw18:
  s_waitcnt vmcnt(0)
  s_branch L_h0done
L_h0done:
  s_barrier
  ds_read_b64_tr_b16 a[224:225], v18 offset:32768
  ds_read_b64_tr_b16 a[226:227], v18 offset:37376
  ds_read_b64_tr_b16 a[228:229], v18 offset:41984
  ds_read_b64_tr_b16 a[230:231], v18 offset:46592
  ds_read_b64_tr_b16 a[232:233], v18 offset:32800
  ds_read_b64_tr_b16 a[234:235], v18 offset:37408
  ds_read_b64_tr_b16 a[236:237], v18 offset:42016
  ds_read_b64_tr_b16 a[238:239], v18 offset:46624
  s_waitcnt lgkmcnt(4)
  v_mfma_f32_16x16x32_bf16 v[64:67], a[224:227], a[96:99], 0
  ds_read_b64_tr_b16 a[240:241], v18 offset:32832
  v_mfma_f32_16x16x32_bf16 v[64:67], a[228:231], a[104:107], v[64:67]
  ds_read_b64_tr_b16 a[242:243], v18 offset:37440
  s_add_u32 s47, s46, 4096
  v_mfma_f32_16x16x32_bf16 v[68:71], a[228:231], a[108:111], 0
  ds_read_b64_tr_b16 a[244:245], v18 offset:42048
  buffer_load_dwordx4 a[128:131], v26, s[24:27], s47 offen offset:0 sc1
  v_mfma_f32_16x16x32_bf16 v[68:71], a[224:227], a[100:103], v[68:71]
  ds_read_b64_tr_b16 a[246:247], v18 offset:46656
  s_waitcnt lgkmcnt(4)
  v_mfma_f32_16x16x32_bf16 v[72:75], a[232:235], a[96:99], 0
  ds_read_b64_tr_b16 a[224:225], v18 offset:32864
  v_mfma_f32_16x16x32_bf16 v[72:75], a[236:239], a[104:107], v[72:75]
  ds_read_b64_tr_b16 a[226:227], v18 offset:37472
  v_mfma_f32_16x16x32_bf16 v[76:79], a[236:239], a[108:111], 0
  ds_read_b64_tr_b16 a[228:229], v18 offset:42080
  buffer_load_dwordx4 a[136:139], v26, s[24:27], s47 offen offset:1024 sc1
  v_mfma_f32_16x16x32_bf16 v[76:79], a[232:235], a[100:103], v[76:79]
  ds_read_b64_tr_b16 a[230:231], v18 offset:46688
  s_waitcnt lgkmcnt(4)
  v_mfma_f32_16x16x32_bf16 v[80:83], a[240:243], a[96:99], 0
  ds_read_b64_tr_b16 a[232:233], v18 offset:32896
  v_mfma_f32_16x16x32_bf16 v[80:83], a[244:247], a[104:107], v[80:83]
  ds_read_b64_tr_b16 a[234:235], v18 offset:37504
  v_mfma_f32_16x16x32_bf16 v[84:87], a[244:247], a[108:111], 0
  ds_read_b64_tr_b16 a[236:237], v18 offset:42112
  buffer_load_dwordx4 a[144:147], v26, s[24:27], s47 offen offset:2048 sc1
  v_mfma_f32_16x16x32_bf16 v[84:87], a[240:243], a[100:103], v[84:87]
  ds_read_b64_tr_b16 a[238:239], v18 offset:46720
  s_waitcnt lgkmcnt(4)
  v_mfma_f32_16x16x32_bf16 v[88:91], a[224:227], a[96:99], 0
  ds_read_b64_tr_b16 a[240:241], v18 offset:32928
  v_mfma_f32_16x16x32_bf16 v[88:91], a[228:231], a[104:107], v[88:91]
  ds_read_b64_tr_b16 a[242:243], v18 offset:37536
  v_mfma_f32_16x16x32_bf16 v[92:95], a[228:231], a[108:111], 0
  ds_read_b64_tr_b16 a[244:245], v18 offset:42144
  buffer_load_dwordx4 a[152:155], v26, s[24:27], s47 offen offset:3072 sc1
  v_mfma_f32_16x16x32_bf16 v[92:95], a[224:227], a[100:103], v[92:95]
  ds_read_b64_tr_b16 a[246:247], v18 offset:46752
  s_waitcnt lgkmcnt(4)
  v_mfma_f32_16x16x32_bf16 v[96:99], a[232:235], a[96:99], 0
  ds_read_b64_tr_b16 a[224:225], v18 offset:32960
  v_mfma_f32_16x16x32_bf16 v[96:99], a[236:239], a[104:107], v[96:99]
  ds_read_b64_tr_b16 a[226:227], v18 offset:37568
  s_add_u32 s47, s76, 4096
  v_mfma_f32_16x16x32_bf16 v[100:103], a[236:239], a[108:111], 0
  ds_read_b64_tr_b16 a[228:229], v18 offset:42176
  buffer_load_dwordx4 a[132:135], v26, s[24:27], s47 offen offset:0 sc1
  v_mfma_f32_16x16x32_bf16 v[100:103], a[232:235], a[100:103], v[100:103]
  ds_read_b64_tr_b16 a[230:231], v18 offset:46784
  s_waitcnt lgkmcnt(4)
  v_mfma_f32_16x16x32_bf16 v[104:107], a[240:243], a[96:99], 0
  ds_read_b64_tr_b16 a[232:233], v18 offset:32992
  v_mfma_f32_16x16x32_bf16 v[104:107], a[244:247], a[104:107], v[104:107]
  ds_read_b64_tr_b16 a[234:235], v18 offset:37600
  v_mfma_f32_16x16x32_bf16 v[108:111], a[244:247], a[108:111], 0
  ds_read_b64_tr_b16 a[236:237], v18 offset:42208
  buffer_load_dwordx4 a[140:143], v26, s[24:27], s47 offen offset:1024 sc1
  v_mfma_f32_16x16x32_bf16 v[108:111], a[240:243], a[100:103], v[108:111]
  ds_read_b64_tr_b16 a[238:239], v18 offset:46816
  s_waitcnt lgkmcnt(4)
  v_mfma_f32_16x16x32_bf16 v[112:115], a[224:227], a[96:99], 0
  ds_read_b64_tr_b16 a[240:241], v18 offset:33024
  v_mfma_f32_16x16x32_bf16 v[112:115], a[228:231], a[104:107], v[112:115]
  ds_read_b64_tr_b16 a[242:243], v18 offset:37632
  v_mfma_f32_16x16x32_bf16 v[116:119], a[228:231], a[108:111], 0
  ds_read_b64_tr_b16 a[244:245], v18 offset:42240
  buffer_load_dwordx4 a[148:151], v26, s[24:27], s47 offen offset:2048 sc1
  v_mfma_f32_16x16x32_bf16 v[116:119], a[224:227], a[100:103], v[116:119]
  ds_read_b64_tr_b16 a[246:247], v18 offset:46848
  s_waitcnt lgkmcnt(4)
  v_mfma_f32_16x16x32_bf16 v[120:123], a[232:235], a[96:99], 0
  ds_read_b64_tr_b16 a[224:225], v18 offset:51200
  v_mfma_f32_16x16x32_bf16 v[120:123], a[236:239], a[104:107], v[120:123]
  ds_read_b64_tr_b16 a[226:227], v18 offset:55808
  v_mfma_f32_16x16x32_bf16 v[124:127], a[236:239], a[108:111], 0
  ds_read_b64_tr_b16 a[228:229], v19 offset:55296
  buffer_load_dwordx4 a[156:159], v26, s[24:27], s47 offen offset:3072 sc1
  v_mfma_f32_16x16x32_bf16 v[124:127], a[232:235], a[100:103], v[124:127]
  ds_read_b64_tr_b16 a[230:231], v19 offset:59904
  s_waitcnt lgkmcnt(4)
  v_mfma_f32_16x16x32_bf16 v[128:131], a[240:243], a[96:99], 0
  ds_read_b64_tr_b16 a[232:233], v18 offset:51232
  v_mfma_f32_16x16x32_bf16 v[128:131], a[244:247], a[104:107], v[128:131]
  ds_read_b64_tr_b16 a[234:235], v18 offset:55840
  s_add_u32 s47, s46, 8192
  v_mfma_f32_16x16x32_bf16 v[132:135], a[244:247], a[108:111], 0
  ds_read_b64_tr_b16 a[236:237], v19 offset:55328
  buffer_load_dwordx4 a[160:163], v26, s[24:27], s47 offen offset:0 sc1
  v_mfma_f32_16x16x32_bf16 v[132:135], a[240:243], a[100:103], v[132:135]
  ds_read_b64_tr_b16 a[238:239], v19 offset:59936
  s_waitcnt lgkmcnt(4)
  v_mfma_f32_16x16x32_bf16 v[64:67], a[224:227], a[112:115], v[64:67]
  ds_read_b64_tr_b16 a[240:241], v18 offset:51264
  v_mfma_f32_16x16x32_bf16 v[64:67], a[228:231], a[120:123], v[64:67]
  ds_read_b64_tr_b16 a[242:243], v18 offset:55872
  v_mfma_f32_16x16x32_bf16 v[68:71], a[228:231], a[124:127], v[68:71]
  ds_read_b64_tr_b16 a[244:245], v19 offset:55360
  buffer_load_dwordx4 a[168:171], v26, s[24:27], s47 offen offset:1024 sc1
  v_mfma_f32_16x16x32_bf16 v[68:71], a[224:227], a[116:119], v[68:71]
  ds_read_b64_tr_b16 a[246:247], v19 offset:59968
  s_waitcnt lgkmcnt(4)
  v_mfma_f32_16x16x32_bf16 v[72:75], a[232:235], a[112:115], v[72:75]
  ds_read_b64_tr_b16 a[224:225], v18 offset:51296
  v_mfma_f32_16x16x32_bf16 v[72:75], a[236:239], a[120:123], v[72:75]
  ds_read_b64_tr_b16 a[226:227], v18 offset:55904
  v_mfma_f32_16x16x32_bf16 v[76:79], a[236:239], a[124:127], v[76:79]
  ds_read_b64_tr_b16 a[228:229], v19 offset:55392
  buffer_load_dwordx4 a[176:179], v26, s[24:27], s47 offen offset:2048 sc1
  v_mfma_f32_16x16x32_bf16 v[76:79], a[232:235], a[116:119], v[76:79]
  ds_read_b64_tr_b16 a[230:231], v19 offset:60000
  s_waitcnt lgkmcnt(4)
  s_waitcnt vmcnt(11)
  s_add_u32 s51, s65, 12288
  buffer_store_dword v253, v254, s[24:27], s51 offen sc1
  v_mfma_f32_16x16x32_bf16 v[80:83], a[240:243], a[112:115], v[80:83]
  ds_read_b64_tr_b16 a[232:233], v18 offset:51328
  v_mfma_f32_16x16x32_bf16 v[80:83], a[244:247], a[120:123], v[80:83]
  ds_read_b64_tr_b16 a[234:235], v18 offset:55936
  v_mfma_f32_16x16x32_bf16 v[84:87], a[244:247], a[124:127], v[84:87]
  ds_read_b64_tr_b16 a[236:237], v19 offset:55424
  buffer_load_dwordx4 a[184:187], v26, s[24:27], s47 offen offset:3072 sc1
  v_mfma_f32_16x16x32_bf16 v[84:87], a[240:243], a[116:119], v[84:87]
  ds_read_b64_tr_b16 a[238:239], v19 offset:60032
  s_waitcnt lgkmcnt(4)
  v_mfma_f32_16x16x32_bf16 v[88:91], a[224:227], a[112:115], v[88:91]
  ds_read_b64_tr_b16 a[240:241], v18 offset:51360
  v_mfma_f32_16x16x32_bf16 v[88:91], a[228:231], a[120:123], v[88:91]
  ds_read_b64_tr_b16 a[242:243], v18 offset:55968
  s_add_u32 s47, s76, 8192
  v_mfma_f32_16x16x32_bf16 v[92:95], a[228:231], a[124:127], v[92:95]
  ds_read_b64_tr_b16 a[244:245], v19 offset:55456
  buffer_load_dwordx4 a[164:167], v26, s[24:27], s47 offen offset:0 sc1
  v_mfma_f32_16x16x32_bf16 v[92:95], a[224:227], a[116:119], v[92:95]
  ds_read_b64_tr_b16 a[246:247], v19 offset:60064
  s_waitcnt lgkmcnt(4)
  v_mfma_f32_16x16x32_bf16 v[96:99], a[232:235], a[112:115], v[96:99]
  ds_read_b64_tr_b16 a[224:225], v18 offset:51392
  v_mfma_f32_16x16x32_bf16 v[96:99], a[236:239], a[120:123], v[96:99]
  ds_read_b64_tr_b16 a[226:227], v18 offset:56000
  v_mfma_f32_16x16x32_bf16 v[100:103], a[236:239], a[124:127], v[100:103]
  ds_read_b64_tr_b16 a[228:229], v19 offset:55488
  buffer_load_dwordx4 a[172:175], v26, s[24:27], s47 offen offset:1024 sc1
  v_mfma_f32_16x16x32_bf16 v[100:103], a[232:235], a[116:119], v[100:103]
  ds_read_b64_tr_b16 a[230:231], v19 offset:60096
  s_waitcnt lgkmcnt(4)
  v_mfma_f32_16x16x32_bf16 v[104:107], a[240:243], a[112:115], v[104:107]
  ds_read_b64_tr_b16 a[232:233], v18 offset:51424
  v_mfma_f32_16x16x32_bf16 v[104:107], a[244:247], a[120:123], v[104:107]
  ds_read_b64_tr_b16 a[234:235], v18 offset:56032
  v_mfma_f32_16x16x32_bf16 v[108:111], a[244:247], a[124:127], v[108:111]
  ds_read_b64_tr_b16 a[236:237], v19 offset:55520
  buffer_load_dwordx4 a[180:183], v26, s[24:27], s47 offen offset:2048 sc1
  v_mfma_f32_16x16x32_bf16 v[108:111], a[240:243], a[116:119], v[108:111]
  ds_read_b64_tr_b16 a[238:239], v19 offset:60128
  s_waitcnt lgkmcnt(4)
  v_mfma_f32_16x16x32_bf16 v[112:115], a[224:227], a[112:115], v[112:115]
  ds_read_b64_tr_b16 a[240:241], v18 offset:51456
  v_mfma_f32_16x16x32_bf16 v[112:115], a[228:231], a[120:123], v[112:115]
  ds_read_b64_tr_b16 a[242:243], v18 offset:56064
  v_mfma_f32_16x16x32_bf16 v[116:119], a[228:231], a[124:127], v[116:119]
  ds_read_b64_tr_b16 a[244:245], v19 offset:55552
  buffer_load_dwordx4 a[188:191], v26, s[24:27], s47 offen offset:3072 sc1
  v_mfma_f32_16x16x32_bf16 v[116:119], a[224:227], a[116:119], v[116:119]
  ds_read_b64_tr_b16 a[246:247], v19 offset:60160
  s_waitcnt vmcnt(9) lgkmcnt(0)
  s_barrier
  v_mfma_f32_16x16x32_bf16 v[120:123], a[232:235], a[112:115], v[120:123]
  ds_read_b64_tr_b16 a[224:225], v19 offset:64512
  v_mfma_f32_16x16x32_bf16 v[120:123], a[236:239], a[120:123], v[120:123]
  ds_read_b64_tr_b16 a[226:227], v20 offset:3584
  v_mfma_f32_16x16x32_bf16 v[124:127], a[236:239], a[124:127], v[124:127]
  ds_read_b64_tr_b16 a[228:229], v20 offset:8192
  v_mfma_f32_16x16x32_bf16 v[124:127], a[232:235], a[116:119], v[124:127]
  ds_read_b64_tr_b16 a[230:231], v20 offset:12800
  v_mfma_f32_16x16x32_bf16 v[128:131], a[240:243], a[112:115], v[128:131]
  ds_read_b64_tr_b16 a[232:233], v19 offset:64544
  v_mfma_f32_16x16x32_bf16 v[128:131], a[244:247], a[120:123], v[128:131]
  ds_read_b64_tr_b16 a[234:235], v20 offset:3616
  v_mfma_f32_16x16x32_bf16 v[132:135], a[244:247], a[124:127], v[132:135]
  ds_read_b64_tr_b16 a[236:237], v20 offset:8224
  v_mfma_f32_16x16x32_bf16 v[132:135], a[240:243], a[116:119], v[132:135]
  ds_read_b64_tr_b16 a[238:239], v20 offset:12832
  s_waitcnt lgkmcnt(4)
  v_mfma_f32_16x16x32_bf16 v[64:67], a[224:227], a[128:131], v[64:67]
  ds_read_b64_tr_b16 a[240:241], v19 offset:64576
  v_mfma_f32_16x16x32_bf16 v[64:67], a[228:231], a[136:139], v[64:67]
  ds_read_b64_tr_b16 a[242:243], v20 offset:3648
  s_add_u32 s45, s78, 73728
  s_add_u32 m0, s92, 0
  v_mfma_f32_16x16x32_bf16 v[68:71], a[228:231], a[140:143], v[68:71]
  ds_read_b64_tr_b16 a[244:245], v20 offset:8256
  buffer_load_dwordx4 v1, s[68:71], s45 offen offset:0 lds
  v_mfma_f32_16x16x32_bf16 v[68:71], a[224:227], a[132:135], v[68:71]
  ds_read_b64_tr_b16 a[246:247], v20 offset:12864
  s_waitcnt lgkmcnt(4)
  s_add_u32 s51, s66, 8192
  buffer_load_dword v255, v248, s[24:27], s51 offen sc1
  v_mfma_f32_16x16x32_bf16 v[72:75], a[232:235], a[128:131], v[72:75]
  ds_read_b64_tr_b16 a[224:225], v19 offset:64608
  v_mfma_f32_16x16x32_bf16 v[72:75], a[236:239], a[136:139], v[72:75]
  ds_read_b64_tr_b16 a[226:227], v20 offset:3680
  v_mfma_f32_16x16x32_bf16 v[76:79], a[236:239], a[140:143], v[76:79]
  ds_read_b64_tr_b16 a[228:229], v20 offset:8288
  buffer_load_dwordx4 v2, s[68:71], s45 offen offset:1024 lds
  v_mfma_f32_16x16x32_bf16 v[76:79], a[232:235], a[132:135], v[76:79]
  ds_read_b64_tr_b16 a[230:231], v20 offset:12896
  s_waitcnt lgkmcnt(4)
  v_mfma_f32_16x16x32_bf16 v[80:83], a[240:243], a[128:131], v[80:83]
  ds_read_b64_tr_b16 a[232:233], v19 offset:64640
  v_mfma_f32_16x16x32_bf16 v[80:83], a[244:247], a[136:139], v[80:83]
  ds_read_b64_tr_b16 a[234:235], v20 offset:3712
  v_mfma_f32_16x16x32_bf16 v[84:87], a[244:247], a[140:143], v[84:87]
  ds_read_b64_tr_b16 a[236:237], v20 offset:8320
  buffer_load_dwordx4 v3, s[68:71], s45 offen offset:2048 lds
  v_mfma_f32_16x16x32_bf16 v[84:87], a[240:243], a[132:135], v[84:87]
  ds_read_b64_tr_b16 a[238:239], v20 offset:12928
  s_waitcnt lgkmcnt(4)
  v_mfma_f32_16x16x32_bf16 v[88:91], a[224:227], a[128:131], v[88:91]
  ds_read_b64_tr_b16 a[240:241], v19 offset:64672
  v_mfma_f32_16x16x32_bf16 v[88:91], a[228:231], a[136:139], v[88:91]
  ds_read_b64_tr_b16 a[242:243], v20 offset:3744
  v_mfma_f32_16x16x32_bf16 v[92:95], a[228:231], a[140:143], v[92:95]
  ds_read_b64_tr_b16 a[244:245], v20 offset:8352
  buffer_load_dwordx4 v4, s[68:71], s45 offen offset:3072 lds
  v_mfma_f32_16x16x32_bf16 v[92:95], a[224:227], a[132:135], v[92:95]
  ds_read_b64_tr_b16 a[246:247], v20 offset:12960
  s_waitcnt lgkmcnt(4)
  v_mfma_f32_16x16x32_bf16 v[96:99], a[232:235], a[128:131], v[96:99]
  ds_read_b64_tr_b16 a[224:225], v19 offset:64704
  v_mfma_f32_16x16x32_bf16 v[96:99], a[236:239], a[136:139], v[96:99]
  ds_read_b64_tr_b16 a[226:227], v20 offset:3776
  s_add_u32 m0, s92, 4096
  v_mfma_f32_16x16x32_bf16 v[100:103], a[236:239], a[140:143], v[100:103]
  ds_read_b64_tr_b16 a[228:229], v20 offset:8384
  buffer_load_dwordx4 v5, s[68:71], s45 offen offset:0 lds
  v_mfma_f32_16x16x32_bf16 v[100:103], a[232:235], a[132:135], v[100:103]
  ds_read_b64_tr_b16 a[230:231], v20 offset:12992
  s_waitcnt lgkmcnt(4)
  v_mfma_f32_16x16x32_bf16 v[104:107], a[240:243], a[128:131], v[104:107]
  ds_read_b64_tr_b16 a[232:233], v19 offset:64736
  v_mfma_f32_16x16x32_bf16 v[104:107], a[244:247], a[136:139], v[104:107]
  ds_read_b64_tr_b16 a[234:235], v20 offset:3808
  v_mfma_f32_16x16x32_bf16 v[108:111], a[244:247], a[140:143], v[108:111]
  ds_read_b64_tr_b16 a[236:237], v20 offset:8416
  buffer_load_dwordx4 v6, s[68:71], s45 offen offset:1024 lds
  v_mfma_f32_16x16x32_bf16 v[108:111], a[240:243], a[132:135], v[108:111]
  ds_read_b64_tr_b16 a[238:239], v20 offset:13024
  s_waitcnt lgkmcnt(4)
  v_mfma_f32_16x16x32_bf16 v[112:115], a[224:227], a[128:131], v[112:115]
  ds_read_b64_tr_b16 a[240:241], v19 offset:64768
  v_mfma_f32_16x16x32_bf16 v[112:115], a[228:231], a[136:139], v[112:115]
  ds_read_b64_tr_b16 a[242:243], v20 offset:3840
  v_mfma_f32_16x16x32_bf16 v[116:119], a[228:231], a[140:143], v[116:119]
  ds_read_b64_tr_b16 a[244:245], v20 offset:8448
  buffer_load_dwordx4 v7, s[68:71], s45 offen offset:2048 lds
  v_mfma_f32_16x16x32_bf16 v[116:119], a[224:227], a[132:135], v[116:119]
  ds_read_b64_tr_b16 a[246:247], v20 offset:13056
  s_waitcnt lgkmcnt(4)
  v_mfma_f32_16x16x32_bf16 v[120:123], a[232:235], a[128:131], v[120:123]
  ds_read_b64_tr_b16 a[224:225], v20 offset:17408
  v_mfma_f32_16x16x32_bf16 v[120:123], a[236:239], a[136:139], v[120:123]
  ds_read_b64_tr_b16 a[226:227], v20 offset:22016
  v_mfma_f32_16x16x32_bf16 v[124:127], a[236:239], a[140:143], v[124:127]
  ds_read_b64_tr_b16 a[228:229], v19 offset:0
  buffer_load_dwordx4 v8, s[68:71], s45 offen offset:3072 lds
  v_mfma_f32_16x16x32_bf16 v[124:127], a[232:235], a[132:135], v[124:127]
  ds_read_b64_tr_b16 a[230:231], v19 offset:4608
  s_waitcnt lgkmcnt(4)
  v_mfma_f32_16x16x32_bf16 v[128:131], a[240:243], a[128:131], v[128:131]
  ds_read_b64_tr_b16 a[232:233], v20 offset:17440
  v_mfma_f32_16x16x32_bf16 v[128:131], a[244:247], a[136:139], v[128:131]
  ds_read_b64_tr_b16 a[234:235], v20 offset:22048
  s_add_u32 m0, s92, 8192
  v_mfma_f32_16x16x32_bf16 v[132:135], a[244:247], a[140:143], v[132:135]
  ds_read_b64_tr_b16 a[236:237], v19 offset:32
  buffer_load_dwordx4 v9, s[68:71], s45 offen offset:0 lds
  v_mfma_f32_16x16x32_bf16 v[132:135], a[240:243], a[132:135], v[132:135]
  ds_read_b64_tr_b16 a[238:239], v19 offset:4640
  s_waitcnt lgkmcnt(4)
  v_mfma_f32_16x16x32_bf16 v[64:67], a[224:227], a[144:147], v[64:67]
  ds_read_b64_tr_b16 a[240:241], v20 offset:17472
  v_mfma_f32_16x16x32_bf16 v[64:67], a[228:231], a[152:155], v[64:67]
  ds_read_b64_tr_b16 a[242:243], v20 offset:22080
  s_add_u32 s47, s46, 12288
  v_mfma_f32_16x16x32_bf16 v[68:71], a[228:231], a[156:159], v[68:71]
  ds_read_b64_tr_b16 a[244:245], v19 offset:64
  buffer_load_dwordx4 a[192:195], v26, s[24:27], s47 offen offset:0 sc1
  v_mfma_f32_16x16x32_bf16 v[68:71], a[224:227], a[148:151], v[68:71]
  ds_read_b64_tr_b16 a[246:247], v19 offset:4672
  s_waitcnt lgkmcnt(4)
  v_mfma_f32_16x16x32_bf16 v[72:75], a[232:235], a[144:147], v[72:75]
  ds_read_b64_tr_b16 a[224:225], v20 offset:17504
  v_mfma_f32_16x16x32_bf16 v[72:75], a[236:239], a[152:155], v[72:75]
  ds_read_b64_tr_b16 a[226:227], v20 offset:22112
  v_mfma_f32_16x16x32_bf16 v[76:79], a[236:239], a[156:159], v[76:79]
  ds_read_b64_tr_b16 a[228:229], v19 offset:96
  buffer_load_dwordx4 a[200:203], v26, s[24:27], s47 offen offset:1024 sc1
  v_mfma_f32_16x16x32_bf16 v[76:79], a[232:235], a[148:151], v[76:79]
  ds_read_b64_tr_b16 a[230:231], v19 offset:4704
  s_waitcnt lgkmcnt(4)
  v_mfma_f32_16x16x32_bf16 v[80:83], a[240:243], a[144:147], v[80:83]
  ds_read_b64_tr_b16 a[232:233], v20 offset:17536
  v_mfma_f32_16x16x32_bf16 v[80:83], a[244:247], a[152:155], v[80:83]
  ds_read_b64_tr_b16 a[234:235], v20 offset:22144
  v_mfma_f32_16x16x32_bf16 v[84:87], a[244:247], a[156:159], v[84:87]
  ds_read_b64_tr_b16 a[236:237], v19 offset:128
  buffer_load_dwordx4 a[208:211], v26, s[24:27], s47 offen offset:2048 sc1
  v_mfma_f32_16x16x32_bf16 v[84:87], a[240:243], a[148:151], v[84:87]
  ds_read_b64_tr_b16 a[238:239], v19 offset:4736
  s_waitcnt lgkmcnt(4)
  v_mfma_f32_16x16x32_bf16 v[88:91], a[224:227], a[144:147], v[88:91]
  ds_read_b64_tr_b16 a[240:241], v20 offset:17568
  v_mfma_f32_16x16x32_bf16 v[88:91], a[228:231], a[152:155], v[88:91]
  ds_read_b64_tr_b16 a[242:243], v20 offset:22176
  v_mfma_f32_16x16x32_bf16 v[92:95], a[228:231], a[156:159], v[92:95]
  ds_read_b64_tr_b16 a[244:245], v19 offset:160
  buffer_load_dwordx4 a[216:219], v26, s[24:27], s47 offen offset:3072 sc1
  v_mfma_f32_16x16x32_bf16 v[92:95], a[224:227], a[148:151], v[92:95]
  ds_read_b64_tr_b16 a[246:247], v19 offset:4768
  s_waitcnt lgkmcnt(4)
  v_mfma_f32_16x16x32_bf16 v[96:99], a[232:235], a[144:147], v[96:99]
  ds_read_b64_tr_b16 a[224:225], v20 offset:17600
  v_mfma_f32_16x16x32_bf16 v[96:99], a[236:239], a[152:155], v[96:99]
  ds_read_b64_tr_b16 a[226:227], v20 offset:22208
  s_add_u32 s47, s76, 12288
  v_mfma_f32_16x16x32_bf16 v[100:103], a[236:239], a[156:159], v[100:103]
  ds_read_b64_tr_b16 a[228:229], v19 offset:192
  buffer_load_dwordx4 a[196:199], v26, s[24:27], s47 offen offset:0 sc1
  v_mfma_f32_16x16x32_bf16 v[100:103], a[232:235], a[148:151], v[100:103]
  ds_read_b64_tr_b16 a[230:231], v19 offset:4800
  s_waitcnt lgkmcnt(4)
  v_mfma_f32_16x16x32_bf16 v[104:107], a[240:243], a[144:147], v[104:107]
  ds_read_b64_tr_b16 a[232:233], v20 offset:17632
  v_mfma_f32_16x16x32_bf16 v[104:107], a[244:247], a[152:155], v[104:107]
  ds_read_b64_tr_b16 a[234:235], v20 offset:22240
  v_mfma_f32_16x16x32_bf16 v[108:111], a[244:247], a[156:159], v[108:111]
  ds_read_b64_tr_b16 a[236:237], v19 offset:224
  buffer_load_dwordx4 a[204:207], v26, s[24:27], s47 offen offset:1024 sc1
  v_mfma_f32_16x16x32_bf16 v[108:111], a[240:243], a[148:151], v[108:111]
  ds_read_b64_tr_b16 a[238:239], v19 offset:4832
  s_waitcnt lgkmcnt(4)
  v_mfma_f32_16x16x32_bf16 v[112:115], a[224:227], a[144:147], v[112:115]
  ds_read_b64_tr_b16 a[240:241], v20 offset:17664
  v_mfma_f32_16x16x32_bf16 v[112:115], a[228:231], a[152:155], v[112:115]
  ds_read_b64_tr_b16 a[242:243], v20 offset:22272
  v_mfma_f32_16x16x32_bf16 v[116:119], a[228:231], a[156:159], v[116:119]
  ds_read_b64_tr_b16 a[244:245], v19 offset:256
  buffer_load_dwordx4 a[212:215], v26, s[24:27], s47 offen offset:2048 sc1
  v_mfma_f32_16x16x32_bf16 v[116:119], a[224:227], a[148:151], v[116:119]
  ds_read_b64_tr_b16 a[246:247], v19 offset:4864
  s_waitcnt vmcnt(17) lgkmcnt(0)
  s_barrier
  s_waitcnt vmcnt(15)
  v_cmp_eq_u32 vcc, v255, v253
  s_nop 3
  s_and_b32 s62, vcc_lo, 0xff
  s_cmp_eq_u32 s62, 0xff
  s_cbranch_scc1 L_ven2
  s_mov_b32 s64, 0
  s_add_u32 s51, s66, 8192
L_poll3:
  s_load_dword s4, s[52:53], s51 offset:0 glc
  s_load_dword s5, s[52:53], s51 offset:128 glc
  s_load_dword s6, s[52:53], s51 offset:256 glc
  s_load_dword s7, s[52:53], s51 offset:384 glc
  s_load_dword s8, s[52:53], s51 offset:512 glc
  s_load_dword s9, s[52:53], s51 offset:640 glc
  s_load_dword s10, s[52:53], s51 offset:768 glc
  s_load_dword s11, s[52:53], s51 offset:896 glc
  s_add_u32 s64, s64, 1
  s_cmp_gt_u32 s64, 20000
  s_cbranch_scc1 L_poll3_ok
  s_waitcnt lgkmcnt(0)
  s_cmp_eq_u64 s[4:5], s[14:15]
  s_cbranch_scc0 L_poll3
  s_cmp_eq_u64 s[6:7], s[14:15]
  s_cbranch_scc0 L_poll3
  s_cmp_eq_u64 s[8:9], s[14:15]
  s_cbranch_scc0 L_poll3
  s_cmp_eq_u64 s[10:11], s[14:15]
  s_cbranch_scc0 L_poll3
L_poll3_ok:
  s_waitcnt lgkmcnt(0)
L_ven2:
  v_mfma_f32_16x16x32_bf16 v[120:123], a[232:235], a[144:147], v[120:123]
  ds_read_b64_tr_b16 a[224:225], v18 offset:0
  v_mfma_f32_16x16x32_bf16 v[120:123], a[236:239], a[152:155], v[120:123]
  ds_read_b64_tr_b16 a[226:227], v18 offset:4608
  v_mfma_f32_16x16x32_bf16 v[124:127], a[236:239], a[156:159], v[124:127]
  ds_read_b64_tr_b16 a[228:229], v18 offset:9216
  buffer_load_dwordx4 a[220:223], v26, s[24:27], s47 offen offset:3072 sc1
  v_mfma_f32_16x16x32_bf16 v[124:127], a[232:235], a[148:151], v[124:127]
  ds_read_b64_tr_b16 a[230:231], v18 offset:13824
  v_mfma_f32_16x16x32_bf16 v[128:131], a[240:243], a[144:147], v[128:131]
  ds_read_b64_tr_b16 a[232:233], v18 offset:32
  v_mfma_f32_16x16x32_bf16 v[128:131], a[244:247], a[152:155], v[128:131]
  ds_read_b64_tr_b16 a[234:235], v18 offset:4640
  v_mfma_f32_16x16x32_bf16 v[132:135], a[244:247], a[156:159], v[132:135]
  ds_read_b64_tr_b16 a[236:237], v18 offset:9248
  v_mfma_f32_16x16x32_bf16 v[132:135], a[240:243], a[148:151], v[132:135]
  ds_read_b64_tr_b16 a[238:239], v18 offset:13856
  s_waitcnt lgkmcnt(4)
  v_mfma_f32_16x16x32_bf16 v[64:67], a[224:227], a[160:163], v[64:67]
  ds_read_b64_tr_b16 a[240:241], v18 offset:64
  v_mfma_f32_16x16x32_bf16 v[64:67], a[228:231], a[168:171], v[64:67]
  ds_read_b64_tr_b16 a[242:243], v18 offset:4672
  s_add_u32 s45, s78, 737280
  s_add_u32 m0, s93, 0
  v_mfma_f32_16x16x32_bf16 v[68:71], a[228:231], a[172:175], v[68:71]
  ds_read_b64_tr_b16 a[244:245], v18 offset:9280
  buffer_load_dwordx4 v1, s[68:71], s45 offen offset:0 lds
  v_mfma_f32_16x16x32_bf16 v[68:71], a[224:227], a[164:167], v[68:71]
  ds_read_b64_tr_b16 a[246:247], v18 offset:13888
  s_waitcnt lgkmcnt(4)
  v_mfma_f32_16x16x32_bf16 v[72:75], a[232:235], a[160:163], v[72:75]
  ds_read_b64_tr_b16 a[224:225], v18 offset:96
  v_mfma_f32_16x16x32_bf16 v[72:75], a[236:239], a[168:171], v[72:75]
  ds_read_b64_tr_b16 a[226:227], v18 offset:4704
  v_mfma_f32_16x16x32_bf16 v[76:79], a[236:239], a[172:175], v[76:79]
  ds_read_b64_tr_b16 a[228:229], v18 offset:9312
  buffer_load_dwordx4 v2, s[68:71], s45 offen offset:1024 lds
  v_mfma_f32_16x16x32_bf16 v[76:79], a[232:235], a[164:167], v[76:79]
  ds_read_b64_tr_b16 a[230:231], v18 offset:13920
  s_waitcnt lgkmcnt(4)
  v_mfma_f32_16x16x32_bf16 v[80:83], a[240:243], a[160:163], v[80:83]
  ds_read_b64_tr_b16 a[232:233], v18 offset:128
  v_mfma_f32_16x16x32_bf16 v[80:83], a[244:247], a[168:171], v[80:83]
  ds_read_b64_tr_b16 a[234:235], v18 offset:4736
  v_mfma_f32_16x16x32_bf16 v[84:87], a[244:247], a[172:175], v[84:87]
  ds_read_b64_tr_b16 a[236:237], v18 offset:9344
  buffer_load_dwordx4 v3, s[68:71], s45 offen offset:2048 lds
  v_mfma_f32_16x16x32_bf16 v[84:87], a[240:243], a[164:167], v[84:87]
  ds_read_b64_tr_b16 a[238:239], v18 offset:13952
  s_waitcnt lgkmcnt(4)
  v_mfma_f32_16x16x32_bf16 v[88:91], a[224:227], a[160:163], v[88:91]
  ds_read_b64_tr_b16 a[240:241], v18 offset:160
  v_mfma_f32_16x16x32_bf16 v[88:91], a[228:231], a[168:171], v[88:91]
  ds_read_b64_tr_b16 a[242:243], v18 offset:4768
  v_mfma_f32_16x16x32_bf16 v[92:95], a[228:231], a[172:175], v[92:95]
  ds_read_b64_tr_b16 a[244:245], v18 offset:9376
  buffer_load_dwordx4 v4, s[68:71], s45 offen offset:3072 lds
  v_mfma_f32_16x16x32_bf16 v[92:95], a[224:227], a[164:167], v[92:95]
  ds_read_b64_tr_b16 a[246:247], v18 offset:13984
  s_waitcnt lgkmcnt(4)
  v_mfma_f32_16x16x32_bf16 v[96:99], a[232:235], a[160:163], v[96:99]
  ds_read_b64_tr_b16 a[224:225], v18 offset:192
  v_mfma_f32_16x16x32_bf16 v[96:99], a[236:239], a[168:171], v[96:99]
  ds_read_b64_tr_b16 a[226:227], v18 offset:4800
  s_add_u32 m0, s93, 4096
  v_mfma_f32_16x16x32_bf16 v[100:103], a[236:239], a[172:175], v[100:103]
  ds_read_b64_tr_b16 a[228:229], v18 offset:9408
  buffer_load_dwordx4 v5, s[68:71], s45 offen offset:0 lds
  v_mfma_f32_16x16x32_bf16 v[100:103], a[232:235], a[164:167], v[100:103]
  ds_read_b64_tr_b16 a[230:231], v18 offset:14016
  s_waitcnt lgkmcnt(4)
  v_mfma_f32_16x16x32_bf16 v[104:107], a[240:243], a[160:163], v[104:107]
  ds_read_b64_tr_b16 a[232:233], v18 offset:224
  v_mfma_f32_16x16x32_bf16 v[104:107], a[244:247], a[168:171], v[104:107]
  ds_read_b64_tr_b16 a[234:235], v18 offset:4832
  v_mfma_f32_16x16x32_bf16 v[108:111], a[244:247], a[172:175], v[108:111]
  ds_read_b64_tr_b16 a[236:237], v18 offset:9440
  buffer_load_dwordx4 v6, s[68:71], s45 offen offset:1024 lds
  v_mfma_f32_16x16x32_bf16 v[108:111], a[240:243], a[164:167], v[108:111]
  ds_read_b64_tr_b16 a[238:239], v18 offset:14048
  s_waitcnt lgkmcnt(4)
  v_mfma_f32_16x16x32_bf16 v[112:115], a[224:227], a[160:163], v[112:115]
  ds_read_b64_tr_b16 a[240:241], v18 offset:256
  v_mfma_f32_16x16x32_bf16 v[112:115], a[228:231], a[168:171], v[112:115]
  ds_read_b64_tr_b16 a[242:243], v18 offset:4864
  v_mfma_f32_16x16x32_bf16 v[116:119], a[228:231], a[172:175], v[116:119]
  ds_read_b64_tr_b16 a[244:245], v18 offset:9472
  buffer_load_dwordx4 v7, s[68:71], s45 offen offset:2048 lds
  v_mfma_f32_16x16x32_bf16 v[116:119], a[224:227], a[164:167], v[116:119]
  ds_read_b64_tr_b16 a[246:247], v18 offset:14080
  s_waitcnt lgkmcnt(4)
  v_mfma_f32_16x16x32_bf16 v[120:123], a[232:235], a[160:163], v[120:123]
  ds_read_b64_tr_b16 a[224:225], v18 offset:18432
  v_mfma_f32_16x16x32_bf16 v[120:123], a[236:239], a[168:171], v[120:123]
  ds_read_b64_tr_b16 a[226:227], v18 offset:23040
  v_mfma_f32_16x16x32_bf16 v[124:127], a[236:239], a[172:175], v[124:127]
  ds_read_b64_tr_b16 a[228:229], v19 offset:9216
  buffer_load_dwordx4 v8, s[68:71], s45 offen offset:3072 lds
  v_mfma_f32_16x16x32_bf16 v[124:127], a[232:235], a[164:167], v[124:127]
  ds_read_b64_tr_b16 a[230:231], v19 offset:13824
  s_waitcnt lgkmcnt(4)
  v_mfma_f32_16x16x32_bf16 v[128:131], a[240:243], a[160:163], v[128:131]
  ds_read_b64_tr_b16 a[232:233], v18 offset:18464
  v_mfma_f32_16x16x32_bf16 v[128:131], a[244:247], a[168:171], v[128:131]
  ds_read_b64_tr_b16 a[234:235], v18 offset:23072
  s_add_u32 m0, s93, 8192
  v_mfma_f32_16x16x32_bf16 v[132:135], a[244:247], a[172:175], v[132:135]
  ds_read_b64_tr_b16 a[236:237], v19 offset:9248
  buffer_load_dwordx4 v9, s[68:71], s45 offen offset:0 lds
  v_mfma_f32_16x16x32_bf16 v[132:135], a[240:243], a[164:167], v[132:135]
  ds_read_b64_tr_b16 a[238:239], v19 offset:13856
  s_waitcnt lgkmcnt(4)
  v_mfma_f32_16x16x32_bf16 v[64:67], a[224:227], a[176:179], v[64:67]
  ds_read_b64_tr_b16 a[240:241], v18 offset:18496
  v_mfma_f32_16x16x32_bf16 v[64:67], a[228:231], a[184:187], v[64:67]
  ds_read_b64_tr_b16 a[242:243], v18 offset:23104
  s_add_u32 s47, s46, 16384
  v_mfma_f32_16x16x32_bf16 v[68:71], a[228:231], a[188:191], v[68:71]
  ds_read_b64_tr_b16 a[244:245], v19 offset:9280
  buffer_load_dwordx4 a[0:3], v26, s[24:27], s47 offen offset:0 sc1
  v_mfma_f32_16x16x32_bf16 v[68:71], a[224:227], a[180:183], v[68:71]
  ds_read_b64_tr_b16 a[246:247], v19 offset:13888
  s_waitcnt lgkmcnt(4)
  v_mfma_f32_16x16x32_bf16 v[72:75], a[232:235], a[176:179], v[72:75]
  ds_read_b64_tr_b16 a[224:225], v18 offset:18528
  v_mfma_f32_16x16x32_bf16 v[72:75], a[236:239], a[184:187], v[72:75]
  ds_read_b64_tr_b16 a[226:227], v18 offset:23136
  v_mfma_f32_16x16x32_bf16 v[76:79], a[236:239], a[188:191], v[76:79]
  ds_read_b64_tr_b16 a[228:229], v19 offset:9312
  buffer_load_dwordx4 a[8:11], v26, s[24:27], s47 offen offset:1024 sc1
  v_mfma_f32_16x16x32_bf16 v[76:79], a[232:235], a[180:183], v[76:79]
  ds_read_b64_tr_b16 a[230:231], v19 offset:13920
  s_waitcnt lgkmcnt(4)
  v_mfma_f32_16x16x32_bf16 v[80:83], a[240:243], a[176:179], v[80:83]
  ds_read_b64_tr_b16 a[232:233], v18 offset:18560
  v_mfma_f32_16x16x32_bf16 v[80:83], a[244:247], a[184:187], v[80:83]
  ds_read_b64_tr_b16 a[234:235], v18 offset:23168
  v_mfma_f32_16x16x32_bf16 v[84:87], a[244:247], a[188:191], v[84:87]
  ds_read_b64_tr_b16 a[236:237], v19 offset:9344
  buffer_load_dwordx4 a[16:19], v26, s[24:27], s47 offen offset:2048 sc1
  v_mfma_f32_16x16x32_bf16 v[84:87], a[240:243], a[180:183], v[84:87]
  ds_read_b64_tr_b16 a[238:239], v19 offset:13952
  s_waitcnt lgkmcnt(4)
  v_mfma_f32_16x16x32_bf16 v[88:91], a[224:227], a[176:179], v[88:91]
  ds_read_b64_tr_b16 a[240:241], v18 offset:18592
  v_mfma_f32_16x16x32_bf16 v[88:91], a[228:231], a[184:187], v[88:91]
  ds_read_b64_tr_b16 a[242:243], v18 offset:23200
  v_mfma_f32_16x16x32_bf16 v[92:95], a[228:231], a[188:191], v[92:95]
  ds_read_b64_tr_b16 a[244:245], v19 offset:9376
  buffer_load_dwordx4 a[24:27], v26, s[24:27], s47 offen offset:3072 sc1
  v_mfma_f32_16x16x32_bf16 v[92:95], a[224:227], a[180:183], v[92:95]
  ds_read_b64_tr_b16 a[246:247], v19 offset:13984
  s_waitcnt lgkmcnt(4)
  v_mfma_f32_16x16x32_bf16 v[96:99], a[232:235], a[176:179], v[96:99]
  ds_read_b64_tr_b16 a[224:225], v18 offset:18624
  v_mfma_f32_16x16x32_bf16 v[96:99], a[236:239], a[184:187], v[96:99]
  ds_read_b64_tr_b16 a[226:227], v18 offset:23232
  s_add_u32 s47, s76, 16384
  v_mfma_f32_16x16x32_bf16 v[100:103], a[236:239], a[188:191], v[100:103]
  ds_read_b64_tr_b16 a[228:229], v19 offset:9408
  buffer_load_dwordx4 a[4:7], v26, s[24:27], s47 offen offset:0 sc1
  v_mfma_f32_16x16x32_bf16 v[100:103], a[232:235], a[180:183], v[100:103]
  ds_read_b64_tr_b16 a[230:231], v19 offset:14016
  s_waitcnt lgkmcnt(4)
  v_mfma_f32_16x16x32_bf16 v[104:107], a[240:243], a[176:179], v[104:107]
  ds_read_b64_tr_b16 a[232:233], v18 offset:18656
  v_mfma_f32_16x16x32_bf16 v[104:107], a[244:247], a[184:187], v[104:107]
  ds_read_b64_tr_b16 a[234:235], v18 offset:23264
  v_mfma_f32_16x16x32_bf16 v[108:111], a[244:247], a[188:191], v[108:111]
  ds_read_b64_tr_b16 a[236:237], v19 offset:9440
  buffer_load_dwordx4 a[12:15], v26, s[24:27], s47 offen offset:1024 sc1
  v_mfma_f32_16x16x32_bf16 v[108:111], a[240:243], a[180:183], v[108:111]
  ds_read_b64_tr_b16 a[238:239], v19 offset:14048
  s_waitcnt lgkmcnt(4)
  v_mfma_f32_16x16x32_bf16 v[112:115], a[224:227], a[176:179], v[112:115]
  ds_read_b64_tr_b16 a[240:241], v18 offset:18688
  v_mfma_f32_16x16x32_bf16 v[112:115], a[228:231], a[184:187], v[112:115]
  ds_read_b64_tr_b16 a[242:243], v18 offset:23296
  v_mfma_f32_16x16x32_bf16 v[116:119], a[228:231], a[188:191], v[116:119]
  ds_read_b64_tr_b16 a[244:245], v19 offset:9472
  buffer_load_dwordx4 a[20:23], v26, s[24:27], s47 offen offset:2048 sc1
  v_mfma_f32_16x16x32_bf16 v[116:119], a[224:227], a[180:183], v[116:119]
  ds_read_b64_tr_b16 a[246:247], v19 offset:14080
  s_waitcnt vmcnt(16) lgkmcnt(0)
  s_barrier
  v_mfma_f32_16x16x32_bf16 v[120:123], a[232:235], a[176:179], v[120:123]
  ds_read_b64_tr_b16 a[224:225], v19 offset:18432
  v_mfma_f32_16x16x32_bf16 v[120:123], a[236:239], a[184:187], v[120:123]
  ds_read_b64_tr_b16 a[226:227], v19 offset:23040
  v_mfma_f32_16x16x32_bf16 v[124:127], a[236:239], a[188:191], v[124:127]
  ds_read_b64_tr_b16 a[228:229], v19 offset:27648
  buffer_load_dwordx4 a[28:31], v26, s[24:27], s47 offen offset:3072 sc1
  v_mfma_f32_16x16x32_bf16 v[124:127], a[232:235], a[180:183], v[124:127]
  ds_read_b64_tr_b16 a[230:231], v19 offset:32256
  v_mfma_f32_16x16x32_bf16 v[128:131], a[240:243], a[176:179], v[128:131]
  ds_read_b64_tr_b16 a[232:233], v19 offset:18464
  v_mfma_f32_16x16x32_bf16 v[128:131], a[244:247], a[184:187], v[128:131]
  ds_read_b64_tr_b16 a[234:235], v19 offset:23072
  v_mfma_f32_16x16x32_bf16 v[132:135], a[244:247], a[188:191], v[132:135]
  ds_read_b64_tr_b16 a[236:237], v19 offset:27680
  v_mfma_f32_16x16x32_bf16 v[132:135], a[240:243], a[180:183], v[132:135]
  ds_read_b64_tr_b16 a[238:239], v19 offset:32288
  s_waitcnt lgkmcnt(4)
  v_mfma_f32_16x16x32_bf16 v[64:67], a[224:227], a[192:195], v[64:67]
  ds_read_b64_tr_b16 a[240:241], v19 offset:18496
  v_mfma_f32_16x16x32_bf16 v[64:67], a[228:231], a[200:203], v[64:67]
  ds_read_b64_tr_b16 a[242:243], v19 offset:23104
  s_add_u32 s45, s78, 110592
  s_add_u32 m0, s94, 0
  v_mfma_f32_16x16x32_bf16 v[68:71], a[228:231], a[204:207], v[68:71]
  ds_read_b64_tr_b16 a[244:245], v19 offset:27712
  buffer_load_dwordx4 v1, s[68:71], s45 offen offset:0 lds
  v_mfma_f32_16x16x32_bf16 v[68:71], a[224:227], a[196:199], v[68:71]
  ds_read_b64_tr_b16 a[246:247], v19 offset:32320
  s_waitcnt lgkmcnt(4)
  s_add_u32 s51, s66, 12288
  buffer_load_dword v255, v248, s[24:27], s51 offen sc1
  v_mfma_f32_16x16x32_bf16 v[72:75], a[232:235], a[192:195], v[72:75]
  ds_read_b64_tr_b16 a[224:225], v19 offset:18528
  v_mfma_f32_16x16x32_bf16 v[72:75], a[236:239], a[200:203], v[72:75]
  ds_read_b64_tr_b16 a[226:227], v19 offset:23136
  v_mfma_f32_16x16x32_bf16 v[76:79], a[236:239], a[204:207], v[76:79]
  ds_read_b64_tr_b16 a[228:229], v19 offset:27744
  buffer_load_dwordx4 v2, s[68:71], s45 offen offset:1024 lds
  v_mfma_f32_16x16x32_bf16 v[76:79], a[232:235], a[196:199], v[76:79]
  ds_read_b64_tr_b16 a[230:231], v19 offset:32352
  s_waitcnt lgkmcnt(4)
  v_mfma_f32_16x16x32_bf16 v[80:83], a[240:243], a[192:195], v[80:83]
  ds_read_b64_tr_b16 a[232:233], v19 offset:18560
  v_mfma_f32_16x16x32_bf16 v[80:83], a[244:247], a[200:203], v[80:83]
  ds_read_b64_tr_b16 a[234:235], v19 offset:23168
  v_mfma_f32_16x16x32_bf16 v[84:87], a[244:247], a[204:207], v[84:87]
  ds_read_b64_tr_b16 a[236:237], v19 offset:27776
  buffer_load_dwordx4 v3, s[68:71], s45 offen offset:2048 lds
  v_mfma_f32_16x16x32_bf16 v[84:87], a[240:243], a[196:199], v[84:87]
  ds_read_b64_tr_b16 a[238:239], v19 offset:32384
  s_waitcnt lgkmcnt(4)
  v_mfma_f32_16x16x32_bf16 v[88:91], a[224:227], a[192:195], v[88:91]
  ds_read_b64_tr_b16 a[240:241], v19 offset:18592
  v_mfma_f32_16x16x32_bf16 v[88:91], a[228:231], a[200:203], v[88:91]
  ds_read_b64_tr_b16 a[242:243], v19 offset:23200
  v_mfma_f32_16x16x32_bf16 v[92:95], a[228:231], a[204:207], v[92:95]
  ds_read_b64_tr_b16 a[244:245], v19 offset:27808
  buffer_load_dwordx4 v4, s[68:71], s45 offen offset:3072 lds
  v_mfma_f32_16x16x32_bf16 v[92:95], a[224:227], a[196:199], v[92:95]
  ds_read_b64_tr_b16 a[246:247], v19 offset:32416
  s_waitcnt lgkmcnt(4)
  v_mfma_f32_16x16x32_bf16 v[96:99], a[232:235], a[192:195], v[96:99]
  ds_read_b64_tr_b16 a[224:225], v19 offset:18624
  v_mfma_f32_16x16x32_bf16 v[96:99], a[236:239], a[200:203], v[96:99]
  ds_read_b64_tr_b16 a[226:227], v19 offset:23232
  s_add_u32 m0, s94, 4096
  v_mfma_f32_16x16x32_bf16 v[100:103], a[236:239], a[204:207], v[100:103]
  ds_read_b64_tr_b16 a[228:229], v19 offset:27840
  buffer_load_dwordx4 v5, s[68:71], s45 offen offset:0 lds
  v_mfma_f32_16x16x32_bf16 v[100:103], a[232:235], a[196:199], v[100:103]
  ds_read_b64_tr_b16 a[230:231], v19 offset:32448
  s_waitcnt lgkmcnt(4)
  v_mfma_f32_16x16x32_bf16 v[104:107], a[240:243], a[192:195], v[104:107]
  ds_read_b64_tr_b16 a[232:233], v19 offset:18656
  v_mfma_f32_16x16x32_bf16 v[104:107], a[244:247], a[200:203], v[104:107]
  ds_read_b64_tr_b16 a[234:235], v19 offset:23264
  v_mfma_f32_16x16x32_bf16 v[108:111], a[244:247], a[204:207], v[108:111]
  ds_read_b64_tr_b16 a[236:237], v19 offset:27872
  buffer_load_dwordx4 v6, s[68:71], s45 offen offset:1024 lds
  v_mfma_f32_16x16x32_bf16 v[108:111], a[240:243], a[196:199], v[108:111]
  ds_read_b64_tr_b16 a[238:239], v19 offset:32480
  s_waitcnt lgkmcnt(4)
  v_mfma_f32_16x16x32_bf16 v[112:115], a[224:227], a[192:195], v[112:115]
  ds_read_b64_tr_b16 a[240:241], v19 offset:18688
  v_mfma_f32_16x16x32_bf16 v[112:115], a[228:231], a[200:203], v[112:115]
  ds_read_b64_tr_b16 a[242:243], v19 offset:23296
  v_mfma_f32_16x16x32_bf16 v[116:119], a[228:231], a[204:207], v[116:119]
  ds_read_b64_tr_b16 a[244:245], v19 offset:27904
  buffer_load_dwordx4 v7, s[68:71], s45 offen offset:2048 lds
  v_mfma_f32_16x16x32_bf16 v[116:119], a[224:227], a[196:199], v[116:119]
  ds_read_b64_tr_b16 a[246:247], v19 offset:32512
  s_waitcnt lgkmcnt(4)
  v_mfma_f32_16x16x32_bf16 v[120:123], a[232:235], a[192:195], v[120:123]
  ds_read_b64_tr_b16 a[224:225], v19 offset:36864
  v_mfma_f32_16x16x32_bf16 v[120:123], a[236:239], a[200:203], v[120:123]
  ds_read_b64_tr_b16 a[226:227], v19 offset:41472
  v_mfma_f32_16x16x32_bf16 v[124:127], a[236:239], a[204:207], v[124:127]
  ds_read_b64_tr_b16 a[228:229], v19 offset:46080
  buffer_load_dwordx4 v8, s[68:71], s45 offen offset:3072 lds
  v_mfma_f32_16x16x32_bf16 v[124:127], a[232:235], a[196:199], v[124:127]
  ds_read_b64_tr_b16 a[230:231], v19 offset:50688
  s_waitcnt lgkmcnt(4)
  v_mfma_f32_16x16x32_bf16 v[128:131], a[240:243], a[192:195], v[128:131]
  ds_read_b64_tr_b16 a[232:233], v19 offset:36896
  v_mfma_f32_16x16x32_bf16 v[128:131], a[244:247], a[200:203], v[128:131]
  ds_read_b64_tr_b16 a[234:235], v19 offset:41504
  s_add_u32 m0, s94, 8192
  v_mfma_f32_16x16x32_bf16 v[132:135], a[244:247], a[204:207], v[132:135]
  ds_read_b64_tr_b16 a[236:237], v19 offset:46112
  buffer_load_dwordx4 v9, s[68:71], s45 offen offset:0 lds
  v_mfma_f32_16x16x32_bf16 v[132:135], a[240:243], a[196:199], v[132:135]
  ds_read_b64_tr_b16 a[238:239], v19 offset:50720
  s_waitcnt lgkmcnt(4)
  v_mfma_f32_16x16x32_bf16 v[64:67], a[224:227], a[208:211], v[64:67]
  ds_read_b64_tr_b16 a[240:241], v19 offset:36928
  v_mfma_f32_16x16x32_bf16 v[64:67], a[228:231], a[216:219], v[64:67]
  ds_read_b64_tr_b16 a[242:243], v19 offset:41536
  s_add_u32 s47, s46, 20480
  v_mfma_f32_16x16x32_bf16 v[68:71], a[228:231], a[220:223], v[68:71]
  ds_read_b64_tr_b16 a[244:245], v19 offset:46144
  buffer_load_dwordx4 a[32:35], v26, s[24:27], s47 offen offset:0 sc1
  v_mfma_f32_16x16x32_bf16 v[68:71], a[224:227], a[212:215], v[68:71]
  ds_read_b64_tr_b16 a[246:247], v19 offset:50752
  s_waitcnt lgkmcnt(4)
  v_mfma_f32_16x16x32_bf16 v[72:75], a[232:235], a[208:211], v[72:75]
  ds_read_b64_tr_b16 a[224:225], v19 offset:36960
  v_mfma_f32_16x16x32_bf16 v[72:75], a[236:239], a[216:219], v[72:75]
  ds_read_b64_tr_b16 a[226:227], v19 offset:41568
  v_mfma_f32_16x16x32_bf16 v[76:79], a[236:239], a[220:223], v[76:79]
  ds_read_b64_tr_b16 a[228:229], v19 offset:46176
  buffer_load_dwordx4 a[40:43], v26, s[24:27], s47 offen offset:1024 sc1
  v_mfma_f32_16x16x32_bf16 v[76:79], a[232:235], a[212:215], v[76:79]
  ds_read_b64_tr_b16 a[230:231], v19 offset:50784
  s_waitcnt lgkmcnt(4)
  v_mfma_f32_16x16x32_bf16 v[80:83], a[240:243], a[208:211], v[80:83]
  ds_read_b64_tr_b16 a[232:233], v19 offset:36992
  v_mfma_f32_16x16x32_bf16 v[80:83], a[244:247], a[216:219], v[80:83]
  ds_read_b64_tr_b16 a[234:235], v19 offset:41600
  v_mfma_f32_16x16x32_bf16 v[84:87], a[244:247], a[220:223], v[84:87]
  ds_read_b64_tr_b16 a[236:237], v19 offset:46208
  buffer_load_dwordx4 a[48:51], v26, s[24:27], s47 offen offset:2048 sc1
  v_mfma_f32_16x16x32_bf16 v[84:87], a[240:243], a[212:215], v[84:87]
  ds_read_b64_tr_b16 a[238:239], v19 offset:50816
  s_waitcnt lgkmcnt(4)
  v_mfma_f32_16x16x32_bf16 v[88:91], a[224:227], a[208:211], v[88:91]
  ds_read_b64_tr_b16 a[240:241], v19 offset:37024
  v_mfma_f32_16x16x32_bf16 v[88:91], a[228:231], a[216:219], v[88:91]
  ds_read_b64_tr_b16 a[242:243], v19 offset:41632
  v_mfma_f32_16x16x32_bf16 v[92:95], a[228:231], a[220:223], v[92:95]
  ds_read_b64_tr_b16 a[244:245], v19 offset:46240
  buffer_load_dwordx4 a[56:59], v26, s[24:27], s47 offen offset:3072 sc1
  v_mfma_f32_16x16x32_bf16 v[92:95], a[224:227], a[212:215], v[92:95]
  ds_read_b64_tr_b16 a[246:247], v19 offset:50848
  s_waitcnt lgkmcnt(4)
  v_mfma_f32_16x16x32_bf16 v[96:99], a[232:235], a[208:211], v[96:99]
  ds_read_b64_tr_b16 a[224:225], v19 offset:37056
  v_mfma_f32_16x16x32_bf16 v[96:99], a[236:239], a[216:219], v[96:99]
  ds_read_b64_tr_b16 a[226:227], v19 offset:41664
  s_add_u32 s47, s76, 20480
  v_mfma_f32_16x16x32_bf16 v[100:103], a[236:239], a[220:223], v[100:103]
  ds_read_b64_tr_b16 a[228:229], v19 offset:46272
  buffer_load_dwordx4 a[36:39], v26, s[24:27], s47 offen offset:0 sc1
  v_mfma_f32_16x16x32_bf16 v[100:103], a[232:235], a[212:215], v[100:103]
  ds_read_b64_tr_b16 a[230:231], v19 offset:50880
  s_waitcnt lgkmcnt(4)
  v_mfma_f32_16x16x32_bf16 v[104:107], a[240:243], a[208:211], v[104:107]
  ds_read_b64_tr_b16 a[232:233], v19 offset:37088
  v_mfma_f32_16x16x32_bf16 v[104:107], a[244:247], a[216:219], v[104:107]
  ds_read_b64_tr_b16 a[234:235], v19 offset:41696
  v_mfma_f32_16x16x32_bf16 v[108:111], a[244:247], a[220:223], v[108:111]
  ds_read_b64_tr_b16 a[236:237], v19 offset:46304
  buffer_load_dwordx4 a[44:47], v26, s[24:27], s47 offen offset:1024 sc1
  v_mfma_f32_16x16x32_bf16 v[108:111], a[240:243], a[212:215], v[108:111]
  ds_read_b64_tr_b16 a[238:239], v19 offset:50912
  s_waitcnt lgkmcnt(4)
  v_mfma_f32_16x16x32_bf16 v[112:115], a[224:227], a[208:211], v[112:115]
  ds_read_b64_tr_b16 a[240:241], v19 offset:37120
  v_mfma_f32_16x16x32_bf16 v[112:115], a[228:231], a[216:219], v[112:115]
  ds_read_b64_tr_b16 a[242:243], v19 offset:41728
  v_mfma_f32_16x16x32_bf16 v[116:119], a[228:231], a[220:223], v[116:119]
  ds_read_b64_tr_b16 a[244:245], v19 offset:46336
  buffer_load_dwordx4 a[52:55], v26, s[24:27], s47 offen offset:2048 sc1
  v_mfma_f32_16x16x32_bf16 v[116:119], a[224:227], a[212:215], v[116:119]
  ds_read_b64_tr_b16 a[246:247], v19 offset:50944
  s_waitcnt vmcnt(17) lgkmcnt(0)
  s_barrier
  s_waitcnt vmcnt(15)
  v_cmp_eq_u32 vcc, v255, v253
  s_nop 3
  s_and_b32 s62, vcc_lo, 0xff
  s_cmp_eq_u32 s62, 0xff
  s_cbranch_scc1 L_ven4
  s_mov_b32 s64, 0
  s_add_u32 s51, s66, 12288
L_poll5:
  s_load_dword s4, s[52:53], s51 offset:0 glc
  s_load_dword s5, s[52:53], s51 offset:128 glc
  s_load_dword s6, s[52:53], s51 offset:256 glc
  s_load_dword s7, s[52:53], s51 offset:384 glc
  s_load_dword s8, s[52:53], s51 offset:512 glc
  s_load_dword s9, s[52:53], s51 offset:640 glc
  s_load_dword s10, s[52:53], s51 offset:768 glc
  s_load_dword s11, s[52:53], s51 offset:896 glc
  s_add_u32 s64, s64, 1
  s_cmp_gt_u32 s64, 20000
  s_cbranch_scc1 L_poll5_ok
  s_waitcnt lgkmcnt(0)
  s_cmp_eq_u64 s[4:5], s[14:15]
  s_cbranch_scc0 L_poll5
  s_cmp_eq_u64 s[6:7], s[14:15]
  s_cbranch_scc0 L_poll5
  s_cmp_eq_u64 s[8:9], s[14:15]
  s_cbranch_scc0 L_poll5
  s_cmp_eq_u64 s[10:11], s[14:15]
  s_cbranch_scc0 L_poll5
L_poll5_ok:
  s_waitcnt lgkmcnt(0)
L_ven4:
  v_mfma_f32_16x16x32_bf16 v[120:123], a[232:235], a[208:211], v[120:123]
  ds_read_b64_tr_b16 a[224:225], v18 offset:32768
  v_mfma_f32_16x16x32_bf16 v[120:123], a[236:239], a[216:219], v[120:123]
  ds_read_b64_tr_b16 a[226:227], v18 offset:37376
  v_mfma_f32_16x16x32_bf16 v[124:127], a[236:239], a[220:223], v[124:127]
  ds_read_b64_tr_b16 a[228:229], v18 offset:41984
  buffer_load_dwordx4 a[60:63], v26, s[24:27], s47 offen offset:3072 sc1
  v_mfma_f32_16x16x32_bf16 v[124:127], a[232:235], a[212:215], v[124:127]
  ds_read_b64_tr_b16 a[230:231], v18 offset:46592
  s_lshl_b32 s62, s3, 7
  s_add_u32 s62, s62, L_p2b-standalone__glu_gated_geglu__prompt_kernel
  s_min_u32 s62, s62, L_end-standalone__glu_gated_geglu__prompt_kernel
  s_add_u32 s62, s62, s100
  v_mfma_f32_16x16x32_bf16 v[128:131], a[240:243], a[208:211], v[128:131]
  ds_read_b64_tr_b16 a[232:233], v18 offset:32800
  s_addc_u32 s63, s101, 0
  v_mov_b32 v46, s62
  v_mov_b32 v47, s63
  v_mfma_f32_16x16x32_bf16 v[128:131], a[244:247], a[216:219], v[128:131]
  ds_read_b64_tr_b16 a[234:235], v18 offset:37408
  global_load_dword v252, v[46:47], off
  v_mfma_f32_16x16x32_bf16 v[132:135], a[244:247], a[220:223], v[132:135]
  ds_read_b64_tr_b16 a[236:237], v18 offset:42016
  v_mfma_f32_16x16x32_bf16 v[132:135], a[240:243], a[212:215], v[132:135]
  ds_read_b64_tr_b16 a[238:239], v18 offset:46624
  s_waitcnt lgkmcnt(4)
  v_mfma_f32_16x16x32_bf16 v[64:67], a[224:227], a[0:3], v[64:67]
  ds_read_b64_tr_b16 a[240:241], v18 offset:32832
  v_mfma_f32_16x16x32_bf16 v[64:67], a[228:231], a[8:11], v[64:67]
  ds_read_b64_tr_b16 a[242:243], v18 offset:37440
  s_add_u32 s45, s78, 774144
  s_add_u32 m0, s80, 83968
  v_mfma_f32_16x16x32_bf16 v[68:71], a[228:231], a[12:15], v[68:71]
  ds_read_b64_tr_b16 a[244:245], v18 offset:42048
  buffer_load_dwordx4 v1, s[68:71], s45 offen offset:0 lds
  v_mfma_f32_16x16x32_bf16 v[68:71], a[224:227], a[4:7], v[68:71]
  ds_read_b64_tr_b16 a[246:247], v18 offset:46656
  s_waitcnt lgkmcnt(4)
  v_mfma_f32_16x16x32_bf16 v[72:75], a[232:235], a[0:3], v[72:75]
  ds_read_b64_tr_b16 a[224:225], v18 offset:32864
  v_mfma_f32_16x16x32_bf16 v[72:75], a[236:239], a[8:11], v[72:75]
  ds_read_b64_tr_b16 a[226:227], v18 offset:37472
  v_mfma_f32_16x16x32_bf16 v[76:79], a[236:239], a[12:15], v[76:79]
  ds_read_b64_tr_b16 a[228:229], v18 offset:42080
  buffer_load_dwordx4 v2, s[68:71], s45 offen offset:1024 lds
  v_mfma_f32_16x16x32_bf16 v[76:79], a[232:235], a[4:7], v[76:79]
  ds_read_b64_tr_b16 a[230:231], v18 offset:46688
  s_waitcnt lgkmcnt(4)
  v_mfma_f32_16x16x32_bf16 v[80:83], a[240:243], a[0:3], v[80:83]
  ds_read_b64_tr_b16 a[232:233], v18 offset:32896
  v_mfma_f32_16x16x32_bf16 v[80:83], a[244:247], a[8:11], v[80:83]
  ds_read_b64_tr_b16 a[234:235], v18 offset:37504
  v_mfma_f32_16x16x32_bf16 v[84:87], a[244:247], a[12:15], v[84:87]
  ds_read_b64_tr_b16 a[236:237], v18 offset:42112
  buffer_load_dwordx4 v3, s[68:71], s45 offen offset:2048 lds
  v_mfma_f32_16x16x32_bf16 v[84:87], a[240:243], a[4:7], v[84:87]
  ds_read_b64_tr_b16 a[238:239], v18 offset:46720
  s_waitcnt lgkmcnt(4)
  v_mfma_f32_16x16x32_bf16 v[88:91], a[224:227], a[0:3], v[88:91]
  ds_read_b64_tr_b16 a[240:241], v18 offset:32928
  v_mfma_f32_16x16x32_bf16 v[88:91], a[228:231], a[8:11], v[88:91]
  ds_read_b64_tr_b16 a[242:243], v18 offset:37536
  v_mfma_f32_16x16x32_bf16 v[92:95], a[228:231], a[12:15], v[92:95]
  ds_read_b64_tr_b16 a[244:245], v18 offset:42144
  buffer_load_dwordx4 v4, s[68:71], s45 offen offset:3072 lds
  v_mfma_f32_16x16x32_bf16 v[92:95], a[224:227], a[4:7], v[92:95]
  ds_read_b64_tr_b16 a[246:247], v18 offset:46752
  s_waitcnt lgkmcnt(4)
  v_mfma_f32_16x16x32_bf16 v[96:99], a[232:235], a[0:3], v[96:99]
  ds_read_b64_tr_b16 a[224:225], v18 offset:32960
  v_mfma_f32_16x16x32_bf16 v[96:99], a[236:239], a[8:11], v[96:99]
  ds_read_b64_tr_b16 a[226:227], v18 offset:37568
  s_add_u32 m0, s80, 88064
  v_mfma_f32_16x16x32_bf16 v[100:103], a[236:239], a[12:15], v[100:103]
  ds_read_b64_tr_b16 a[228:229], v18 offset:42176
  buffer_load_dwordx4 v5, s[68:71], s45 offen offset:0 lds
  v_mfma_f32_16x16x32_bf16 v[100:103], a[232:235], a[4:7], v[100:103]
  ds_read_b64_tr_b16 a[230:231], v18 offset:46784
  s_waitcnt lgkmcnt(4)
  v_mfma_f32_16x16x32_bf16 v[104:107], a[240:243], a[0:3], v[104:107]
  ds_read_b64_tr_b16 a[232:233], v18 offset:32992
  v_mfma_f32_16x16x32_bf16 v[104:107], a[244:247], a[8:11], v[104:107]
  ds_read_b64_tr_b16 a[234:235], v18 offset:37600
  v_mfma_f32_16x16x32_bf16 v[108:111], a[244:247], a[12:15], v[108:111]
  ds_read_b64_tr_b16 a[236:237], v18 offset:42208
  buffer_load_dwordx4 v6, s[68:71], s45 offen offset:1024 lds
  v_mfma_f32_16x16x32_bf16 v[108:111], a[240:243], a[4:7], v[108:111]
  ds_read_b64_tr_b16 a[238:239], v18 offset:46816
  s_waitcnt lgkmcnt(4)
  v_mfma_f32_16x16x32_bf16 v[112:115], a[224:227], a[0:3], v[112:115]
  ds_read_b64_tr_b16 a[240:241], v18 offset:33024
  v_mfma_f32_16x16x32_bf16 v[112:115], a[228:231], a[8:11], v[112:115]
  ds_read_b64_tr_b16 a[242:243], v18 offset:37632
  v_mfma_f32_16x16x32_bf16 v[116:119], a[228:231], a[12:15], v[116:119]
  ds_read_b64_tr_b16 a[244:245], v18 offset:42240
  buffer_load_dwordx4 v7, s[68:71], s45 offen offset:2048 lds
  v_mfma_f32_16x16x32_bf16 v[116:119], a[224:227], a[4:7], v[116:119]
  ds_read_b64_tr_b16 a[246:247], v18 offset:46848
  s_waitcnt lgkmcnt(4)
  v_mfma_f32_16x16x32_bf16 v[120:123], a[232:235], a[0:3], v[120:123]
  ds_read_b64_tr_b16 a[224:225], v18 offset:51200
  v_mfma_f32_16x16x32_bf16 v[120:123], a[236:239], a[8:11], v[120:123]
  ds_read_b64_tr_b16 a[226:227], v18 offset:55808
  v_mfma_f32_16x16x32_bf16 v[124:127], a[236:239], a[12:15], v[124:127]
  ds_read_b64_tr_b16 a[228:229], v19 offset:55296
  buffer_load_dwordx4 v8, s[68:71], s45 offen offset:3072 lds
  v_mfma_f32_16x16x32_bf16 v[124:127], a[232:235], a[4:7], v[124:127]
  ds_read_b64_tr_b16 a[230:231], v19 offset:59904
  s_waitcnt lgkmcnt(4)
  v_mfma_f32_16x16x32_bf16 v[128:131], a[240:243], a[0:3], v[128:131]
  ds_read_b64_tr_b16 a[232:233], v18 offset:51232
  v_mfma_f32_16x16x32_bf16 v[128:131], a[244:247], a[8:11], v[128:131]
  ds_read_b64_tr_b16 a[234:235], v18 offset:55840
  s_add_u32 m0, s80, 92160
  v_mfma_f32_16x16x32_bf16 v[132:135], a[244:247], a[12:15], v[132:135]
  ds_read_b64_tr_b16 a[236:237], v19 offset:55328
  buffer_load_dwordx4 v9, s[68:71], s45 offen offset:0 lds
  v_mfma_f32_16x16x32_bf16 v[132:135], a[240:243], a[4:7], v[132:135]
  ds_read_b64_tr_b16 a[238:239], v19 offset:59936
  s_waitcnt lgkmcnt(4)
  v_mfma_f32_16x16x32_bf16 v[64:67], a[224:227], a[16:19], v[64:67]
  ds_read_b64_tr_b16 a[240:241], v18 offset:51264
  v_mfma_f32_16x16x32_bf16 v[64:67], a[228:231], a[24:27], v[64:67]
  ds_read_b64_tr_b16 a[242:243], v18 offset:55872
  s_add_u32 s47, s46, 24576
  v_mfma_f32_16x16x32_bf16 v[68:71], a[228:231], a[28:31], v[68:71]
  ds_read_b64_tr_b16 a[244:245], v19 offset:55360
  buffer_load_dwordx4 a[64:67], v26, s[24:27], s47 offen offset:0 sc1
  v_mfma_f32_16x16x32_bf16 v[68:71], a[224:227], a[20:23], v[68:71]
  ds_read_b64_tr_b16 a[246:247], v19 offset:59968
  s_waitcnt lgkmcnt(4)
  v_mfma_f32_16x16x32_bf16 v[72:75], a[232:235], a[16:19], v[72:75]
  ds_read_b64_tr_b16 a[224:225], v18 offset:51296
  v_mfma_f32_16x16x32_bf16 v[72:75], a[236:239], a[24:27], v[72:75]
  ds_read_b64_tr_b16 a[226:227], v18 offset:55904
  v_mfma_f32_16x16x32_bf16 v[76:79], a[236:239], a[28:31], v[76:79]
  ds_read_b64_tr_b16 a[228:229], v19 offset:55392
  buffer_load_dwordx4 a[72:75], v26, s[24:27], s47 offen offset:1024 sc1
  v_mfma_f32_16x16x32_bf16 v[76:79], a[232:235], a[20:23], v[76:79]
  ds_read_b64_tr_b16 a[230:231], v19 offset:60000
  s_waitcnt lgkmcnt(4)
  v_mfma_f32_16x16x32_bf16 v[80:83], a[240:243], a[16:19], v[80:83]
  ds_read_b64_tr_b16 a[232:233], v18 offset:51328
  v_mfma_f32_16x16x32_bf16 v[80:83], a[244:247], a[24:27], v[80:83]
  ds_read_b64_tr_b16 a[234:235], v18 offset:55936
  v_mfma_f32_16x16x32_bf16 v[84:87], a[244:247], a[28:31], v[84:87]
  ds_read_b64_tr_b16 a[236:237], v19 offset:55424
  buffer_load_dwordx4 a[80:83], v26, s[24:27], s47 offen offset:2048 sc1
  v_mfma_f32_16x16x32_bf16 v[84:87], a[240:243], a[20:23], v[84:87]
  ds_read_b64_tr_b16 a[238:239], v19 offset:60032
  s_waitcnt lgkmcnt(4)
  v_mfma_f32_16x16x32_bf16 v[88:91], a[224:227], a[16:19], v[88:91]
  ds_read_b64_tr_b16 a[240:241], v18 offset:51360
  v_mfma_f32_16x16x32_bf16 v[88:91], a[228:231], a[24:27], v[88:91]
  ds_read_b64_tr_b16 a[242:243], v18 offset:55968
  v_mfma_f32_16x16x32_bf16 v[92:95], a[228:231], a[28:31], v[92:95]
  ds_read_b64_tr_b16 a[244:245], v19 offset:55456
  buffer_load_dwordx4 a[88:91], v26, s[24:27], s47 offen offset:3072 sc1
  v_mfma_f32_16x16x32_bf16 v[92:95], a[224:227], a[20:23], v[92:95]
  ds_read_b64_tr_b16 a[246:247], v19 offset:60064
  s_waitcnt lgkmcnt(4)
  v_mfma_f32_16x16x32_bf16 v[96:99], a[232:235], a[16:19], v[96:99]
  ds_read_b64_tr_b16 a[224:225], v18 offset:51392
  v_mfma_f32_16x16x32_bf16 v[96:99], a[236:239], a[24:27], v[96:99]
  ds_read_b64_tr_b16 a[226:227], v18 offset:56000
  s_add_u32 s47, s76, 24576
  v_mfma_f32_16x16x32_bf16 v[100:103], a[236:239], a[28:31], v[100:103]
  ds_read_b64_tr_b16 a[228:229], v19 offset:55488
  buffer_load_dwordx4 a[68:71], v26, s[24:27], s47 offen offset:0 sc1
  v_mfma_f32_16x16x32_bf16 v[100:103], a[232:235], a[20:23], v[100:103]
  ds_read_b64_tr_b16 a[230:231], v19 offset:60096
  s_waitcnt lgkmcnt(4)
  v_mfma_f32_16x16x32_bf16 v[104:107], a[240:243], a[16:19], v[104:107]
  ds_read_b64_tr_b16 a[232:233], v18 offset:51424
  v_mfma_f32_16x16x32_bf16 v[104:107], a[244:247], a[24:27], v[104:107]
  ds_read_b64_tr_b16 a[234:235], v18 offset:56032
  v_mfma_f32_16x16x32_bf16 v[108:111], a[244:247], a[28:31], v[108:111]
  ds_read_b64_tr_b16 a[236:237], v19 offset:55520
  buffer_load_dwordx4 a[76:79], v26, s[24:27], s47 offen offset:1024 sc1
  v_mfma_f32_16x16x32_bf16 v[108:111], a[240:243], a[20:23], v[108:111]
  ds_read_b64_tr_b16 a[238:239], v19 offset:60128
  s_waitcnt lgkmcnt(4)
  v_mfma_f32_16x16x32_bf16 v[112:115], a[224:227], a[16:19], v[112:115]
  ds_read_b64_tr_b16 a[240:241], v18 offset:51456
  v_mfma_f32_16x16x32_bf16 v[112:115], a[228:231], a[24:27], v[112:115]
  ds_read_b64_tr_b16 a[242:243], v18 offset:56064
  v_mfma_f32_16x16x32_bf16 v[116:119], a[228:231], a[28:31], v[116:119]
  ds_read_b64_tr_b16 a[244:245], v19 offset:55552
  buffer_load_dwordx4 a[84:87], v26, s[24:27], s47 offen offset:2048 sc1
  v_mfma_f32_16x16x32_bf16 v[116:119], a[224:227], a[20:23], v[116:119]
  ds_read_b64_tr_b16 a[246:247], v19 offset:60160
  s_waitcnt vmcnt(17) lgkmcnt(0)
  s_barrier
  v_mfma_f32_16x16x32_bf16 v[120:123], a[232:235], a[16:19], v[120:123]
  ds_read_b64_tr_b16 a[224:225], v19 offset:64512
  v_mfma_f32_16x16x32_bf16 v[120:123], a[236:239], a[24:27], v[120:123]
  ds_read_b64_tr_b16 a[226:227], v20 offset:3584
  v_mfma_f32_16x16x32_bf16 v[124:127], a[236:239], a[28:31], v[124:127]
  ds_read_b64_tr_b16 a[228:229], v20 offset:8192
  buffer_load_dwordx4 a[92:95], v26, s[24:27], s47 offen offset:3072 sc1
  v_mfma_f32_16x16x32_bf16 v[124:127], a[232:235], a[20:23], v[124:127]
  ds_read_b64_tr_b16 a[230:231], v20 offset:12800
  v_mfma_f32_16x16x32_bf16 v[128:131], a[240:243], a[16:19], v[128:131]
  ds_read_b64_tr_b16 a[232:233], v19 offset:64544
  v_mfma_f32_16x16x32_bf16 v[128:131], a[244:247], a[24:27], v[128:131]
  ds_read_b64_tr_b16 a[234:235], v20 offset:3616
  v_mfma_f32_16x16x32_bf16 v[132:135], a[244:247], a[28:31], v[132:135]
  ds_read_b64_tr_b16 a[236:237], v20 offset:8224
  v_mfma_f32_16x16x32_bf16 v[132:135], a[240:243], a[20:23], v[132:135]
  ds_read_b64_tr_b16 a[238:239], v20 offset:12832
  s_waitcnt lgkmcnt(4)
  v_mfma_f32_16x16x32_bf16 v[64:67], a[224:227], a[32:35], v[64:67]
  ds_read_b64_tr_b16 a[240:241], v19 offset:64576
  v_mfma_f32_16x16x32_bf16 v[64:67], a[228:231], a[40:43], v[64:67]
  ds_read_b64_tr_b16 a[242:243], v20 offset:3648
  s_mov_b32 s45, s79
  s_add_u32 m0, s92, 0
  v_mfma_f32_16x16x32_bf16 v[68:71], a[228:231], a[44:47], v[68:71]
  ds_read_b64_tr_b16 a[244:245], v20 offset:8256
  buffer_load_dwordx4 v1, s[68:71], s45 offen offset:0 lds
  v_mfma_f32_16x16x32_bf16 v[68:71], a[224:227], a[36:39], v[68:71]
  ds_read_b64_tr_b16 a[246:247], v20 offset:12864
  s_waitcnt lgkmcnt(4)
  s_lshl_b32 s58, s33, 3
  v_mfma_f32_16x16x32_bf16 v[72:75], a[232:235], a[32:35], v[72:75]
  ds_read_b64_tr_b16 a[224:225], v19 offset:64608
  buffer_load_dwordx4 v2, s[68:71], s45 offen offset:1024 lds
  v_mfma_f32_16x16x32_bf16 v[72:75], a[236:239], a[40:43], v[72:75]
  ds_read_b64_tr_b16 a[226:227], v20 offset:3680
  v_mfma_f32_16x16x32_bf16 v[76:79], a[236:239], a[44:47], v[76:79]
  ds_read_b64_tr_b16 a[228:229], v20 offset:8288
  v_mfma_f32_16x16x32_bf16 v[76:79], a[232:235], a[36:39], v[76:79]
  ds_read_b64_tr_b16 a[230:231], v20 offset:12896
  s_waitcnt lgkmcnt(4)
  s_add_u32 s58, s58, s31
  buffer_load_dwordx4 v3, s[68:71], s45 offen offset:2048 lds
  v_mfma_f32_16x16x32_bf16 v[80:83], a[240:243], a[32:35], v[80:83]
  ds_read_b64_tr_b16 a[232:233], v19 offset:64640
  v_mfma_f32_16x16x32_bf16 v[80:83], a[244:247], a[40:43], v[80:83]
  ds_read_b64_tr_b16 a[234:235], v20 offset:3712
  v_mfma_f32_16x16x32_bf16 v[84:87], a[244:247], a[44:47], v[84:87]
  ds_read_b64_tr_b16 a[236:237], v20 offset:8320
  buffer_load_dwordx4 v4, s[68:71], s45 offen offset:3072 lds
  v_mfma_f32_16x16x32_bf16 v[84:87], a[240:243], a[36:39], v[84:87]
  ds_read_b64_tr_b16 a[238:239], v20 offset:12928
  s_waitcnt lgkmcnt(4)
  s_lshl_b32 s59, s58, 4
  v_mfma_f32_16x16x32_bf16 v[88:91], a[224:227], a[32:35], v[88:91]
  ds_read_b64_tr_b16 a[240:241], v19 offset:64672
  s_add_u32 m0, s92, 4096
  v_mfma_f32_16x16x32_bf16 v[88:91], a[228:231], a[40:43], v[88:91]
  ds_read_b64_tr_b16 a[242:243], v20 offset:3744
  buffer_load_dwordx4 v5, s[68:71], s45 offen offset:0 lds
  v_mfma_f32_16x16x32_bf16 v[92:95], a[228:231], a[44:47], v[92:95]
  ds_read_b64_tr_b16 a[244:245], v20 offset:8352
  v_mfma_f32_16x16x32_bf16 v[92:95], a[224:227], a[36:39], v[92:95]
  ds_read_b64_tr_b16 a[246:247], v20 offset:12960
  s_waitcnt lgkmcnt(4)
  s_add_u32 s59, s59, s32
  v_mfma_f32_16x16x32_bf16 v[96:99], a[232:235], a[32:35], v[96:99]
  ds_read_b64_tr_b16 a[224:225], v19 offset:64704
  buffer_load_dwordx4 v6, s[68:71], s45 offen offset:1024 lds
  v_mfma_f32_16x16x32_bf16 v[96:99], a[236:239], a[40:43], v[96:99]
  ds_read_b64_tr_b16 a[226:227], v20 offset:3776
  v_mfma_f32_16x16x32_bf16 v[100:103], a[236:239], a[44:47], v[100:103]
  ds_read_b64_tr_b16 a[228:229], v20 offset:8384
  v_mfma_f32_16x16x32_bf16 v[100:103], a[232:235], a[36:39], v[100:103]
  ds_read_b64_tr_b16 a[230:231], v20 offset:12992
  s_waitcnt lgkmcnt(4)
  s_lshl_b32 s59, s59, 2
  buffer_load_dwordx4 v7, s[68:71], s45 offen offset:2048 lds
  v_mfma_f32_16x16x32_bf16 v[104:107], a[240:243], a[32:35], v[104:107]
  ds_read_b64_tr_b16 a[232:233], v20 offset:17408
  v_mfma_f32_16x16x32_bf16 v[104:107], a[244:247], a[40:43], v[104:107]
  ds_read_b64_tr_b16 a[234:235], v20 offset:22016
  v_mfma_f32_16x16x32_bf16 v[108:111], a[244:247], a[44:47], v[108:111]
  ds_read_b64_tr_b16 a[236:237], v19 offset:0
  buffer_load_dwordx4 v8, s[68:71], s45 offen offset:3072 lds
  v_mfma_f32_16x16x32_bf16 v[108:111], a[240:243], a[36:39], v[108:111]
  ds_read_b64_tr_b16 a[238:239], v19 offset:4608
  s_waitcnt lgkmcnt(4)
  s_add_u32 s59, s59, s28
  v_mfma_f32_16x16x32_bf16 v[112:115], a[224:227], a[32:35], v[112:115]
  ds_read_b64_tr_b16 a[240:241], v20 offset:17440
  s_add_u32 m0, s92, 8192
  v_mfma_f32_16x16x32_bf16 v[112:115], a[228:231], a[40:43], v[112:115]
  ds_read_b64_tr_b16 a[242:243], v20 offset:22048
  buffer_load_dwordx4 v9, s[68:71], s45 offen offset:0 lds
  v_mfma_f32_16x16x32_bf16 v[116:119], a[228:231], a[44:47], v[116:119]
  ds_read_b64_tr_b16 a[244:245], v19 offset:32
  v_mfma_f32_16x16x32_bf16 v[116:119], a[224:227], a[36:39], v[116:119]
  ds_read_b64_tr_b16 a[246:247], v19 offset:4640
  s_waitcnt lgkmcnt(4)
  s_mul_i32 s59, s59, 3072
  s_add_u32 s47, s46, 28672
  v_mfma_f32_16x16x32_bf16 v[64:67], a[232:235], a[48:51], v[64:67]
  ds_read_b64_tr_b16 a[224:225], v20 offset:17472
  buffer_load_dwordx4 a[96:99], v26, s[24:27], s47 offen offset:0 sc1
  v_mfma_f32_16x16x32_bf16 v[64:67], a[236:239], a[56:59], v[64:67]
  ds_read_b64_tr_b16 a[226:227], v20 offset:22080
  v_mfma_f32_16x16x32_bf16 v[68:71], a[236:239], a[60:63], v[68:71]
  ds_read_b64_tr_b16 a[228:229], v19 offset:64
  v_mfma_f32_16x16x32_bf16 v[68:71], a[232:235], a[52:55], v[68:71]
  ds_read_b64_tr_b16 a[230:231], v19 offset:4672
  s_waitcnt lgkmcnt(4)
  s_add_u32 s59, s59, 20971520
  buffer_load_dwordx4 a[104:107], v26, s[24:27], s47 offen offset:1024 sc1
  v_mfma_f32_16x16x32_bf16 v[72:75], a[240:243], a[48:51], v[72:75]
  ds_read_b64_tr_b16 a[232:233], v20 offset:17504
  v_mfma_f32_16x16x32_bf16 v[72:75], a[244:247], a[56:59], v[72:75]
  ds_read_b64_tr_b16 a[234:235], v20 offset:22112
  v_mfma_f32_16x16x32_bf16 v[76:79], a[244:247], a[60:63], v[76:79]
  ds_read_b64_tr_b16 a[236:237], v19 offset:96
  buffer_load_dwordx4 a[112:115], v26, s[24:27], s47 offen offset:2048 sc1
  v_mfma_f32_16x16x32_bf16 v[76:79], a[240:243], a[52:55], v[76:79]
  ds_read_b64_tr_b16 a[238:239], v19 offset:4704
  s_waitcnt lgkmcnt(4)
  v_mfma_f32_16x16x32_bf16 v[80:83], a[224:227], a[48:51], v[80:83]
  ds_read_b64_tr_b16 a[240:241], v20 offset:17536
  v_mfma_f32_16x16x32_bf16 v[80:83], a[228:231], a[56:59], v[80:83]
  ds_read_b64_tr_b16 a[242:243], v20 offset:22144
  buffer_load_dwordx4 a[120:123], v26, s[24:27], s47 offen offset:3072 sc1
  v_mfma_f32_16x16x32_bf16 v[84:87], a[228:231], a[60:63], v[84:87]
  ds_read_b64_tr_b16 a[244:245], v19 offset:128
  v_mfma_f32_16x16x32_bf16 v[84:87], a[224:227], a[52:55], v[84:87]
  ds_read_b64_tr_b16 a[246:247], v19 offset:4736
  s_waitcnt lgkmcnt(4)
  s_add_u32 s47, s76, 28672
  v_mfma_f32_16x16x32_bf16 v[88:91], a[232:235], a[48:51], v[88:91]
  ds_read_b64_tr_b16 a[224:225], v20 offset:17568
  buffer_load_dwordx4 a[100:103], v26, s[24:27], s47 offen offset:0 sc1
  v_mfma_f32_16x16x32_bf16 v[88:91], a[236:239], a[56:59], v[88:91]
  ds_read_b64_tr_b16 a[226:227], v20 offset:22176
  v_mfma_f32_16x16x32_bf16 v[92:95], a[236:239], a[60:63], v[92:95]
  ds_read_b64_tr_b16 a[228:229], v19 offset:160
  v_mfma_f32_16x16x32_bf16 v[92:95], a[232:235], a[52:55], v[92:95]
  ds_read_b64_tr_b16 a[230:231], v19 offset:4768
  s_waitcnt lgkmcnt(4)
  buffer_load_dwordx4 a[108:111], v26, s[24:27], s47 offen offset:1024 sc1
  v_mfma_f32_16x16x32_bf16 v[96:99], a[240:243], a[48:51], v[96:99]
  ds_read_b64_tr_b16 a[232:233], v20 offset:17600
  v_mfma_f32_16x16x32_bf16 v[96:99], a[244:247], a[56:59], v[96:99]
  ds_read_b64_tr_b16 a[234:235], v20 offset:22208
  v_mfma_f32_16x16x32_bf16 v[100:103], a[244:247], a[60:63], v[100:103]
  ds_read_b64_tr_b16 a[236:237], v19 offset:192
  buffer_load_dwordx4 a[116:119], v26, s[24:27], s47 offen offset:2048 sc1
  v_mfma_f32_16x16x32_bf16 v[100:103], a[240:243], a[52:55], v[100:103]
  ds_read_b64_tr_b16 a[238:239], v19 offset:4800
  s_waitcnt vmcnt(16) lgkmcnt(0)
  s_barrier
  v_mfma_f32_16x16x32_bf16 v[104:107], a[224:227], a[48:51], v[104:107]
  ds_read_b64_tr_b16 a[240:241], v18 offset:0
  v_mfma_f32_16x16x32_bf16 v[104:107], a[228:231], a[56:59], v[104:107]
  ds_read_b64_tr_b16 a[242:243], v18 offset:4608
  buffer_load_dwordx4 a[124:127], v26, s[24:27], s47 offen offset:3072 sc1
  v_mfma_f32_16x16x32_bf16 v[108:111], a[228:231], a[60:63], v[108:111]
  ds_read_b64_tr_b16 a[244:245], v18 offset:9216
  v_mfma_f32_16x16x32_bf16 v[108:111], a[224:227], a[52:55], v[108:111]
  ds_read_b64_tr_b16 a[246:247], v18 offset:13824
  v_mfma_f32_16x16x32_bf16 v[112:115], a[232:235], a[48:51], v[112:115]
  ds_read_b64_tr_b16 a[224:225], v18 offset:32
  v_mfma_f32_16x16x32_bf16 v[112:115], a[236:239], a[56:59], v[112:115]
  ds_read_b64_tr_b16 a[226:227], v18 offset:4640
  v_mfma_f32_16x16x32_bf16 v[116:119], a[236:239], a[60:63], v[116:119]
  ds_read_b64_tr_b16 a[228:229], v18 offset:9248
  v_mfma_f32_16x16x32_bf16 v[116:119], a[232:235], a[52:55], v[116:119]
  ds_read_b64_tr_b16 a[230:231], v18 offset:13856
  s_waitcnt lgkmcnt(4)
  v_mfma_f32_16x16x32_bf16 v[64:67], a[240:243], a[64:67], v[64:67]
  ds_read_b64_tr_b16 a[232:233], v18 offset:64
  v_mfma_f32_16x16x32_bf16 v[64:67], a[244:247], a[72:75], v[64:67]
  ds_read_b64_tr_b16 a[234:235], v18 offset:4672
  s_add_u32 s47, s46, 32768
  v_mfma_f32_16x16x32_bf16 v[68:71], a[244:247], a[76:79], v[68:71]
  ds_read_b64_tr_b16 a[236:237], v18 offset:9280
  buffer_load_dwordx2 a[128:129], v27, s[24:27], s47 offen offset:0 sc1
  v_mfma_f32_16x16x32_bf16 v[68:71], a[240:243], a[68:71], v[68:71]
  ds_read_b64_tr_b16 a[238:239], v18 offset:13888
  s_waitcnt lgkmcnt(4)
  v_mfma_f32_16x16x32_bf16 v[72:75], a[224:227], a[64:67], v[72:75]
  ds_read_b64_tr_b16 a[240:241], v18 offset:96
  buffer_load_dwordx2 a[130:131], v27, s[24:27], s47 offen offset:512 sc1
  v_mfma_f32_16x16x32_bf16 v[72:75], a[228:231], a[72:75], v[72:75]
  ds_read_b64_tr_b16 a[242:243], v18 offset:4704
  v_mfma_f32_16x16x32_bf16 v[76:79], a[228:231], a[76:79], v[76:79]
  ds_read_b64_tr_b16 a[244:245], v18 offset:9312
  buffer_load_dwordx2 a[136:137], v27, s[24:27], s47 offen offset:1024 sc1
  v_mfma_f32_16x16x32_bf16 v[76:79], a[224:227], a[68:71], v[76:79]
  ds_read_b64_tr_b16 a[246:247], v18 offset:13920
  s_waitcnt lgkmcnt(4)
  v_mfma_f32_16x16x32_bf16 v[80:83], a[232:235], a[64:67], v[80:83]
  ds_read_b64_tr_b16 a[224:225], v18 offset:128
  v_mfma_f32_16x16x32_bf16 v[80:83], a[236:239], a[72:75], v[80:83]
  ds_read_b64_tr_b16 a[226:227], v18 offset:4736
  buffer_load_dwordx2 a[138:139], v27, s[24:27], s47 offen offset:1536 sc1
  v_mfma_f32_16x16x32_bf16 v[84:87], a[236:239], a[76:79], v[84:87]
  ds_read_b64_tr_b16 a[228:229], v18 offset:9344
  v_mfma_f32_16x16x32_bf16 v[84:87], a[232:235], a[68:71], v[84:87]
  ds_read_b64_tr_b16 a[230:231], v18 offset:13952
  s_waitcnt lgkmcnt(4)
  buffer_load_dwordx2 a[144:145], v27, s[24:27], s47 offen offset:2048 sc1
  v_mfma_f32_16x16x32_bf16 v[88:91], a[240:243], a[64:67], v[88:91]
  ds_read_b64_tr_b16 a[232:233], v18 offset:160
  v_mfma_f32_16x16x32_bf16 v[88:91], a[244:247], a[72:75], v[88:91]
  ds_read_b64_tr_b16 a[234:235], v18 offset:4768
  buffer_load_dwordx2 a[146:147], v27, s[24:27], s47 offen offset:2560 sc1
  v_mfma_f32_16x16x32_bf16 v[92:95], a[244:247], a[76:79], v[92:95]
  ds_read_b64_tr_b16 a[236:237], v18 offset:9376
  v_mfma_f32_16x16x32_bf16 v[92:95], a[240:243], a[68:71], v[92:95]
  ds_read_b64_tr_b16 a[238:239], v18 offset:13984
  s_waitcnt lgkmcnt(4)
  v_mfma_f32_16x16x32_bf16 v[96:99], a[224:227], a[64:67], v[96:99]
  ds_read_b64_tr_b16 a[240:241], v18 offset:192
  buffer_load_dwordx2 a[152:153], v27, s[24:27], s47 offen offset:3072 sc1
  v_mfma_f32_16x16x32_bf16 v[96:99], a[228:231], a[72:75], v[96:99]
  ds_read_b64_tr_b16 a[242:243], v18 offset:4800
  v_mfma_f32_16x16x32_bf16 v[100:103], a[228:231], a[76:79], v[100:103]
  ds_read_b64_tr_b16 a[244:245], v18 offset:9408
  buffer_load_dwordx2 a[154:155], v27, s[24:27], s47 offen offset:3584 sc1
  v_mfma_f32_16x16x32_bf16 v[100:103], a[224:227], a[68:71], v[100:103]
  ds_read_b64_tr_b16 a[246:247], v18 offset:14016
  s_waitcnt lgkmcnt(4)
  v_mfma_f32_16x16x32_bf16 v[104:107], a[232:235], a[64:67], v[104:107]
  ds_read_b64_tr_b16 a[224:225], v18 offset:18432
  s_add_u32 s47, s76, 32768
  v_mfma_f32_16x16x32_bf16 v[104:107], a[236:239], a[72:75], v[104:107]
  ds_read_b64_tr_b16 a[226:227], v18 offset:23040
  buffer_load_dwordx2 a[132:133], v27, s[24:27], s47 offen offset:0 sc1
  v_mfma_f32_16x16x32_bf16 v[108:111], a[236:239], a[76:79], v[108:111]
  ds_read_b64_tr_b16 a[228:229], v19 offset:9216
  v_mfma_f32_16x16x32_bf16 v[108:111], a[232:235], a[68:71], v[108:111]
  ds_read_b64_tr_b16 a[230:231], v19 offset:13824
  s_waitcnt lgkmcnt(4)
  buffer_load_dwordx2 a[134:135], v27, s[24:27], s47 offen offset:512 sc1
  v_mfma_f32_16x16x32_bf16 v[112:115], a[240:243], a[64:67], v[112:115]
  ds_read_b64_tr_b16 a[232:233], v18 offset:18464
  v_mfma_f32_16x16x32_bf16 v[112:115], a[244:247], a[72:75], v[112:115]
  ds_read_b64_tr_b16 a[234:235], v18 offset:23072
  buffer_load_dwordx2 a[140:141], v27, s[24:27], s47 offen offset:1024 sc1
  v_mfma_f32_16x16x32_bf16 v[116:119], a[244:247], a[76:79], v[116:119]
  ds_read_b64_tr_b16 a[236:237], v19 offset:9248
  v_mfma_f32_16x16x32_bf16 v[116:119], a[240:243], a[68:71], v[116:119]
  ds_read_b64_tr_b16 a[238:239], v19 offset:13856
  s_waitcnt lgkmcnt(4)
  v_mfma_f32_16x16x32_bf16 v[64:67], a[224:227], a[80:83], v[64:67]
  ds_read_b64_tr_b16 a[240:241], v18 offset:18496
  buffer_load_dwordx2 a[142:143], v27, s[24:27], s47 offen offset:1536 sc1
  v_mfma_f32_16x16x32_bf16 v[64:67], a[228:231], a[88:91], v[64:67]
  ds_read_b64_tr_b16 a[242:243], v18 offset:23104
  v_mfma_f32_16x16x32_bf16 v[68:71], a[228:231], a[92:95], v[68:71]
  ds_read_b64_tr_b16 a[244:245], v19 offset:9280
  buffer_load_dwordx2 a[148:149], v27, s[24:27], s47 offen offset:2048 sc1
  v_mfma_f32_16x16x32_bf16 v[68:71], a[224:227], a[84:87], v[68:71]
  ds_read_b64_tr_b16 a[246:247], v19 offset:13888
  s_waitcnt lgkmcnt(4)
  v_mfma_f32_16x16x32_bf16 v[72:75], a[232:235], a[80:83], v[72:75]
  ds_read_b64_tr_b16 a[224:225], v18 offset:18528
  buffer_load_dwordx2 a[150:151], v27, s[24:27], s47 offen offset:2560 sc1
  v_mfma_f32_16x16x32_bf16 v[72:75], a[236:239], a[88:91], v[72:75]
  ds_read_b64_tr_b16 a[226:227], v18 offset:23136
  v_mfma_f32_16x16x32_bf16 v[76:79], a[236:239], a[92:95], v[76:79]
  ds_read_b64_tr_b16 a[228:229], v19 offset:9312
  v_mfma_f32_16x16x32_bf16 v[76:79], a[232:235], a[84:87], v[76:79]
  ds_read_b64_tr_b16 a[230:231], v19 offset:13920
  s_waitcnt lgkmcnt(4)
  buffer_load_dwordx2 a[156:157], v27, s[24:27], s47 offen offset:3072 sc1
  v_mfma_f32_16x16x32_bf16 v[80:83], a[240:243], a[80:83], v[80:83]
  ds_read_b64_tr_b16 a[232:233], v18 offset:18560
  v_mfma_f32_16x16x32_bf16 v[80:83], a[244:247], a[88:91], v[80:83]
  ds_read_b64_tr_b16 a[234:235], v18 offset:23168
  buffer_load_dwordx2 a[158:159], v27, s[24:27], s47 offen offset:3584 sc1
  v_mfma_f32_16x16x32_bf16 v[84:87], a[244:247], a[92:95], v[84:87]
  ds_read_b64_tr_b16 a[236:237], v19 offset:9344
  v_mfma_f32_16x16x32_bf16 v[84:87], a[240:243], a[84:87], v[84:87]
  ds_read_b64_tr_b16 a[238:239], v19 offset:13952
  s_waitcnt lgkmcnt(4)
  v_mfma_f32_16x16x32_bf16 v[88:91], a[224:227], a[80:83], v[88:91]
  ds_read_b64_tr_b16 a[240:241], v18 offset:18592
  v_mfma_f32_16x16x32_bf16 v[88:91], a[228:231], a[88:91], v[88:91]
  ds_read_b64_tr_b16 a[242:243], v18 offset:23200
  v_mfma_f32_16x16x32_bf16 v[92:95], a[228:231], a[92:95], v[92:95]
  ds_read_b64_tr_b16 a[244:245], v19 offset:9376
  v_mfma_f32_16x16x32_bf16 v[92:95], a[224:227], a[84:87], v[92:95]
  ds_read_b64_tr_b16 a[246:247], v19 offset:13984
  s_waitcnt lgkmcnt(4)
  v_mfma_f32_16x16x32_bf16 v[96:99], a[232:235], a[80:83], v[96:99]
  ds_read_b64_tr_b16 a[224:225], v18 offset:18624
  v_mfma_f32_16x16x32_bf16 v[96:99], a[236:239], a[88:91], v[96:99]
  ds_read_b64_tr_b16 a[226:227], v18 offset:23232
  v_mfma_f32_16x16x32_bf16 v[100:103], a[236:239], a[92:95], v[100:103]
  ds_read_b64_tr_b16 a[228:229], v19 offset:9408
  v_mfma_f32_16x16x32_bf16 v[100:103], a[232:235], a[84:87], v[100:103]
  ds_read_b64_tr_b16 a[230:231], v19 offset:14016
  s_waitcnt vmcnt(16) lgkmcnt(0)
  s_barrier
  v_mfma_f32_16x16x32_bf16 v[104:107], a[240:243], a[80:83], v[104:107]
  ds_read_b64_tr_b16 a[160:161], v19 offset:18432
  ds_read_b64_tr_b16 a[162:163], v19 offset:23040
  v_mfma_f32_16x16x32_bf16 v[104:107], a[244:247], a[88:91], v[104:107]
  ds_read_b64_tr_b16 a[164:165], v19 offset:27648
  ds_read_b64_tr_b16 a[166:167], v19 offset:32256
  v_mfma_f32_16x16x32_bf16 v[108:111], a[244:247], a[92:95], v[108:111]
  ds_read_b64_tr_b16 a[168:169], v19 offset:36864
  ds_read_b64_tr_b16 a[170:171], v19 offset:41472
  v_mfma_f32_16x16x32_bf16 v[108:111], a[240:243], a[84:87], v[108:111]
  ds_read_b64_tr_b16 a[172:173], v19 offset:46080
  ds_read_b64_tr_b16 a[174:175], v19 offset:50688
  v_mfma_f32_16x16x32_bf16 v[112:115], a[224:227], a[80:83], v[112:115]
  ds_read_b64_tr_b16 a[176:177], v18 offset:32768
  ds_read_b64_tr_b16 a[178:179], v18 offset:37376
  v_mfma_f32_16x16x32_bf16 v[112:115], a[228:231], a[88:91], v[112:115]
  ds_read_b64_tr_b16 a[180:181], v18 offset:41984
  ds_read_b64_tr_b16 a[182:183], v18 offset:46592
  v_mfma_f32_16x16x32_bf16 v[116:119], a[228:231], a[92:95], v[116:119]
  ds_read_b64_tr_b16 a[184:185], v18 offset:51200
  ds_read_b64_tr_b16 a[186:187], v18 offset:55808
  v_mfma_f32_16x16x32_bf16 v[116:119], a[224:227], a[84:87], v[116:119]
  ds_read_b64_tr_b16 a[188:189], v19 offset:55296
  ds_read_b64_tr_b16 a[190:191], v19 offset:59904
L_p2b:
  s_waitcnt lgkmcnt(8)
  v_mfma_f32_16x16x32_bf16 v[64:67], a[160:163], a[96:99], v[64:67]
  ds_read_b64_tr_b16 a[192:193], v19 offset:18464
  v_mfma_f32_16x16x32_bf16 v[64:67], a[164:167], a[104:107], v[64:67]
  ds_read_b64_tr_b16 a[194:195], v19 offset:23072
  v_mfma_f32_16x16x32_bf16 v[64:67], a[168:171], a[112:115], v[64:67]
  ds_read_b64_tr_b16 a[196:197], v19 offset:27680
  v_mfma_f32_16x16x32_bf16 v[64:67], a[172:175], a[120:123], v[64:67]
  ds_read_b64_tr_b16 a[198:199], v19 offset:32288
  v_mfma_f32_16x16x32_bf16 v[68:71], a[172:175], a[124:127], v[68:71]
  ds_read_b64_tr_b16 a[200:201], v19 offset:36896
  s_add_u32 s62, s77, 0
  s_cmp_ge_u32 s62, 9
  s_cselect_b32 s63, 9, 0
  v_mfma_f32_16x16x32_bf16 v[68:71], a[168:171], a[116:119], v[68:71]
  ds_read_b64_tr_b16 a[202:203], v19 offset:41504
  s_sub_u32 s62, s62, s63
  s_lshr_b32 s63, s62, 1
  v_mfma_f32_16x16x32_bf16 v[68:71], a[164:167], a[108:111], v[68:71]
  ds_read_b64_tr_b16 a[204:205], v19 offset:46112
  s_min_u32 s63, s63, 3
  s_lshl_b32 s67, s63, 1
  v_mfma_f32_16x16x32_bf16 v[68:71], a[160:163], a[100:103], v[68:71]
  s_waitcnt vmcnt(0)
  ds_read_b64_tr_b16 a[206:207], v19 offset:50720
  s_waitcnt lgkmcnt(8)
  v_mfma_f32_16x16x32_bf16 v[64:67], a[176:179], a[128:131], v[64:67]
  ds_read_b64_tr_b16 a[160:161], v18 offset:32800
  v_mfma_f32_16x16x32_bf16 v[64:67], a[180:183], a[136:139], v[64:67]
  ds_read_b64_tr_b16 a[162:163], v18 offset:37408
  v_mfma_f32_16x16x32_bf16 v[64:67], a[184:187], a[144:147], v[64:67]
  ds_read_b64_tr_b16 a[164:165], v18 offset:42016
  v_mfma_f32_16x16x32_bf16 v[64:67], a[188:191], a[152:155], v[64:67]
  ds_read_b64_tr_b16 a[166:167], v18 offset:46624
  v_mfma_f32_16x16x32_bf16 v[68:71], a[188:191], a[156:159], v[68:71]
  ds_read_b64_tr_b16 a[168:169], v18 offset:51232
  s_sub_u32 s62, s62, s67
  s_mul_i32 s63, s63, 49152
  v_mfma_f32_16x16x32_bf16 v[68:71], a[184:187], a[148:151], v[68:71]
  ds_read_b64_tr_b16 a[170:171], v18 offset:55840
  s_lshl_b32 s62, s62, 10
  s_add_u32 s63, s63, s62
  v_mfma_f32_16x16x32_bf16 v[68:71], a[180:183], a[140:143], v[68:71]
  ds_read_b64_tr_b16 a[172:173], v19 offset:55328
  s_add_u32 s81, s63, s59
  v_mfma_f32_16x16x32_bf16 v[68:71], a[176:179], a[132:135], v[68:71]
  ds_read_b64_tr_b16 a[174:175], v19 offset:59936
  s_waitcnt lgkmcnt(8)
  v_mfma_f32_16x16x32_bf16 v[72:75], a[192:195], a[96:99], v[72:75]
  ds_read_b64_tr_b16 a[176:177], v19 offset:18496
  v_mfma_f32_16x16x32_bf16 v[72:75], a[196:199], a[104:107], v[72:75]
  ds_read_b64_tr_b16 a[178:179], v19 offset:23104
  v_mfma_f32_16x16x32_bf16 v[72:75], a[200:203], a[112:115], v[72:75]
  ds_read_b64_tr_b16 a[180:181], v19 offset:27712
  v_mfma_f32_16x16x32_bf16 v[72:75], a[204:207], a[120:123], v[72:75]
  ds_read_b64_tr_b16 a[182:183], v19 offset:32320
  v_mfma_f32_16x16x32_bf16 v[76:79], a[204:207], a[124:127], v[76:79]
  ds_read_b64_tr_b16 a[184:185], v19 offset:36928
  s_add_u32 s62, s77, 1
  s_cmp_ge_u32 s62, 9
  s_cselect_b32 s63, 9, 0
  v_mfma_f32_16x16x32_bf16 v[76:79], a[200:203], a[116:119], v[76:79]
  ds_read_b64_tr_b16 a[186:187], v19 offset:41536
  s_sub_u32 s62, s62, s63
  s_lshr_b32 s63, s62, 1
  v_mfma_f32_16x16x32_bf16 v[76:79], a[196:199], a[108:111], v[76:79]
  ds_read_b64_tr_b16 a[188:189], v19 offset:46144
  s_min_u32 s63, s63, 3
  s_lshl_b32 s67, s63, 1
  v_mfma_f32_16x16x32_bf16 v[76:79], a[192:195], a[100:103], v[76:79]
  ds_read_b64_tr_b16 a[190:191], v19 offset:50752
  s_waitcnt lgkmcnt(8)
  v_cvt_pk_bf16_f32 v42, v64, v65
  v_cvt_pk_bf16_f32 v43, v66, v67
  v_mfma_f32_16x16x32_bf16 v[72:75], a[160:163], a[128:131], v[72:75]
  ds_read_b64_tr_b16 a[192:193], v18 offset:32832
  v_mfma_f32_16x16x32_bf16 v[72:75], a[164:167], a[136:139], v[72:75]
  ds_read_b64_tr_b16 a[194:195], v18 offset:37440
  v_mfma_f32_16x16x32_bf16 v[72:75], a[168:171], a[144:147], v[72:75]
  ds_read_b64_tr_b16 a[196:197], v18 offset:42048
  v_mfma_f32_16x16x32_bf16 v[72:75], a[172:175], a[152:155], v[72:75]
  ds_read_b64_tr_b16 a[198:199], v18 offset:46656
  v_mfma_f32_16x16x32_bf16 v[76:79], a[172:175], a[156:159], v[76:79]
  ds_read_b64_tr_b16 a[200:201], v18 offset:51264
  s_sub_u32 s62, s62, s67
  s_mul_i32 s63, s63, 49152
  v_mfma_f32_16x16x32_bf16 v[76:79], a[168:171], a[148:151], v[76:79]
  ds_read_b64_tr_b16 a[202:203], v18 offset:55872
  s_lshl_b32 s62, s62, 10
  s_add_u32 s63, s63, s62
  v_mfma_f32_16x16x32_bf16 v[76:79], a[164:167], a[140:143], v[76:79]
  ds_read_b64_tr_b16 a[204:205], v19 offset:55360
  s_add_u32 s82, s63, s59
  v_cvt_pk_bf16_f32 v44, v68, v69
  v_cvt_pk_bf16_f32 v45, v70, v71
  v_mfma_f32_16x16x32_bf16 v[76:79], a[160:163], a[132:135], v[76:79]
  ds_read_b64_tr_b16 a[206:207], v19 offset:59968
  s_waitcnt lgkmcnt(8)
  buffer_store_dwordx4 v[42:45], v26, s[24:27], s81 offen sc1
  v_mfma_f32_16x16x32_bf16 v[80:83], a[176:179], a[96:99], v[80:83]
  ds_read_b64_tr_b16 a[160:161], v19 offset:18528
  v_mfma_f32_16x16x32_bf16 v[80:83], a[180:183], a[104:107], v[80:83]
  ds_read_b64_tr_b16 a[162:163], v19 offset:23136
  v_mfma_f32_16x16x32_bf16 v[80:83], a[184:187], a[112:115], v[80:83]
  ds_read_b64_tr_b16 a[164:165], v19 offset:27744
  v_mfma_f32_16x16x32_bf16 v[80:83], a[188:191], a[120:123], v[80:83]
  ds_read_b64_tr_b16 a[166:167], v19 offset:32352
  v_mfma_f32_16x16x32_bf16 v[84:87], a[188:191], a[124:127], v[84:87]
  ds_read_b64_tr_b16 a[168:169], v19 offset:36960
  s_add_u32 s62, s77, 2
  s_cmp_ge_u32 s62, 9
  s_cselect_b32 s63, 9, 0
  v_mfma_f32_16x16x32_bf16 v[84:87], a[184:187], a[116:119], v[84:87]
  ds_read_b64_tr_b16 a[170:171], v19 offset:41568
  s_sub_u32 s62, s62, s63
  s_lshr_b32 s63, s62, 1
  v_mfma_f32_16x16x32_bf16 v[84:87], a[180:183], a[108:111], v[84:87]
  ds_read_b64_tr_b16 a[172:173], v19 offset:46176
  s_min_u32 s63, s63, 3
  s_lshl_b32 s67, s63, 1
  v_mfma_f32_16x16x32_bf16 v[84:87], a[176:179], a[100:103], v[84:87]
  ds_read_b64_tr_b16 a[174:175], v19 offset:50784
  s_waitcnt lgkmcnt(8)
  v_cvt_pk_bf16_f32 v46, v72, v73
  v_cvt_pk_bf16_f32 v47, v74, v75
  v_mfma_f32_16x16x32_bf16 v[80:83], a[192:195], a[128:131], v[80:83]
  ds_read_b64_tr_b16 a[176:177], v18 offset:32864
  v_mfma_f32_16x16x32_bf16 v[80:83], a[196:199], a[136:139], v[80:83]
  ds_read_b64_tr_b16 a[178:179], v18 offset:37472
  v_mfma_f32_16x16x32_bf16 v[80:83], a[200:203], a[144:147], v[80:83]
  ds_read_b64_tr_b16 a[180:181], v18 offset:42080
  v_mfma_f32_16x16x32_bf16 v[80:83], a[204:207], a[152:155], v[80:83]
  ds_read_b64_tr_b16 a[182:183], v18 offset:46688
  v_mfma_f32_16x16x32_bf16 v[84:87], a[204:207], a[156:159], v[84:87]
  ds_read_b64_tr_b16 a[184:185], v18 offset:51296
  s_sub_u32 s62, s62, s67
  s_mul_i32 s63, s63, 49152
  v_mfma_f32_16x16x32_bf16 v[84:87], a[200:203], a[148:151], v[84:87]
  ds_read_b64_tr_b16 a[186:187], v18 offset:55904
  s_lshl_b32 s62, s62, 10
  s_add_u32 s63, s63, s62
  v_mfma_f32_16x16x32_bf16 v[84:87], a[196:199], a[140:143], v[84:87]
  ds_read_b64_tr_b16 a[188:189], v19 offset:55392
  s_add_u32 s83, s63, s59
  v_cvt_pk_bf16_f32 v48, v76, v77
  v_cvt_pk_bf16_f32 v49, v78, v79
  v_mfma_f32_16x16x32_bf16 v[84:87], a[192:195], a[132:135], v[84:87]
  ds_read_b64_tr_b16 a[190:191], v19 offset:60000
  s_waitcnt lgkmcnt(8)
  buffer_store_dwordx4 v[46:49], v26, s[24:27], s82 offen sc1
  v_mfma_f32_16x16x32_bf16 v[88:91], a[160:163], a[96:99], v[88:91]
  ds_read_b64_tr_b16 a[192:193], v19 offset:18560
  v_mfma_f32_16x16x32_bf16 v[88:91], a[164:167], a[104:107], v[88:91]
  ds_read_b64_tr_b16 a[194:195], v19 offset:23168
  v_mfma_f32_16x16x32_bf16 v[88:91], a[168:171], a[112:115], v[88:91]
  ds_read_b64_tr_b16 a[196:197], v19 offset:27776
  v_mfma_f32_16x16x32_bf16 v[88:91], a[172:175], a[120:123], v[88:91]
  ds_read_b64_tr_b16 a[198:199], v19 offset:32384
  v_mfma_f32_16x16x32_bf16 v[92:95], a[172:175], a[124:127], v[92:95]
  ds_read_b64_tr_b16 a[200:201], v19 offset:36992
  s_add_u32 s62, s77, 3
  s_cmp_ge_u32 s62, 9
  s_cselect_b32 s63, 9, 0
  v_mfma_f32_16x16x32_bf16 v[92:95], a[168:171], a[116:119], v[92:95]
  ds_read_b64_tr_b16 a[202:203], v19 offset:41600
  s_sub_u32 s62, s62, s63
  s_lshr_b32 s63, s62, 1
  v_mfma_f32_16x16x32_bf16 v[92:95], a[164:167], a[108:111], v[92:95]
  ds_read_b64_tr_b16 a[204:205], v19 offset:46208
  s_min_u32 s63, s63, 3
  s_lshl_b32 s67, s63, 1
  v_mfma_f32_16x16x32_bf16 v[92:95], a[160:163], a[100:103], v[92:95]
  ds_read_b64_tr_b16 a[206:207], v19 offset:50816
  s_waitcnt lgkmcnt(8)
  v_cvt_pk_bf16_f32 v42, v80, v81
  v_cvt_pk_bf16_f32 v43, v82, v83
  v_mfma_f32_16x16x32_bf16 v[88:91], a[176:179], a[128:131], v[88:91]
  ds_read_b64_tr_b16 a[160:161], v18 offset:32896
  v_mfma_f32_16x16x32_bf16 v[88:91], a[180:183], a[136:139], v[88:91]
  ds_read_b64_tr_b16 a[162:163], v18 offset:37504
  v_mfma_f32_16x16x32_bf16 v[88:91], a[184:187], a[144:147], v[88:91]
  ds_read_b64_tr_b16 a[164:165], v18 offset:42112
  v_mfma_f32_16x16x32_bf16 v[88:91], a[188:191], a[152:155], v[88:91]
  ds_read_b64_tr_b16 a[166:167], v18 offset:46720
  v_mfma_f32_16x16x32_bf16 v[92:95], a[188:191], a[156:159], v[92:95]
  ds_read_b64_tr_b16 a[168:169], v18 offset:51328
  s_sub_u32 s62, s62, s67
  s_mul_i32 s63, s63, 49152
  v_mfma_f32_16x16x32_bf16 v[92:95], a[184:187], a[148:151], v[92:95]
  ds_read_b64_tr_b16 a[170:171], v18 offset:55936
  s_lshl_b32 s62, s62, 10
  s_add_u32 s63, s63, s62
  v_mfma_f32_16x16x32_bf16 v[92:95], a[180:183], a[140:143], v[92:95]
  ds_read_b64_tr_b16 a[172:173], v19 offset:55424
  s_add_u32 s84, s63, s59
  v_cvt_pk_bf16_f32 v44, v84, v85
  v_cvt_pk_bf16_f32 v45, v86, v87
  v_mfma_f32_16x16x32_bf16 v[92:95], a[176:179], a[132:135], v[92:95]
  ds_read_b64_tr_b16 a[174:175], v19 offset:60032
  s_waitcnt lgkmcnt(8)
  buffer_store_dwordx4 v[42:45], v26, s[24:27], s83 offen sc1
  v_mfma_f32_16x16x32_bf16 v[96:99], a[192:195], a[96:99], v[96:99]
  ds_read_b64_tr_b16 a[176:177], v19 offset:18592
  v_mfma_f32_16x16x32_bf16 v[96:99], a[196:199], a[104:107], v[96:99]
  ds_read_b64_tr_b16 a[178:179], v19 offset:23200
  v_mfma_f32_16x16x32_bf16 v[96:99], a[200:203], a[112:115], v[96:99]
  ds_read_b64_tr_b16 a[180:181], v19 offset:27808
  v_mfma_f32_16x16x32_bf16 v[96:99], a[204:207], a[120:123], v[96:99]
  ds_read_b64_tr_b16 a[182:183], v19 offset:32416
  v_mfma_f32_16x16x32_bf16 v[100:103], a[204:207], a[124:127], v[100:103]
  ds_read_b64_tr_b16 a[184:185], v19 offset:37024
  s_add_u32 s62, s77, 4
  s_cmp_ge_u32 s62, 9
  s_cselect_b32 s63, 9, 0
  v_mfma_f32_16x16x32_bf16 v[100:103], a[200:203], a[116:119], v[100:103]
  ds_read_b64_tr_b16 a[186:187], v19 offset:41632
  s_sub_u32 s62, s62, s63
  s_lshr_b32 s63, s62, 1
  v_mfma_f32_16x16x32_bf16 v[100:103], a[196:199], a[108:111], v[100:103]
  ds_read_b64_tr_b16 a[188:189], v19 offset:46240
  s_min_u32 s63, s63, 3
  s_lshl_b32 s67, s63, 1
  v_mfma_f32_16x16x32_bf16 v[100:103], a[192:195], a[100:103], v[100:103]
  ds_read_b64_tr_b16 a[190:191], v19 offset:50848
  s_waitcnt lgkmcnt(8)
  v_cvt_pk_bf16_f32 v46, v88, v89
  v_cvt_pk_bf16_f32 v47, v90, v91
  v_mfma_f32_16x16x32_bf16 v[96:99], a[160:163], a[128:131], v[96:99]
  ds_read_b64_tr_b16 a[192:193], v18 offset:32928
  v_mfma_f32_16x16x32_bf16 v[96:99], a[164:167], a[136:139], v[96:99]
  ds_read_b64_tr_b16 a[194:195], v18 offset:37536
  v_mfma_f32_16x16x32_bf16 v[96:99], a[168:171], a[144:147], v[96:99]
  ds_read_b64_tr_b16 a[196:197], v18 offset:42144
  v_mfma_f32_16x16x32_bf16 v[96:99], a[172:175], a[152:155], v[96:99]
  ds_read_b64_tr_b16 a[198:199], v18 offset:46752
  v_mfma_f32_16x16x32_bf16 v[100:103], a[172:175], a[156:159], v[100:103]
  ds_read_b64_tr_b16 a[200:201], v18 offset:51360
  s_sub_u32 s62, s62, s67
  s_mul_i32 s63, s63, 49152
  v_mfma_f32_16x16x32_bf16 v[100:103], a[168:171], a[148:151], v[100:103]
  ds_read_b64_tr_b16 a[202:203], v18 offset:55968
  s_lshl_b32 s62, s62, 10
  s_add_u32 s63, s63, s62
  v_mfma_f32_16x16x32_bf16 v[100:103], a[164:167], a[140:143], v[100:103]
  ds_read_b64_tr_b16 a[204:205], v19 offset:55456
  s_add_u32 s85, s63, s59
  v_cvt_pk_bf16_f32 v48, v92, v93
  v_cvt_pk_bf16_f32 v49, v94, v95
  v_mfma_f32_16x16x32_bf16 v[100:103], a[160:163], a[132:135], v[100:103]
  ds_read_b64_tr_b16 a[206:207], v19 offset:60064
  s_waitcnt lgkmcnt(8)
  buffer_store_dwordx4 v[46:49], v26, s[24:27], s84 offen sc1
  v_mfma_f32_16x16x32_bf16 v[104:107], a[176:179], a[96:99], v[104:107]
  ds_read_b64_tr_b16 a[160:161], v19 offset:18624
  v_mfma_f32_16x16x32_bf16 v[104:107], a[180:183], a[104:107], v[104:107]
  ds_read_b64_tr_b16 a[162:163], v19 offset:23232
  v_mfma_f32_16x16x32_bf16 v[104:107], a[184:187], a[112:115], v[104:107]
  ds_read_b64_tr_b16 a[164:165], v19 offset:27840
  v_mfma_f32_16x16x32_bf16 v[104:107], a[188:191], a[120:123], v[104:107]
  ds_read_b64_tr_b16 a[166:167], v19 offset:32448
  v_mfma_f32_16x16x32_bf16 v[108:111], a[188:191], a[124:127], v[108:111]
  ds_read_b64_tr_b16 a[168:169], v19 offset:37056
  s_add_u32 s62, s77, 5
  s_cmp_ge_u32 s62, 9
  s_cselect_b32 s63, 9, 0
  v_mfma_f32_16x16x32_bf16 v[108:111], a[184:187], a[116:119], v[108:111]
  ds_read_b64_tr_b16 a[170:171], v19 offset:41664
  s_sub_u32 s62, s62, s63
  s_lshr_b32 s63, s62, 1
  v_mfma_f32_16x16x32_bf16 v[108:111], a[180:183], a[108:111], v[108:111]
  ds_read_b64_tr_b16 a[172:173], v19 offset:46272
  s_min_u32 s63, s63, 3
  s_lshl_b32 s67, s63, 1
  v_mfma_f32_16x16x32_bf16 v[108:111], a[176:179], a[100:103], v[108:111]
  ds_read_b64_tr_b16 a[174:175], v19 offset:50880
  s_waitcnt lgkmcnt(8)
  v_cvt_pk_bf16_f32 v42, v96, v97
  v_cvt_pk_bf16_f32 v43, v98, v99
  v_mfma_f32_16x16x32_bf16 v[104:107], a[192:195], a[128:131], v[104:107]
  ds_read_b64_tr_b16 a[176:177], v18 offset:32960
  v_mfma_f32_16x16x32_bf16 v[104:107], a[196:199], a[136:139], v[104:107]
  ds_read_b64_tr_b16 a[178:179], v18 offset:37568
  v_mfma_f32_16x16x32_bf16 v[104:107], a[200:203], a[144:147], v[104:107]
  ds_read_b64_tr_b16 a[180:181], v18 offset:42176
  v_mfma_f32_16x16x32_bf16 v[104:107], a[204:207], a[152:155], v[104:107]
  ds_read_b64_tr_b16 a[182:183], v18 offset:46784
  v_mfma_f32_16x16x32_bf16 v[108:111], a[204:207], a[156:159], v[108:111]
  ds_read_b64_tr_b16 a[184:185], v18 offset:51392
  s_sub_u32 s62, s62, s67
  s_mul_i32 s63, s63, 49152
  v_mfma_f32_16x16x32_bf16 v[108:111], a[200:203], a[148:151], v[108:111]
  ds_read_b64_tr_b16 a[186:187], v18 offset:56000
  s_lshl_b32 s62, s62, 10
  s_add_u32 s63, s63, s62
  v_mfma_f32_16x16x32_bf16 v[108:111], a[196:199], a[140:143], v[108:111]
  ds_read_b64_tr_b16 a[188:189], v19 offset:55488
  s_add_u32 s86, s63, s59
  v_cvt_pk_bf16_f32 v44, v100, v101
  v_cvt_pk_bf16_f32 v45, v102, v103
  v_mfma_f32_16x16x32_bf16 v[108:111], a[192:195], a[132:135], v[108:111]
  ds_read_b64_tr_b16 a[190:191], v19 offset:60096
  s_waitcnt lgkmcnt(8)
  buffer_store_dwordx4 v[42:45], v26, s[24:27], s85 offen sc1
  v_mfma_f32_16x16x32_bf16 v[112:115], a[160:163], a[96:99], v[112:115]
  ds_read_b64_tr_b16 a[192:193], v19 offset:64736
  v_mfma_f32_16x16x32_bf16 v[112:115], a[164:167], a[104:107], v[112:115]
  ds_read_b64_tr_b16 a[194:195], v20 offset:3808
  v_mfma_f32_16x16x32_bf16 v[112:115], a[168:171], a[112:115], v[112:115]
  ds_read_b64_tr_b16 a[196:197], v20 offset:8416
  v_mfma_f32_16x16x32_bf16 v[112:115], a[172:175], a[120:123], v[112:115]
  ds_read_b64_tr_b16 a[198:199], v20 offset:13024
  v_mfma_f32_16x16x32_bf16 v[116:119], a[172:175], a[124:127], v[116:119]
  ds_read_b64_tr_b16 a[200:201], v20 offset:17632
  s_add_u32 s62, s77, 6
  s_cmp_ge_u32 s62, 9
  s_cselect_b32 s63, 9, 0
  v_mfma_f32_16x16x32_bf16 v[116:119], a[168:171], a[116:119], v[116:119]
  ds_read_b64_tr_b16 a[202:203], v20 offset:22240
  s_sub_u32 s62, s62, s63
  s_lshr_b32 s63, s62, 1
  v_mfma_f32_16x16x32_bf16 v[116:119], a[164:167], a[108:111], v[116:119]
  ds_read_b64_tr_b16 a[204:205], v19 offset:224
  s_min_u32 s63, s63, 3
  s_lshl_b32 s67, s63, 1
  v_mfma_f32_16x16x32_bf16 v[116:119], a[160:163], a[100:103], v[116:119]
  ds_read_b64_tr_b16 a[206:207], v19 offset:4832
  s_waitcnt lgkmcnt(8)
  v_cvt_pk_bf16_f32 v46, v104, v105
  v_cvt_pk_bf16_f32 v47, v106, v107
  v_mfma_f32_16x16x32_bf16 v[112:115], a[176:179], a[128:131], v[112:115]
  ds_read_b64_tr_b16 a[160:161], v18 offset:224
  v_mfma_f32_16x16x32_bf16 v[112:115], a[180:183], a[136:139], v[112:115]
  ds_read_b64_tr_b16 a[162:163], v18 offset:4832
  v_mfma_f32_16x16x32_bf16 v[112:115], a[184:187], a[144:147], v[112:115]
  ds_read_b64_tr_b16 a[164:165], v18 offset:9440
  v_mfma_f32_16x16x32_bf16 v[112:115], a[188:191], a[152:155], v[112:115]
  ds_read_b64_tr_b16 a[166:167], v18 offset:14048
  v_mfma_f32_16x16x32_bf16 v[116:119], a[188:191], a[156:159], v[116:119]
  ds_read_b64_tr_b16 a[168:169], v18 offset:18656
  s_sub_u32 s62, s62, s67
  s_mul_i32 s63, s63, 49152
  v_mfma_f32_16x16x32_bf16 v[116:119], a[184:187], a[148:151], v[116:119]
  ds_read_b64_tr_b16 a[170:171], v18 offset:23264
  s_lshl_b32 s62, s62, 10
  s_add_u32 s63, s63, s62
  v_mfma_f32_16x16x32_bf16 v[116:119], a[180:183], a[140:143], v[116:119]
  ds_read_b64_tr_b16 a[172:173], v19 offset:9440
  s_add_u32 s87, s63, s59
  v_cvt_pk_bf16_f32 v48, v108, v109
  v_cvt_pk_bf16_f32 v49, v110, v111
  v_mfma_f32_16x16x32_bf16 v[116:119], a[176:179], a[132:135], v[116:119]
  ds_read_b64_tr_b16 a[174:175], v19 offset:14048
  s_waitcnt lgkmcnt(8)
  buffer_store_dwordx4 v[46:49], v26, s[24:27], s86 offen sc1
  v_mfma_f32_16x16x32_bf16 v[120:123], a[192:195], a[32:35], v[120:123]
  ds_read_b64_tr_b16 a[176:177], v19 offset:18656
  v_mfma_f32_16x16x32_bf16 v[120:123], a[196:199], a[40:43], v[120:123]
  ds_read_b64_tr_b16 a[178:179], v19 offset:23264
  v_mfma_f32_16x16x32_bf16 v[120:123], a[200:203], a[48:51], v[120:123]
  ds_read_b64_tr_b16 a[180:181], v19 offset:27872
  v_mfma_f32_16x16x32_bf16 v[120:123], a[204:207], a[56:59], v[120:123]
  ds_read_b64_tr_b16 a[182:183], v19 offset:32480
  v_mfma_f32_16x16x32_bf16 v[124:127], a[204:207], a[60:63], v[124:127]
  ds_read_b64_tr_b16 a[184:185], v19 offset:37088
  v_mfma_f32_16x16x32_bf16 v[124:127], a[200:203], a[52:55], v[124:127]
  ds_read_b64_tr_b16 a[186:187], v19 offset:41696
  v_cvt_pk_bf16_f32 v42, v112, v113
  v_cvt_pk_bf16_f32 v43, v114, v115
  v_mfma_f32_16x16x32_bf16 v[124:127], a[196:199], a[44:47], v[124:127]
  ds_read_b64_tr_b16 a[188:189], v19 offset:46304
  v_cvt_pk_bf16_f32 v44, v116, v117
  v_cvt_pk_bf16_f32 v45, v118, v119
  v_mfma_f32_16x16x32_bf16 v[124:127], a[192:195], a[36:39], v[124:127]
  ds_read_b64_tr_b16 a[190:191], v19 offset:50912
  s_waitcnt lgkmcnt(8)
  buffer_store_dwordx4 v[42:45], v26, s[24:27], s87 offen sc1
  v_mfma_f32_16x16x32_bf16 v[120:123], a[160:163], a[64:67], v[120:123]
  ds_read_b64_tr_b16 a[192:193], v18 offset:32992
  v_mfma_f32_16x16x32_bf16 v[120:123], a[164:167], a[72:75], v[120:123]
  ds_read_b64_tr_b16 a[194:195], v18 offset:37600
  v_mfma_f32_16x16x32_bf16 v[120:123], a[168:171], a[80:83], v[120:123]
  ds_read_b64_tr_b16 a[196:197], v18 offset:42208
  v_mfma_f32_16x16x32_bf16 v[120:123], a[172:175], a[88:91], v[120:123]
  ds_read_b64_tr_b16 a[198:199], v18 offset:46816
  v_mfma_f32_16x16x32_bf16 v[124:127], a[172:175], a[92:95], v[124:127]
  ds_read_b64_tr_b16 a[200:201], v18 offset:51424
  s_lshl_b32 s66, s58, 2
  s_add_u32 s66, s66, s28
  s_lshl_b32 s66, s66, 9
  v_mfma_f32_16x16x32_bf16 v[124:127], a[168:171], a[84:87], v[124:127]
  ds_read_b64_tr_b16 a[202:203], v18 offset:56032
  s_add_u32 s66, s66, 42991616
  s_lshl_b32 s48, s32, 7
  s_add_u32 s48, s48, s66
  v_mfma_f32_16x16x32_bf16 v[124:127], a[164:167], a[76:79], v[124:127]
  ds_read_b64_tr_b16 a[204:205], v19 offset:55520
  s_lshl_b32 s47, s58, 2
  s_add_u32 s47, s47, s32
  s_lshl_b32 s47, s47, 4
  v_mfma_f32_16x16x32_bf16 v[124:127], a[160:163], a[68:71], v[124:127]
  ds_read_b64_tr_b16 a[206:207], v19 offset:60128
  s_waitcnt lgkmcnt(8)
  s_add_u32 s47, s47, s28
  s_mul_i32 s47, s47, 3072
  s_add_u32 s47, s47, 20971520
  v_mfma_f32_16x16x32_bf16 v[120:123], a[176:179], a[96:99], v[120:123]
  ds_read_b64_tr_b16 a[160:161], v19 offset:64768
  v_mfma_f32_16x16x32_bf16 v[120:123], a[180:183], a[104:107], v[120:123]
  ds_read_b64_tr_b16 a[162:163], v20 offset:3840
  v_mfma_f32_16x16x32_bf16 v[120:123], a[184:187], a[112:115], v[120:123]
  ds_read_b64_tr_b16 a[164:165], v20 offset:8448
  v_mfma_f32_16x16x32_bf16 v[120:123], a[188:191], a[120:123], v[120:123]
  ds_read_b64_tr_b16 a[166:167], v20 offset:13056
  v_mfma_f32_16x16x32_bf16 v[124:127], a[188:191], a[124:127], v[124:127]
  ds_read_b64_tr_b16 a[168:169], v20 offset:17664
  s_cmp_eq_u32 s32, 3
  s_cselect_b32 s49, 1024, 0
  s_lshl_b32 s50, s33, 8
  s_lshl_b32 s51, s40, 7
  v_mfma_f32_16x16x32_bf16 v[124:127], a[184:187], a[116:119], v[124:127]
  ds_read_b64_tr_b16 a[170:171], v20 offset:22272
  s_add_u32 s50, s50, s51
  s_lshl_b32 s51, s28, 5
  s_add_u32 s50, s50, s51
  v_mfma_f32_16x16x32_bf16 v[124:127], a[180:183], a[108:111], v[124:127]
  ds_read_b64_tr_b16 a[172:173], v19 offset:256
  s_mul_i32 s50, s50, 1152
  s_mul_i32 s51, s41, 288
  s_add_u32 s50, s50, s51
  v_mfma_f32_16x16x32_bf16 v[124:127], a[176:179], a[100:103], v[124:127]
  ds_read_b64_tr_b16 a[174:175], v19 offset:4864
  s_waitcnt lgkmcnt(8)
  s_add_u32 s81, s32, 1
  s_and_b32 s81, s81, 3
  s_mul_i32 s81, s81, 12288
  v_mfma_f32_16x16x32_bf16 v[120:123], a[192:195], a[128:131], v[120:123]
  ds_read_b64_tr_b16 a[176:177], v18 offset:256
  v_mfma_f32_16x16x32_bf16 v[120:123], a[196:199], a[136:139], v[120:123]
  ds_read_b64_tr_b16 a[178:179], v18 offset:4864
  v_mfma_f32_16x16x32_bf16 v[120:123], a[200:203], a[144:147], v[120:123]
  ds_read_b64_tr_b16 a[180:181], v18 offset:9472
  v_mfma_f32_16x16x32_bf16 v[120:123], a[204:207], a[152:155], v[120:123]
  ds_read_b64_tr_b16 a[182:183], v18 offset:14080
  v_mfma_f32_16x16x32_bf16 v[124:127], a[204:207], a[156:159], v[124:127]
  ds_read_b64_tr_b16 a[184:185], v18 offset:18688
  s_add_u32 s81, s81, s47
  s_add_u32 s82, s32, 2
  s_and_b32 s82, s82, 3
  v_mfma_f32_16x16x32_bf16 v[124:127], a[200:203], a[148:151], v[124:127]
  ds_read_b64_tr_b16 a[186:187], v18 offset:23296
  s_mul_i32 s82, s82, 12288
  s_add_u32 s82, s82, s47
  s_add_u32 s83, s32, 3
  v_mfma_f32_16x16x32_bf16 v[124:127], a[196:199], a[140:143], v[124:127]
  ds_read_b64_tr_b16 a[188:189], v19 offset:9472
  s_and_b32 s83, s83, 3
  s_mul_i32 s83, s83, 12288
  s_add_u32 s83, s83, s47
  v_mfma_f32_16x16x32_bf16 v[124:127], a[192:195], a[132:135], v[124:127]
  ds_read_b64_tr_b16 a[190:191], v19 offset:14080
  s_waitcnt lgkmcnt(8)
  s_lshl_b32 s51, s32, 6
  s_cmp_eq_u32 s32, 3
  s_cselect_b32 s51, 224, s51
  s_add_u32 s50, s50, s51
  v_mfma_f32_16x16x32_bf16 v[128:131], a[160:163], a[32:35], v[128:131]
  ds_read_b64_tr_b16 a[192:193], v19 offset:18688
  v_mfma_f32_16x16x32_bf16 v[128:131], a[164:167], a[40:43], v[128:131]
  ds_read_b64_tr_b16 a[194:195], v19 offset:23296
  v_mfma_f32_16x16x32_bf16 v[128:131], a[168:171], a[48:51], v[128:131]
  ds_read_b64_tr_b16 a[196:197], v19 offset:27904
  v_mfma_f32_16x16x32_bf16 v[128:131], a[172:175], a[56:59], v[128:131]
  ds_read_b64_tr_b16 a[198:199], v19 offset:32512
  v_mfma_f32_16x16x32_bf16 v[132:135], a[172:175], a[60:63], v[132:135]
  ds_read_b64_tr_b16 a[200:201], v19 offset:37120
  s_mov_b32 s16, s12
  s_mov_b32 s17, s13
  s_mov_b32 s18, 2359296
  v_mfma_f32_16x16x32_bf16 v[132:135], a[168:171], a[52:55], v[132:135]
  ds_read_b64_tr_b16 a[202:203], v19 offset:41728
  s_mov_b32 s19, 0x00020000
  v_and_b32 v2, 15, v0
  v_mul_u32_u24 v2, 1152, v2
  v_mfma_f32_16x16x32_bf16 v[132:135], a[164:167], a[44:47], v[132:135]
  ds_read_b64_tr_b16 a[204:205], v19 offset:46336
  v_lshrrev_b32 v3, 4, v0
  v_lshlrev_b32 v3, 3, v3
  v_add_u32 v2, v2, v3
  v_mfma_f32_16x16x32_bf16 v[132:135], a[160:163], a[36:39], v[132:135]
  ds_read_b64_tr_b16 a[206:207], v19 offset:50944
  s_waitcnt lgkmcnt(8)
  v_add_u32 v3, 18432, v2
  s_mov_b32 s67, 0xffff0000
  s_mov_b32 s72, 0
  v_mfma_f32_16x16x32_bf16 v[128:131], a[176:179], a[64:67], v[128:131]
  ds_read_b64_tr_b16 a[160:161], v18 offset:33024
  v_mfma_f32_16x16x32_bf16 v[128:131], a[180:183], a[72:75], v[128:131]
  ds_read_b64_tr_b16 a[162:163], v18 offset:37632
  v_mfma_f32_16x16x32_bf16 v[128:131], a[184:187], a[80:83], v[128:131]
  ds_read_b64_tr_b16 a[164:165], v18 offset:42240
  v_mfma_f32_16x16x32_bf16 v[128:131], a[188:191], a[88:91], v[128:131]
  ds_read_b64_tr_b16 a[166:167], v18 offset:46848
  v_mfma_f32_16x16x32_bf16 v[132:135], a[188:191], a[92:95], v[132:135]
  ds_read_b64_tr_b16 a[168:169], v18 offset:51456
  v_mfma_f32_16x16x32_bf16 v[132:135], a[184:187], a[84:87], v[132:135]
  ds_read_b64_tr_b16 a[170:171], v18 offset:56064
  v_mfma_f32_16x16x32_bf16 v[132:135], a[180:183], a[76:79], v[132:135]
  ds_read_b64_tr_b16 a[172:173], v19 offset:55552
  v_mfma_f32_16x16x32_bf16 v[132:135], a[176:179], a[68:71], v[132:135]
  ds_read_b64_tr_b16 a[174:175], v19 offset:60160
  s_waitcnt lgkmcnt(8)
  v_mfma_f32_16x16x32_bf16 v[128:131], a[192:195], a[96:99], v[128:131]
  v_mfma_f32_16x16x32_bf16 v[128:131], a[196:199], a[104:107], v[128:131]
  v_mfma_f32_16x16x32_bf16 v[128:131], a[200:203], a[112:115], v[128:131]
  v_mfma_f32_16x16x32_bf16 v[128:131], a[204:207], a[120:123], v[128:131]
  v_mfma_f32_16x16x32_bf16 v[132:135], a[204:207], a[124:127], v[132:135]
  s_waitcnt vmcnt(0)
  buffer_store_dword v253, v254, s[24:27], s48 offen sc1
  v_mfma_f32_16x16x32_bf16 v[132:135], a[200:203], a[116:119], v[132:135]
  v_mfma_f32_16x16x32_bf16 v[132:135], a[196:199], a[108:111], v[132:135]
  v_mfma_f32_16x16x32_bf16 v[132:135], a[192:195], a[100:103], v[132:135]
  s_waitcnt lgkmcnt(0)
  v_mfma_f32_16x16x32_bf16 v[128:131], a[160:163], a[128:131], v[128:131]
  v_mfma_f32_16x16x32_bf16 v[128:131], a[164:167], a[136:139], v[128:131]
  v_mfma_f32_16x16x32_bf16 v[128:131], a[168:171], a[144:147], v[128:131]
  v_mfma_f32_16x16x32_bf16 v[128:131], a[172:175], a[152:155], v[128:131]
  v_mfma_f32_16x16x32_bf16 v[132:135], a[172:175], a[156:159], v[132:135]
  v_mfma_f32_16x16x32_bf16 v[132:135], a[168:171], a[148:151], v[132:135]
  v_mfma_f32_16x16x32_bf16 v[132:135], a[164:167], a[140:143], v[132:135]
  v_mfma_f32_16x16x32_bf16 v[132:135], a[160:163], a[132:135], v[132:135]
  s_mov_b32 s64, 0
  s_add_u32 s51, s66, 0
L_poll6:
  s_load_dword s4, s[52:53], s51 offset:0 glc
  s_load_dword s5, s[52:53], s51 offset:128 glc
  s_load_dword s6, s[52:53], s51 offset:256 glc
  s_load_dword s7, s[52:53], s51 offset:384 glc
  s_add_u32 s64, s64, 1
  s_cmp_gt_u32 s64, 20000
  s_cbranch_scc1 L_poll6_ok
  s_waitcnt lgkmcnt(0)
  s_cmp_eq_u64 s[4:5], s[14:15]
  s_cbranch_scc0 L_poll6
  s_cmp_eq_u64 s[6:7], s[14:15]
  s_cbranch_scc0 L_poll6
L_poll6_ok:
  s_waitcnt lgkmcnt(0)
L_pp_ok:
  s_add_u32 s51, s81, s49
  buffer_load_dwordx4 v[144:147], v26, s[24:27], s51 offen sc1
  s_add_u32 s51, s82, s49
  buffer_load_dwordx4 v[148:151], v26, s[24:27], s51 offen sc1
  s_add_u32 s51, s83, s49
  buffer_load_dwordx4 v[152:155], v26, s[24:27], s51 offen sc1
  s_add_u32 s51, s81, s49
  s_add_u32 s51, s51, 1024
  buffer_load_dwordx4 v[156:159], v26, s[24:27], s51 offen sc1
  s_add_u32 s51, s82, s49
  s_add_u32 s51, s51, 1024
  buffer_load_dwordx4 v[160:163], v26, s[24:27], s51 offen sc1
  s_add_u32 s51, s83, s49
  s_add_u32 s51, s51, 1024
  buffer_load_dwordx4 v[164:167], v26, s[24:27], s51 offen sc1
  s_cmp_eq_u32 s32, 3
  s_cbranch_scc0 L_k2skip
  s_mov_b32 s51, s81
  buffer_load_dwordx4 v[168:171], v26, s[24:27], s51 offen sc1
  s_mov_b32 s51, s82
  buffer_load_dwordx4 v[172:175], v26, s[24:27], s51 offen sc1
  s_mov_b32 s51, s83
  buffer_load_dwordx4 v[176:179], v26, s[24:27], s51 offen sc1
L_k2skip:
  s_waitcnt vmcnt(3)
  v_lshlrev_b32 v32, 16, v144
  v_and_b32 v33, s67, v144
  v_lshlrev_b32 v34, 16, v145
  v_and_b32 v35, s67, v145
  v_lshlrev_b32 v36, 16, v146
  v_and_b32 v37, s67, v146
  v_lshlrev_b32 v38, 16, v147
  v_and_b32 v39, s67, v147
  v_pk_add_f32 v[120:121], v[120:121], v[32:33]
  v_pk_add_f32 v[122:123], v[122:123], v[34:35]
  v_pk_add_f32 v[124:125], v[124:125], v[36:37]
  v_pk_add_f32 v[126:127], v[126:127], v[38:39]
  v_lshlrev_b32 v40, 16, v148
  v_and_b32 v41, s67, v148
  v_lshlrev_b32 v50, 16, v149
  v_and_b32 v51, s67, v149
  v_lshlrev_b32 v52, 16, v150
  v_and_b32 v53, s67, v150
  v_lshlrev_b32 v54, 16, v151
  v_and_b32 v55, s67, v151
  v_pk_add_f32 v[120:121], v[120:121], v[40:41]
  v_pk_add_f32 v[122:123], v[122:123], v[50:51]
  v_pk_add_f32 v[124:125], v[124:125], v[52:53]
  v_pk_add_f32 v[126:127], v[126:127], v[54:55]
  v_lshlrev_b32 v32, 16, v152
  v_and_b32 v33, s67, v152
  v_lshlrev_b32 v34, 16, v153
  v_and_b32 v35, s67, v153
  v_lshlrev_b32 v36, 16, v154
  v_and_b32 v37, s67, v154
  v_lshlrev_b32 v38, 16, v155
  v_and_b32 v39, s67, v155
  v_pk_add_f32 v[120:121], v[120:121], v[32:33]
  v_pk_add_f32 v[122:123], v[122:123], v[34:35]
  v_pk_add_f32 v[124:125], v[124:125], v[36:37]
  v_pk_add_f32 v[126:127], v[126:127], v[38:39]
  v_cvt_pk_bf16_f32 v120, v120, v121
  v_cvt_pk_bf16_f32 v121, v122, v123
  buffer_store_dwordx2 v[120:121], v2, s[16:19], s50 offen offset:0
  v_cvt_pk_bf16_f32 v124, v124, v125
  v_cvt_pk_bf16_f32 v125, v126, v127
  buffer_store_dwordx2 v[124:125], v3, s[16:19], s50 offen offset:0
  s_cmp_eq_u32 s32, 3
  s_cbranch_scc0 L_w1
  s_waitcnt vmcnt(5)
  s_branch L_w2
L_w1:
  s_waitcnt vmcnt(2)
L_w2:
  v_lshlrev_b32 v32, 16, v156
  v_and_b32 v33, s67, v156
  v_lshlrev_b32 v34, 16, v157
  v_and_b32 v35, s67, v157
  v_lshlrev_b32 v36, 16, v158
  v_and_b32 v37, s67, v158
  v_lshlrev_b32 v38, 16, v159
  v_and_b32 v39, s67, v159
  v_pk_add_f32 v[128:129], v[128:129], v[32:33]
  v_pk_add_f32 v[130:131], v[130:131], v[34:35]
  v_pk_add_f32 v[132:133], v[132:133], v[36:37]
  v_pk_add_f32 v[134:135], v[134:135], v[38:39]
  v_lshlrev_b32 v40, 16, v160
  v_and_b32 v41, s67, v160
  v_lshlrev_b32 v50, 16, v161
  v_and_b32 v51, s67, v161
  v_lshlrev_b32 v52, 16, v162
  v_and_b32 v53, s67, v162
  v_lshlrev_b32 v54, 16, v163
  v_and_b32 v55, s67, v163
  v_pk_add_f32 v[128:129], v[128:129], v[40:41]
  v_pk_add_f32 v[130:131], v[130:131], v[50:51]
  v_pk_add_f32 v[132:133], v[132:133], v[52:53]
  v_pk_add_f32 v[134:135], v[134:135], v[54:55]
  v_lshlrev_b32 v32, 16, v164
  v_and_b32 v33, s67, v164
  v_lshlrev_b32 v34, 16, v165
  v_and_b32 v35, s67, v165
  v_lshlrev_b32 v36, 16, v166
  v_and_b32 v37, s67, v166
  v_lshlrev_b32 v38, 16, v167
  v_and_b32 v39, s67, v167
  v_pk_add_f32 v[128:129], v[128:129], v[32:33]
  v_pk_add_f32 v[130:131], v[130:131], v[34:35]
  v_pk_add_f32 v[132:133], v[132:133], v[36:37]
  v_pk_add_f32 v[134:135], v[134:135], v[38:39]
  v_cvt_pk_bf16_f32 v128, v128, v129
  v_cvt_pk_bf16_f32 v129, v130, v131
  buffer_store_dwordx2 v[128:129], v2, s[16:19], s50 offen offset:32
  v_cvt_pk_bf16_f32 v132, v132, v133
  v_cvt_pk_bf16_f32 v133, v134, v135
  buffer_store_dwordx2 v[132:133], v3, s[16:19], s50 offen offset:32
  s_cmp_eq_u32 s32, 3
  s_cbranch_scc0 L_fin
  s_waitcnt vmcnt(4)
  s_sub_u32 s50, s50, 32
  v_lshlrev_b32 v32, 16, v168
  v_and_b32 v33, s67, v168
  v_lshlrev_b32 v34, 16, v169
  v_and_b32 v35, s67, v169
  v_lshlrev_b32 v36, 16, v170
  v_and_b32 v37, s67, v170
  v_lshlrev_b32 v38, 16, v171
  v_and_b32 v39, s67, v171
  v_pk_add_f32 v[112:113], v[112:113], v[32:33]
  v_pk_add_f32 v[114:115], v[114:115], v[34:35]
  v_pk_add_f32 v[116:117], v[116:117], v[36:37]
  v_pk_add_f32 v[118:119], v[118:119], v[38:39]
  v_lshlrev_b32 v40, 16, v172
  v_and_b32 v41, s67, v172
  v_lshlrev_b32 v50, 16, v173
  v_and_b32 v51, s67, v173
  v_lshlrev_b32 v52, 16, v174
  v_and_b32 v53, s67, v174
  v_lshlrev_b32 v54, 16, v175
  v_and_b32 v55, s67, v175
  v_pk_add_f32 v[112:113], v[112:113], v[40:41]
  v_pk_add_f32 v[114:115], v[114:115], v[50:51]
  v_pk_add_f32 v[116:117], v[116:117], v[52:53]
  v_pk_add_f32 v[118:119], v[118:119], v[54:55]
  v_lshlrev_b32 v32, 16, v176
  v_and_b32 v33, s67, v176
  v_lshlrev_b32 v34, 16, v177
  v_and_b32 v35, s67, v177
  v_lshlrev_b32 v36, 16, v178
  v_and_b32 v37, s67, v178
  v_lshlrev_b32 v38, 16, v179
  v_and_b32 v39, s67, v179
  v_pk_add_f32 v[112:113], v[112:113], v[32:33]
  v_pk_add_f32 v[114:115], v[114:115], v[34:35]
  v_pk_add_f32 v[116:117], v[116:117], v[36:37]
  v_pk_add_f32 v[118:119], v[118:119], v[38:39]
  v_cvt_pk_bf16_f32 v112, v112, v113
  v_cvt_pk_bf16_f32 v113, v114, v115
  buffer_store_dwordx2 v[112:113], v2, s[16:19], s50 offen offset:0
  v_cvt_pk_bf16_f32 v116, v116, v117
  v_cvt_pk_bf16_f32 v117, v118, v119
  buffer_store_dwordx2 v[116:117], v3, s[16:19], s50 offen offset:0
L_fin:
L_end:
  s_endpgm
.section .rodata,"a"
.p2align 6
.amdhsa_kernel standalone__glu_gated_geglu__prompt_kernel
  .amdhsa_next_free_vgpr 512
  .amdhsa_next_free_sgpr 102
  .amdhsa_accum_offset 256
  .amdhsa_group_segment_fixed_size 0
  .amdhsa_kernarg_size 56
  .amdhsa_user_sgpr_count 2
  .amdhsa_user_sgpr_kernarg_segment_ptr 1
  .amdhsa_system_sgpr_workgroup_id_x 1
  .amdhsa_float_denorm_mode_32 3
.end_amdhsa_kernel
```
